```python
import torch

def _softmax(x, axis=-1):
    return torch.softmax(x, dim=axis)
def _gelu(x):
    return torch.nn.functional.gelu(x, approximate="tanh")
def _silu(x):
    return torch.nn.functional.silu(x)
def _sigmoid(x):
    return torch.sigmoid(x)
def _layernorm(x, axis=-1, eps=1e-5):
    m = x.mean(dim=axis, keepdim=True)
    v = x.var(dim=axis, keepdim=True, unbiased=False)
    return (x - m) / torch.sqrt(v + eps)
def _scatter_add(tgt, idx, src, axis=0):
    return tgt.clone().index_add_(axis, idx, src)
def _segment_sum(src, seg, n):
    out = torch.zeros((n,) + src.shape[1:], dtype=src.dtype)
    return out.index_add_(0, seg, src)
def _pad(x, pw):
    flat = tuple(v for pair in reversed(pw) for v in pair)
    return torch.nn.functional.pad(x, flat)

kernel_name = 'sequential_preLN__linear_attn_block__swiglu_ffn__prompt'

def setup_inputs():

    _w = (lambda a: (lambda t: t.to(torch.bfloat16) if t.is_floating_point() else t)(torch.as_tensor(a)))
    def _A_setup():
        B, S, D = 1, 2048, 640
        return {
            "x": _w((lambda *s: torch.randn(*s, dtype=torch.bfloat16) * 0.05)(B, S, D)),
            "wqkv": _w((lambda *s: torch.randn(*s, dtype=torch.bfloat16) * 0.1)(D, 3 * D)),
            "wo": _w((lambda *s: torch.randn(*s, dtype=torch.bfloat16) * 0.05)(D, D)),
        }
    _A_in = _A_setup()

    def _B_setup():
        B, S, D, F = 1, 2048, 640, 1728
        return {
            "x": _w((lambda *s: torch.randn(*s, dtype=torch.bfloat16) * 0.05)(B, S, D)),
            "w_gate": _w((lambda *s: torch.randn(*s, dtype=torch.bfloat16) * 0.05)(D, F)),
            "w_up": _w((lambda *s: torch.randn(*s, dtype=torch.bfloat16) * 0.05)(D, F)),
            "w_down": _w((lambda *s: torch.randn(*s, dtype=torch.bfloat16) * 0.05)(F, D)),
        }
    _B_in = _B_setup()

    return {
        "A_x": _A_in["x"],
        "A_wqkv": _A_in["wqkv"],
        "A_wo": _A_in["wo"],
        "B_x": _B_in["x"],
        "B_w_gate": _B_in["w_gate"],
        "B_w_up": _B_in["w_up"],
        "B_w_down": _B_in["w_down"],
    }

def reference(A_x, A_wqkv, A_wo, B_x, B_w_gate, B_w_up, B_w_down):
    def _A_ref(x, wqkv, wo):
        B, S, D = x.shape
        H = 32; Dh = D // H
        qkv = (lambda x, *d: x.permute(*d))((x @ wqkv).reshape(B, S, 3, H, Dh), 2, 0, 3, 1, 4)
        q, k, v = qkv[0], qkv[1], qkv[2]
        phi = lambda t: torch.where(t > 0, t + 1, torch.exp(t)) + 1e-6
        pq, pk = phi(q), phi(k)
        kv = torch.einsum("bhsd,bhse->bhde", pk, v)
        z = torch.einsum("bhsd->bhd", pk)
        num = torch.einsum("bhqd,bhde->bhqe", pq, kv)
        den = torch.einsum("bhqd,bhd->bhq", pq, z)[..., None] + 1e-6
        o = num / den
        return (lambda x, *d: x.permute(*d))(o, 0, 2, 1, 3).reshape(B, S, D) @ wo

    def _B_ref(x, w_gate, w_up, w_down):
        g = _silu(x @ w_gate)
        u = x @ w_up
        return (g * u) @ w_down

    x = A_x
    h = x + _A_ref(_layernorm(x, axis=-1), A_wqkv, A_wo)
    h2 = h + _B_ref(_layernorm(h, axis=-1), B_w_gate, B_w_up, B_w_down)
    return h2
```

```asm
; @launch grid=(256,1,1) block=(256,1,1) lds=163840
.amdgcn_target "amdgcn-amd-amdhsa--gfx950"
.text
.globl sequential_preLN__linear_attn_block__swiglu_ffn__prompt_kernel
.p2align 8
.type sequential_preLN__linear_attn_block__swiglu_ffn__prompt_kernel,@function
sequential_preLN__linear_attn_block__swiglu_ffn__prompt_kernel:
s_cmp_ge_u32 s2, 256
s_cbranch_scc1 L_end_sequential_preLN__linear_attn_block__swiglu_ffn__prompt_kernel
v_lshrrev_b32 v2, 6, v0
v_and_b32 v1, 63, v0
v_readfirstlane_b32 s16, v2
s_load_dwordx4 s[4:7], s[0:1], 0
s_load_dwordx4 s[24:27], s[0:1], 64
s_and_b32 s19, s2, 7
s_lshr_b32 s20, s2, 3
s_mov_b32 s11, 0x20000
s_mov_b32 s15, 0x20000
s_mov_b32 s59, 0x20000
s_mov_b32 s63, 0x20000
s_mov_b32 s10, 268435456
s_mov_b32 s14, 2621440
s_mov_b32 s58, 2457600
s_movk_i32 s62, 256
s_mov_b32 s77, 0x7f000000
s_cmp_lt_u32 s20, 8
s_cbranch_scc0 L_gemm_sequential_preLN__linear_attn_block__swiglu_ffn__prompt_kernel
s_load_dwordx2 s[28:29], s[0:1], 16
s_load_dwordx4 s[32:35], s[0:1], 32
s_load_dwordx2 s[30:31], s[0:1], 48
s_waitcnt lgkmcnt(0)
s_mov_b32 s12, s4
s_and_b32 s13, s5, 0xffff
s_mov_b32 s56, s6
s_and_b32 s57, s7, 0xffff
s_mov_b32 s60, s24
s_and_b32 s61, s25, 0xffff
s_mov_b32 s8, s26
s_and_b32 s9, s27, 0xffff
s_mov_b32 s64, s28
s_and_b32 s65, s29, 0xffff
s_mov_b32 s66, 819200
s_mov_b32 s67, 0x20000
s_mov_b32 s68, s32
s_and_b32 s69, s33, 0xffff
s_mov_b32 s70, 2211840
s_mov_b32 s71, 0x20000
s_mov_b32 s72, s34
s_and_b32 s73, s35, 0xffff
s_mov_b32 s74, 2211840
s_mov_b32 s75, 0x20000
s_mov_b32 s44, s30
s_and_b32 s45, s31, 0xffff
s_mov_b32 s46, 2211840
s_mov_b32 s47, 0x20000
s_lshl_b32 s17, s19, 3
s_add_u32 s17, s17, s20
s_cmp_lt_u32 s17, 30
s_cselect_b32 s48, s56, s12
s_cselect_b32 s49, s57, s13
s_cselect_b32 s50, s58, s14
s_mov_b32 s51, 0x20000
s_cselect_b32 s52, 30720, 64
s_cselect_b32 s53, 30720, 64
s_cselect_b32 s54, 3, 4
s_cselect_b32 s55, 7, 15
s_movk_i32 s22, 1280
s_cselect_b32 s22, 3840, s22
s_mul_i32 s23, s16, 614400
s_lshl_b32 s24, s17, 7
s_add_u32 s23, s23, s24
s_sub_u32 s33, s17, 30
s_lshl_b32 s33, s33, 2
s_add_u32 s33, s33, s16
s_mul_i32 s24, s33, 20480
s_cmp_lt_u32 s17, 30
s_cselect_b32 s23, s23, s24
s_cselect_b32 s52, s52, 256
s_cselect_b32 s53, s53, 4096
v_lshrrev_b32 v8, s54, v1
v_and_b32 v9, s55, v1
v_mul_lo_u32 v10, v8, s22
v_lshl_add_u32 v10, v9, 4, v10
buffer_load_dwordx4 v[32:35], v10, s[48:51], s23 offen
s_add_u32 s23, s23, s52
buffer_load_dwordx4 v[36:39], v10, s[48:51], s23 offen
s_add_u32 s23, s23, s52
buffer_load_dwordx4 v[40:43], v10, s[48:51], s23 offen
s_add_u32 s23, s23, s52
buffer_load_dwordx4 v[44:47], v10, s[48:51], s23 offen
s_add_u32 s23, s23, s52
buffer_load_dwordx4 v[48:51], v10, s[48:51], s23 offen
s_add_u32 s23, s23, s53
buffer_load_dwordx4 v[52:55], v10, s[48:51], s23 offen
s_add_u32 s23, s23, s52
buffer_load_dwordx4 v[56:59], v10, s[48:51], s23 offen
s_add_u32 s23, s23, s52
buffer_load_dwordx4 v[60:63], v10, s[48:51], s23 offen
s_add_u32 s23, s23, s52
buffer_load_dwordx4 v[64:67], v10, s[48:51], s23 offen
s_add_u32 s23, s23, s52
buffer_load_dwordx4 v[68:71], v10, s[48:51], s23 offen
s_add_u32 s23, s23, s53
buffer_load_dwordx4 v[72:75], v10, s[48:51], s23 offen
s_add_u32 s23, s23, s52
buffer_load_dwordx4 v[76:79], v10, s[48:51], s23 offen
s_add_u32 s23, s23, s52
buffer_load_dwordx4 v[80:83], v10, s[48:51], s23 offen
s_add_u32 s23, s23, s52
buffer_load_dwordx4 v[84:87], v10, s[48:51], s23 offen
s_add_u32 s23, s23, s52
buffer_load_dwordx4 v[88:91], v10, s[48:51], s23 offen
s_add_u32 s23, s23, s53
buffer_load_dwordx4 v[92:95], v10, s[48:51], s23 offen
s_add_u32 s23, s23, s52
buffer_load_dwordx4 v[96:99], v10, s[48:51], s23 offen
s_add_u32 s23, s23, s52
buffer_load_dwordx4 v[100:103], v10, s[48:51], s23 offen
s_add_u32 s23, s23, s52
buffer_load_dwordx4 v[104:107], v10, s[48:51], s23 offen
s_add_u32 s23, s23, s52
buffer_load_dwordx4 v[108:111], v10, s[48:51], s23 offen
s_add_u32 s23, s23, s53
v_lshlrev_b32 v2, 4, v1
v_mov_b32 v4, 0
v_mov_b32 v5, 0
v_mov_b32 v6, 0
v_mov_b32 v7, 0
s_lshl_b32 s20, s17, 11
s_lshl_b32 s21, s16, 9
s_add_u32 s20, s20, s21
s_add_u32 s20, s20, 19795968
s_mov_b32 exec_hi, 0
buffer_store_dwordx4 v[4:7], v2, s[8:11], s20 offen sc1
s_mov_b64 exec, -1
s_mul_i32 s20, s17, 69888
s_lshl_b32 s21, s16, 10
s_add_u32 s20, s20, s21
s_add_u32 s20, s20, 19927040
s_cmp_lt_u32 s17, 16
s_cselect_b32 s20, s20, 2130706432
s_cmp_lt_u32 s16, 2
s_cselect_b32 s20, s20, 2130706432
buffer_store_dwordx4 v[4:7], v2, s[8:11], s20 offen sc1
s_lshl_b32 s18, s17, 2
s_add_u32 s18, s18, s16
s_mul_i32 s19, s16, 40960
v_lshrrev_b32 v112, 3, v1
v_and_b32 v113, 7, v1
v_bfe_u32 v114, v1, 4, 2
v_lshlrev_b32 v115, 1, v114
v_xor_b32 v113, v113, v115
v_xor_b32 v115, 4, v113
v_mul_u32_u24 v11, 1280, v112
v_lshl_add_u32 v11, v113, 4, v11
v_mul_u32_u24 v12, 3456, v112
v_lshl_add_u32 v13, v115, 4, v12
v_lshl_add_u32 v12, v113, 4, v12
s_add_u32 s24, s18, 0
s_mul_hi_u32 s26, s24, 429496730
s_mul_i32 s25, s26, 10
s_sub_u32 s25, s24, s25
s_cmp_lt_u32 s18, 200
s_cselect_b32 s27, 0, 2130706432
s_mul_i32 s28, s26, 40960
s_lshl_b32 s29, s25, 7
s_add_u32 s28, s28, s29
s_add_u32 s28, s28, s27
s_mul_i32 s29, s25, 81920
s_lshl_b32 s26, s26, 10
s_add_u32 s29, s29, s26
s_add_u32 s29, s29, s27
s_add_u32 s96, s29, 12320768
s_add_u32 s30, s19, 32768
s_mov_b32 m0, s30
s_add_u32 s31, s28, 0
buffer_load_dwordx4 v11, s[64:67], s31 offen  lds
s_add_u32 s30, s19, 33792
s_mov_b32 m0, s30
s_add_u32 s31, s28, 10240
buffer_load_dwordx4 v11, s[64:67], s31 offen  lds
s_add_u32 s30, s19, 34816
s_mov_b32 m0, s30
s_add_u32 s31, s28, 20480
buffer_load_dwordx4 v11, s[64:67], s31 offen  lds
s_add_u32 s30, s19, 35840
s_mov_b32 m0, s30
s_add_u32 s31, s28, 30720
buffer_load_dwordx4 v11, s[64:67], s31 offen  lds
s_lshl_b32 s43, s18, 2
v_lshrrev_b32 v119, 4, v1
v_and_b32 v116, 15, v1
v_mul_u32_u24 v117, 1280, v119
v_lshl_add_u32 v117, v116, 4, v117
s_mul_i32 s42, s43, 1280
buffer_load_dwordx4 v[128:131], v117, s[64:67], s42 offen offset:0
buffer_load_dwordx4 v[132:135], v117, s[64:67], s42 offen offset:256
buffer_load_dwordx4 v[136:139], v117, s[64:67], s42 offen offset:512
buffer_load_dwordx4 v[140:143], v117, s[64:67], s42 offen offset:768
buffer_load_dwordx4 v[144:147], v117, s[64:67], s42 offen offset:1024
v_mov_b32 v16, 0
v_mov_b32 v17, 0
v_mov_b32 v18, 0
v_mov_b32 v19, 0
v_mov_b32 v20, 0
v_mov_b32 v21, 0
v_mov_b32 v22, 0
v_mov_b32 v23, 0
s_cmp_ge_u32 s17, 30
s_cbranch_scc1 L_aux_stats_sequential_preLN__linear_attn_block__swiglu_ffn__prompt_kernel
s_mov_b32 s22, 0x3f80
s_mov_b32 s23, 0x3f800000
s_waitcnt vmcnt(30)
v_dot2_f32_bf16 v16, v32, s22, v16
v_dot2_f32_bf16 v17, v32, s23, v17
v_dot2_f32_bf16 v18, v33, s22, v18
v_dot2_f32_bf16 v19, v33, s23, v19
v_dot2_f32_bf16 v20, v34, s22, v20
v_dot2_f32_bf16 v21, v34, s23, v21
v_dot2_f32_bf16 v22, v35, s22, v22
v_dot2_f32_bf16 v23, v35, s23, v23
s_waitcnt vmcnt(29)
v_dot2_f32_bf16 v16, v36, s22, v16
v_dot2_f32_bf16 v17, v36, s23, v17
v_dot2_f32_bf16 v18, v37, s22, v18
v_dot2_f32_bf16 v19, v37, s23, v19
v_dot2_f32_bf16 v20, v38, s22, v20
v_dot2_f32_bf16 v21, v38, s23, v21
v_dot2_f32_bf16 v22, v39, s22, v22
v_dot2_f32_bf16 v23, v39, s23, v23
s_waitcnt vmcnt(28)
v_dot2_f32_bf16 v16, v40, s22, v16
v_dot2_f32_bf16 v17, v40, s23, v17
v_dot2_f32_bf16 v18, v41, s22, v18
v_dot2_f32_bf16 v19, v41, s23, v19
v_dot2_f32_bf16 v20, v42, s22, v20
v_dot2_f32_bf16 v21, v42, s23, v21
v_dot2_f32_bf16 v22, v43, s22, v22
v_dot2_f32_bf16 v23, v43, s23, v23
s_waitcnt vmcnt(27)
v_dot2_f32_bf16 v16, v44, s22, v16
v_dot2_f32_bf16 v17, v44, s23, v17
v_dot2_f32_bf16 v18, v45, s22, v18
v_dot2_f32_bf16 v19, v45, s23, v19
v_dot2_f32_bf16 v20, v46, s22, v20
v_dot2_f32_bf16 v21, v46, s23, v21
v_dot2_f32_bf16 v22, v47, s22, v22
v_dot2_f32_bf16 v23, v47, s23, v23
s_waitcnt vmcnt(26)
v_dot2_f32_bf16 v16, v48, s22, v16
v_dot2_f32_bf16 v17, v48, s23, v17
v_dot2_f32_bf16 v18, v49, s22, v18
v_dot2_f32_bf16 v19, v49, s23, v19
v_dot2_f32_bf16 v20, v50, s22, v20
v_dot2_f32_bf16 v21, v50, s23, v21
v_dot2_f32_bf16 v22, v51, s22, v22
v_dot2_f32_bf16 v23, v51, s23, v23
s_waitcnt vmcnt(25)
v_dot2_f32_bf16 v16, v52, s22, v16
v_dot2_f32_bf16 v17, v52, s23, v17
v_dot2_f32_bf16 v18, v53, s22, v18
v_dot2_f32_bf16 v19, v53, s23, v19
v_dot2_f32_bf16 v20, v54, s22, v20
v_dot2_f32_bf16 v21, v54, s23, v21
v_dot2_f32_bf16 v22, v55, s22, v22
v_dot2_f32_bf16 v23, v55, s23, v23
s_waitcnt vmcnt(24)
v_dot2_f32_bf16 v16, v56, s22, v16
v_dot2_f32_bf16 v17, v56, s23, v17
v_dot2_f32_bf16 v18, v57, s22, v18
v_dot2_f32_bf16 v19, v57, s23, v19
v_dot2_f32_bf16 v20, v58, s22, v20
v_dot2_f32_bf16 v21, v58, s23, v21
v_dot2_f32_bf16 v22, v59, s22, v22
v_dot2_f32_bf16 v23, v59, s23, v23
s_waitcnt vmcnt(23)
v_dot2_f32_bf16 v16, v60, s22, v16
v_dot2_f32_bf16 v17, v60, s23, v17
v_dot2_f32_bf16 v18, v61, s22, v18
v_dot2_f32_bf16 v19, v61, s23, v19
v_dot2_f32_bf16 v20, v62, s22, v20
v_dot2_f32_bf16 v21, v62, s23, v21
v_dot2_f32_bf16 v22, v63, s22, v22
v_dot2_f32_bf16 v23, v63, s23, v23
s_waitcnt vmcnt(22)
v_dot2_f32_bf16 v16, v64, s22, v16
v_dot2_f32_bf16 v17, v64, s23, v17
v_dot2_f32_bf16 v18, v65, s22, v18
v_dot2_f32_bf16 v19, v65, s23, v19
v_dot2_f32_bf16 v20, v66, s22, v20
v_dot2_f32_bf16 v21, v66, s23, v21
v_dot2_f32_bf16 v22, v67, s22, v22
v_dot2_f32_bf16 v23, v67, s23, v23
s_waitcnt vmcnt(21)
v_dot2_f32_bf16 v16, v68, s22, v16
v_dot2_f32_bf16 v17, v68, s23, v17
v_dot2_f32_bf16 v18, v69, s22, v18
v_dot2_f32_bf16 v19, v69, s23, v19
v_dot2_f32_bf16 v20, v70, s22, v20
v_dot2_f32_bf16 v21, v70, s23, v21
v_dot2_f32_bf16 v22, v71, s22, v22
v_dot2_f32_bf16 v23, v71, s23, v23
s_waitcnt vmcnt(20)
v_dot2_f32_bf16 v16, v72, s22, v16
v_dot2_f32_bf16 v17, v72, s23, v17
v_dot2_f32_bf16 v18, v73, s22, v18
v_dot2_f32_bf16 v19, v73, s23, v19
v_dot2_f32_bf16 v20, v74, s22, v20
v_dot2_f32_bf16 v21, v74, s23, v21
v_dot2_f32_bf16 v22, v75, s22, v22
v_dot2_f32_bf16 v23, v75, s23, v23
s_waitcnt vmcnt(19)
v_dot2_f32_bf16 v16, v76, s22, v16
v_dot2_f32_bf16 v17, v76, s23, v17
v_dot2_f32_bf16 v18, v77, s22, v18
v_dot2_f32_bf16 v19, v77, s23, v19
v_dot2_f32_bf16 v20, v78, s22, v20
v_dot2_f32_bf16 v21, v78, s23, v21
v_dot2_f32_bf16 v22, v79, s22, v22
v_dot2_f32_bf16 v23, v79, s23, v23
s_waitcnt vmcnt(18)
v_dot2_f32_bf16 v16, v80, s22, v16
v_dot2_f32_bf16 v17, v80, s23, v17
v_dot2_f32_bf16 v18, v81, s22, v18
v_dot2_f32_bf16 v19, v81, s23, v19
v_dot2_f32_bf16 v20, v82, s22, v20
v_dot2_f32_bf16 v21, v82, s23, v21
v_dot2_f32_bf16 v22, v83, s22, v22
v_dot2_f32_bf16 v23, v83, s23, v23
s_waitcnt vmcnt(17)
v_dot2_f32_bf16 v16, v84, s22, v16
v_dot2_f32_bf16 v17, v84, s23, v17
v_dot2_f32_bf16 v18, v85, s22, v18
v_dot2_f32_bf16 v19, v85, s23, v19
v_dot2_f32_bf16 v20, v86, s22, v20
v_dot2_f32_bf16 v21, v86, s23, v21
v_dot2_f32_bf16 v22, v87, s22, v22
v_dot2_f32_bf16 v23, v87, s23, v23
s_waitcnt vmcnt(16)
v_dot2_f32_bf16 v16, v88, s22, v16
v_dot2_f32_bf16 v17, v88, s23, v17
v_dot2_f32_bf16 v18, v89, s22, v18
v_dot2_f32_bf16 v19, v89, s23, v19
v_dot2_f32_bf16 v20, v90, s22, v20
v_dot2_f32_bf16 v21, v90, s23, v21
v_dot2_f32_bf16 v22, v91, s22, v22
v_dot2_f32_bf16 v23, v91, s23, v23
s_waitcnt vmcnt(15)
v_dot2_f32_bf16 v16, v92, s22, v16
v_dot2_f32_bf16 v17, v92, s23, v17
v_dot2_f32_bf16 v18, v93, s22, v18
v_dot2_f32_bf16 v19, v93, s23, v19
v_dot2_f32_bf16 v20, v94, s22, v20
v_dot2_f32_bf16 v21, v94, s23, v21
v_dot2_f32_bf16 v22, v95, s22, v22
v_dot2_f32_bf16 v23, v95, s23, v23
s_waitcnt vmcnt(14)
v_dot2_f32_bf16 v16, v96, s22, v16
v_dot2_f32_bf16 v17, v96, s23, v17
v_dot2_f32_bf16 v18, v97, s22, v18
v_dot2_f32_bf16 v19, v97, s23, v19
v_dot2_f32_bf16 v20, v98, s22, v20
v_dot2_f32_bf16 v21, v98, s23, v21
v_dot2_f32_bf16 v22, v99, s22, v22
v_dot2_f32_bf16 v23, v99, s23, v23
s_waitcnt vmcnt(13)
v_dot2_f32_bf16 v16, v100, s22, v16
v_dot2_f32_bf16 v17, v100, s23, v17
v_dot2_f32_bf16 v18, v101, s22, v18
v_dot2_f32_bf16 v19, v101, s23, v19
v_dot2_f32_bf16 v20, v102, s22, v20
v_dot2_f32_bf16 v21, v102, s23, v21
v_dot2_f32_bf16 v22, v103, s22, v22
v_dot2_f32_bf16 v23, v103, s23, v23
s_waitcnt vmcnt(12)
v_dot2_f32_bf16 v16, v104, s22, v16
v_dot2_f32_bf16 v17, v104, s23, v17
v_dot2_f32_bf16 v18, v105, s22, v18
v_dot2_f32_bf16 v19, v105, s23, v19
v_dot2_f32_bf16 v20, v106, s22, v20
v_dot2_f32_bf16 v21, v106, s23, v21
v_dot2_f32_bf16 v22, v107, s22, v22
v_dot2_f32_bf16 v23, v107, s23, v23
s_waitcnt vmcnt(11)
v_dot2_f32_bf16 v16, v108, s22, v16
v_dot2_f32_bf16 v17, v108, s23, v17
v_dot2_f32_bf16 v18, v109, s22, v18
v_dot2_f32_bf16 v19, v109, s23, v19
v_dot2_f32_bf16 v20, v110, s22, v20
v_dot2_f32_bf16 v21, v110, s23, v21
v_dot2_f32_bf16 v22, v111, s22, v22
v_dot2_f32_bf16 v23, v111, s23, v23
s_nop 3
v_add_f32_dpp v16, v16, v16 row_ror:8 row_mask:0xf bank_mask:0xf
v_add_f32_dpp v17, v17, v17 row_ror:8 row_mask:0xf bank_mask:0xf
v_add_f32_dpp v18, v18, v18 row_ror:8 row_mask:0xf bank_mask:0xf
v_add_f32_dpp v19, v19, v19 row_ror:8 row_mask:0xf bank_mask:0xf
v_add_f32_dpp v20, v20, v20 row_ror:8 row_mask:0xf bank_mask:0xf
v_add_f32_dpp v21, v21, v21 row_ror:8 row_mask:0xf bank_mask:0xf
v_add_f32_dpp v22, v22, v22 row_ror:8 row_mask:0xf bank_mask:0xf
v_add_f32_dpp v23, v23, v23 row_ror:8 row_mask:0xf bank_mask:0xf
v_mov_b32 v24, v16
v_mov_b32 v25, v17
v_mov_b32 v26, v18
v_mov_b32 v27, v19
v_mov_b32 v28, v20
v_mov_b32 v29, v21
v_mov_b32 v30, v22
v_mov_b32 v31, v23
v_permlane16_swap_b32 v16, v24
v_permlane16_swap_b32 v17, v25
v_permlane16_swap_b32 v18, v26
v_permlane16_swap_b32 v19, v27
v_permlane16_swap_b32 v20, v28
v_permlane16_swap_b32 v21, v29
v_permlane16_swap_b32 v22, v30
v_permlane16_swap_b32 v23, v31
v_add_f32 v16, v16, v24
v_add_f32 v17, v17, v25
v_add_f32 v18, v18, v26
v_add_f32 v19, v19, v27
v_add_f32 v20, v20, v28
v_add_f32 v21, v21, v29
v_add_f32 v22, v22, v30
v_add_f32 v23, v23, v31
v_mov_b32 v24, v16
v_mov_b32 v25, v17
v_mov_b32 v26, v18
v_mov_b32 v27, v19
v_mov_b32 v28, v20
v_mov_b32 v29, v21
v_mov_b32 v30, v22
v_mov_b32 v31, v23
v_permlane32_swap_b32 v16, v24
v_permlane32_swap_b32 v17, v25
v_permlane32_swap_b32 v18, v26
v_permlane32_swap_b32 v19, v27
v_permlane32_swap_b32 v20, v28
v_permlane32_swap_b32 v21, v29
v_permlane32_swap_b32 v22, v30
v_permlane32_swap_b32 v23, v31
v_add_f32 v16, v16, v24
v_add_f32 v17, v17, v25
v_add_f32 v18, v18, v26
v_add_f32 v19, v19, v27
v_add_f32 v20, v20, v28
v_add_f32 v21, v21, v29
v_add_f32 v22, v22, v30
v_add_f32 v23, v23, v31
v_lshlrev_b32 v10, 5, v9
s_lshl_b32 s20, s16, 8
s_add_u32 s20, s20, 36864
v_add_u32 v10, s20, v10
ds_write_b128 v10, v[16:19]
ds_write_b128 v10, v[20:23] offset:16
v_lshlrev_b32 v10, 2, v1
v_add_u32 v24, 36864, v10
s_waitcnt lgkmcnt(0)
s_barrier
ds_read_b32 v16, v24 offset:0
ds_read_b32 v17, v24 offset:256
ds_read_b32 v18, v24 offset:512
ds_read_b32 v19, v24 offset:768
s_waitcnt lgkmcnt(2)
v_add_f32 v16, v16, v17
s_waitcnt lgkmcnt(0)
v_add_f32 v18, v18, v19
v_add_f32 v16, v16, v18
s_lshl_b32 s20, s17, 8
s_add_u32 s20, s20, 21061632
s_cmp_eq_u32 s16, 0
s_cselect_b32 s20, s20, 2130706432
buffer_store_dword v16, v10, s[8:11], s20 offen sc1
s_branch L_aux_sig_sequential_preLN__linear_attn_block__swiglu_ffn__prompt_kernel
L_aux_stats_sequential_preLN__linear_attn_block__swiglu_ffn__prompt_kernel:
s_nop 12
s_mov_b32 s22, 0x3f803f80
s_waitcnt vmcnt(30)
v_dot2_f32_bf16 v16, v32, s22, v16
v_dot2_f32_bf16 v17, v32, v32, v17
v_dot2_f32_bf16 v16, v33, s22, v16
v_dot2_f32_bf16 v17, v33, v33, v17
v_dot2_f32_bf16 v16, v34, s22, v16
v_dot2_f32_bf16 v17, v34, v34, v17
v_dot2_f32_bf16 v16, v35, s22, v16
v_dot2_f32_bf16 v17, v35, v35, v17
s_waitcnt vmcnt(29)
v_dot2_f32_bf16 v16, v36, s22, v16
v_dot2_f32_bf16 v17, v36, v36, v17
v_dot2_f32_bf16 v16, v37, s22, v16
v_dot2_f32_bf16 v17, v37, v37, v17
v_dot2_f32_bf16 v16, v38, s22, v16
v_dot2_f32_bf16 v17, v38, v38, v17
v_dot2_f32_bf16 v16, v39, s22, v16
v_dot2_f32_bf16 v17, v39, v39, v17
s_waitcnt vmcnt(28)
v_dot2_f32_bf16 v16, v40, s22, v16
v_dot2_f32_bf16 v17, v40, v40, v17
v_dot2_f32_bf16 v16, v41, s22, v16
v_dot2_f32_bf16 v17, v41, v41, v17
v_dot2_f32_bf16 v16, v42, s22, v16
v_dot2_f32_bf16 v17, v42, v42, v17
v_dot2_f32_bf16 v16, v43, s22, v16
v_dot2_f32_bf16 v17, v43, v43, v17
s_waitcnt vmcnt(27)
v_dot2_f32_bf16 v16, v44, s22, v16
v_dot2_f32_bf16 v17, v44, v44, v17
v_dot2_f32_bf16 v16, v45, s22, v16
v_dot2_f32_bf16 v17, v45, v45, v17
v_dot2_f32_bf16 v16, v46, s22, v16
v_dot2_f32_bf16 v17, v46, v46, v17
v_dot2_f32_bf16 v16, v47, s22, v16
v_dot2_f32_bf16 v17, v47, v47, v17
s_waitcnt vmcnt(26)
v_dot2_f32_bf16 v16, v48, s22, v16
v_dot2_f32_bf16 v17, v48, v48, v17
v_dot2_f32_bf16 v16, v49, s22, v16
v_dot2_f32_bf16 v17, v49, v49, v17
v_dot2_f32_bf16 v16, v50, s22, v16
v_dot2_f32_bf16 v17, v50, v50, v17
v_dot2_f32_bf16 v16, v51, s22, v16
v_dot2_f32_bf16 v17, v51, v51, v17
s_waitcnt vmcnt(25)
v_dot2_f32_bf16 v18, v52, s22, v18
v_dot2_f32_bf16 v19, v52, v52, v19
v_dot2_f32_bf16 v18, v53, s22, v18
v_dot2_f32_bf16 v19, v53, v53, v19
v_dot2_f32_bf16 v18, v54, s22, v18
v_dot2_f32_bf16 v19, v54, v54, v19
v_dot2_f32_bf16 v18, v55, s22, v18
v_dot2_f32_bf16 v19, v55, v55, v19
s_waitcnt vmcnt(24)
v_dot2_f32_bf16 v18, v56, s22, v18
v_dot2_f32_bf16 v19, v56, v56, v19
v_dot2_f32_bf16 v18, v57, s22, v18
v_dot2_f32_bf16 v19, v57, v57, v19
v_dot2_f32_bf16 v18, v58, s22, v18
v_dot2_f32_bf16 v19, v58, v58, v19
v_dot2_f32_bf16 v18, v59, s22, v18
v_dot2_f32_bf16 v19, v59, v59, v19
s_waitcnt vmcnt(23)
v_dot2_f32_bf16 v18, v60, s22, v18
v_dot2_f32_bf16 v19, v60, v60, v19
v_dot2_f32_bf16 v18, v61, s22, v18
v_dot2_f32_bf16 v19, v61, v61, v19
v_dot2_f32_bf16 v18, v62, s22, v18
v_dot2_f32_bf16 v19, v62, v62, v19
v_dot2_f32_bf16 v18, v63, s22, v18
v_dot2_f32_bf16 v19, v63, v63, v19
s_waitcnt vmcnt(22)
v_dot2_f32_bf16 v18, v64, s22, v18
v_dot2_f32_bf16 v19, v64, v64, v19
v_dot2_f32_bf16 v18, v65, s22, v18
v_dot2_f32_bf16 v19, v65, v65, v19
v_dot2_f32_bf16 v18, v66, s22, v18
v_dot2_f32_bf16 v19, v66, v66, v19
v_dot2_f32_bf16 v18, v67, s22, v18
v_dot2_f32_bf16 v19, v67, v67, v19
s_waitcnt vmcnt(21)
v_dot2_f32_bf16 v18, v68, s22, v18
v_dot2_f32_bf16 v19, v68, v68, v19
v_dot2_f32_bf16 v18, v69, s22, v18
v_dot2_f32_bf16 v19, v69, v69, v19
v_dot2_f32_bf16 v18, v70, s22, v18
v_dot2_f32_bf16 v19, v70, v70, v19
v_dot2_f32_bf16 v18, v71, s22, v18
v_dot2_f32_bf16 v19, v71, v71, v19
s_waitcnt vmcnt(20)
v_dot2_f32_bf16 v20, v72, s22, v20
v_dot2_f32_bf16 v21, v72, v72, v21
v_dot2_f32_bf16 v20, v73, s22, v20
v_dot2_f32_bf16 v21, v73, v73, v21
v_dot2_f32_bf16 v20, v74, s22, v20
v_dot2_f32_bf16 v21, v74, v74, v21
v_dot2_f32_bf16 v20, v75, s22, v20
v_dot2_f32_bf16 v21, v75, v75, v21
s_waitcnt vmcnt(19)
v_dot2_f32_bf16 v20, v76, s22, v20
v_dot2_f32_bf16 v21, v76, v76, v21
v_dot2_f32_bf16 v20, v77, s22, v20
v_dot2_f32_bf16 v21, v77, v77, v21
v_dot2_f32_bf16 v20, v78, s22, v20
v_dot2_f32_bf16 v21, v78, v78, v21
v_dot2_f32_bf16 v20, v79, s22, v20
v_dot2_f32_bf16 v21, v79, v79, v21
s_waitcnt vmcnt(18)
v_dot2_f32_bf16 v20, v80, s22, v20
v_dot2_f32_bf16 v21, v80, v80, v21
v_dot2_f32_bf16 v20, v81, s22, v20
v_dot2_f32_bf16 v21, v81, v81, v21
v_dot2_f32_bf16 v20, v82, s22, v20
v_dot2_f32_bf16 v21, v82, v82, v21
v_dot2_f32_bf16 v20, v83, s22, v20
v_dot2_f32_bf16 v21, v83, v83, v21
s_waitcnt vmcnt(17)
v_dot2_f32_bf16 v20, v84, s22, v20
v_dot2_f32_bf16 v21, v84, v84, v21
v_dot2_f32_bf16 v20, v85, s22, v20
v_dot2_f32_bf16 v21, v85, v85, v21
v_dot2_f32_bf16 v20, v86, s22, v20
v_dot2_f32_bf16 v21, v86, v86, v21
v_dot2_f32_bf16 v20, v87, s22, v20
v_dot2_f32_bf16 v21, v87, v87, v21
s_waitcnt vmcnt(16)
v_dot2_f32_bf16 v20, v88, s22, v20
v_dot2_f32_bf16 v21, v88, v88, v21
v_dot2_f32_bf16 v20, v89, s22, v20
v_dot2_f32_bf16 v21, v89, v89, v21
v_dot2_f32_bf16 v20, v90, s22, v20
v_dot2_f32_bf16 v21, v90, v90, v21
v_dot2_f32_bf16 v20, v91, s22, v20
v_dot2_f32_bf16 v21, v91, v91, v21
s_waitcnt vmcnt(15)
v_dot2_f32_bf16 v22, v92, s22, v22
v_dot2_f32_bf16 v23, v92, v92, v23
v_dot2_f32_bf16 v22, v93, s22, v22
v_dot2_f32_bf16 v23, v93, v93, v23
v_dot2_f32_bf16 v22, v94, s22, v22
v_dot2_f32_bf16 v23, v94, v94, v23
v_dot2_f32_bf16 v22, v95, s22, v22
v_dot2_f32_bf16 v23, v95, v95, v23
s_waitcnt vmcnt(14)
v_dot2_f32_bf16 v22, v96, s22, v22
v_dot2_f32_bf16 v23, v96, v96, v23
v_dot2_f32_bf16 v22, v97, s22, v22
v_dot2_f32_bf16 v23, v97, v97, v23
v_dot2_f32_bf16 v22, v98, s22, v22
v_dot2_f32_bf16 v23, v98, v98, v23
v_dot2_f32_bf16 v22, v99, s22, v22
v_dot2_f32_bf16 v23, v99, v99, v23
s_waitcnt vmcnt(13)
v_dot2_f32_bf16 v22, v100, s22, v22
v_dot2_f32_bf16 v23, v100, v100, v23
v_dot2_f32_bf16 v22, v101, s22, v22
v_dot2_f32_bf16 v23, v101, v101, v23
v_dot2_f32_bf16 v22, v102, s22, v22
v_dot2_f32_bf16 v23, v102, v102, v23
v_dot2_f32_bf16 v22, v103, s22, v22
v_dot2_f32_bf16 v23, v103, v103, v23
s_waitcnt vmcnt(12)
v_dot2_f32_bf16 v22, v104, s22, v22
v_dot2_f32_bf16 v23, v104, v104, v23
v_dot2_f32_bf16 v22, v105, s22, v22
v_dot2_f32_bf16 v23, v105, v105, v23
v_dot2_f32_bf16 v22, v106, s22, v22
v_dot2_f32_bf16 v23, v106, v106, v23
v_dot2_f32_bf16 v22, v107, s22, v22
v_dot2_f32_bf16 v23, v107, v107, v23
s_waitcnt vmcnt(11)
v_dot2_f32_bf16 v22, v108, s22, v22
v_dot2_f32_bf16 v23, v108, v108, v23
v_dot2_f32_bf16 v22, v109, s22, v22
v_dot2_f32_bf16 v23, v109, v109, v23
v_dot2_f32_bf16 v22, v110, s22, v22
v_dot2_f32_bf16 v23, v110, v110, v23
v_dot2_f32_bf16 v22, v111, s22, v22
v_dot2_f32_bf16 v23, v111, v111, v23
s_nop 3
v_add_f32_dpp v16, v16, v16 row_ror:8 row_mask:0xf bank_mask:0xf
v_add_f32_dpp v17, v17, v17 row_ror:8 row_mask:0xf bank_mask:0xf
v_add_f32_dpp v18, v18, v18 row_ror:8 row_mask:0xf bank_mask:0xf
v_add_f32_dpp v19, v19, v19 row_ror:8 row_mask:0xf bank_mask:0xf
v_add_f32_dpp v20, v20, v20 row_ror:8 row_mask:0xf bank_mask:0xf
v_add_f32_dpp v21, v21, v21 row_ror:8 row_mask:0xf bank_mask:0xf
v_add_f32_dpp v22, v22, v22 row_ror:8 row_mask:0xf bank_mask:0xf
v_add_f32_dpp v23, v23, v23 row_ror:8 row_mask:0xf bank_mask:0xf
v_add_f32_dpp v16, v16, v16 row_ror:4 row_mask:0xf bank_mask:0xf
v_add_f32_dpp v17, v17, v17 row_ror:4 row_mask:0xf bank_mask:0xf
v_add_f32_dpp v18, v18, v18 row_ror:4 row_mask:0xf bank_mask:0xf
v_add_f32_dpp v19, v19, v19 row_ror:4 row_mask:0xf bank_mask:0xf
v_add_f32_dpp v20, v20, v20 row_ror:4 row_mask:0xf bank_mask:0xf
v_add_f32_dpp v21, v21, v21 row_ror:4 row_mask:0xf bank_mask:0xf
v_add_f32_dpp v22, v22, v22 row_ror:4 row_mask:0xf bank_mask:0xf
v_add_f32_dpp v23, v23, v23 row_ror:4 row_mask:0xf bank_mask:0xf
v_add_f32_dpp v16, v16, v16 row_ror:2 row_mask:0xf bank_mask:0xf
v_add_f32_dpp v17, v17, v17 row_ror:2 row_mask:0xf bank_mask:0xf
v_add_f32_dpp v18, v18, v18 row_ror:2 row_mask:0xf bank_mask:0xf
v_add_f32_dpp v19, v19, v19 row_ror:2 row_mask:0xf bank_mask:0xf
v_add_f32_dpp v20, v20, v20 row_ror:2 row_mask:0xf bank_mask:0xf
v_add_f32_dpp v21, v21, v21 row_ror:2 row_mask:0xf bank_mask:0xf
v_add_f32_dpp v22, v22, v22 row_ror:2 row_mask:0xf bank_mask:0xf
v_add_f32_dpp v23, v23, v23 row_ror:2 row_mask:0xf bank_mask:0xf
v_add_f32_dpp v16, v16, v16 row_ror:1 row_mask:0xf bank_mask:0xf
v_add_f32_dpp v17, v17, v17 row_ror:1 row_mask:0xf bank_mask:0xf
v_add_f32_dpp v18, v18, v18 row_ror:1 row_mask:0xf bank_mask:0xf
v_add_f32_dpp v19, v19, v19 row_ror:1 row_mask:0xf bank_mask:0xf
v_add_f32_dpp v20, v20, v20 row_ror:1 row_mask:0xf bank_mask:0xf
v_add_f32_dpp v21, v21, v21 row_ror:1 row_mask:0xf bank_mask:0xf
v_add_f32_dpp v22, v22, v22 row_ror:1 row_mask:0xf bank_mask:0xf
v_add_f32_dpp v23, v23, v23 row_ror:1 row_mask:0xf bank_mask:0xf
v_mul_f32 v17, 0x3acccccd, v17
v_mul_f32 v24, 0x3acccccd, v16
v_fma_f32 v16, -v24, v24, v17
v_max_f32 v16, 0, v16
v_add_f32 v16, 0x3727c5ac, v16
v_rsq_f32 v16, v16
v_mov_b32 v17, v24
v_mul_f32 v19, 0x3acccccd, v19
v_mul_f32 v24, 0x3acccccd, v18
v_fma_f32 v18, -v24, v24, v19
v_max_f32 v18, 0, v18
v_add_f32 v18, 0x3727c5ac, v18
v_rsq_f32 v18, v18
v_mov_b32 v19, v24
v_mul_f32 v21, 0x3acccccd, v21
v_mul_f32 v24, 0x3acccccd, v20
v_fma_f32 v20, -v24, v24, v21
v_max_f32 v20, 0, v20
v_add_f32 v20, 0x3727c5ac, v20
v_rsq_f32 v20, v20
v_mov_b32 v21, v24
v_mul_f32 v23, 0x3acccccd, v23
v_mul_f32 v24, 0x3acccccd, v22
v_fma_f32 v22, -v24, v24, v23
v_max_f32 v22, 0, v22
v_add_f32 v22, 0x3727c5ac, v22
v_rsq_f32 v22, v22
v_mov_b32 v23, v24
v_lshlrev_b32 v10, 2, v8
s_lshl_b32 s20, s33, 6
s_add_u32 s20, s20, 21045248
s_cmp_lt_u32 s17, 62
s_cselect_b32 s20, s20, 2130706432
s_add_u32 s21, s20, 8192
s_mov_b32 exec_lo, 0x00010001
s_mov_b32 exec_hi, 0x00010001
buffer_store_dword v16, v10, s[8:11], s20 offen offset:0 sc1
buffer_store_dword v17, v10, s[8:11], s21 offen offset:0 sc1
buffer_store_dword v18, v10, s[8:11], s20 offen offset:16 sc1
buffer_store_dword v19, v10, s[8:11], s21 offen offset:16 sc1
buffer_store_dword v20, v10, s[8:11], s20 offen offset:32 sc1
buffer_store_dword v21, v10, s[8:11], s21 offen offset:32 sc1
buffer_store_dword v22, v10, s[8:11], s20 offen offset:48 sc1
buffer_store_dword v23, v10, s[8:11], s21 offen offset:48 sc1
s_mov_b64 exec, -1
L_aux_sig_sequential_preLN__linear_attn_block__swiglu_ffn__prompt_kernel:
s_waitcnt vmcnt(0) lgkmcnt(0)
s_nop 12
s_barrier
v_mov_b32 v4, 1
v_mov_b32 v5, 0
s_cmp_eq_u32 s16, 0
s_cselect_b32 s20, 0, 2130706432
s_mov_b64 exec, 1
buffer_atomic_add v4, v5, s[60:63], s20 offen sc1
s_mov_b64 exec, -1
v_lshrrev_b32 v14, 4, v1
v_bfe_u32 v15, v1, 2, 2
v_and_b32 v16, 3, v1
v_lshlrev_b32 v16, 3, v16
v_add_u32 v16, s19, v16
v_lshl_add_u32 v17, v14, 2, v15
v_lshrrev_b32 v18, 1, v14
v_and_b32 v19, 1, v14
v_lshl_add_u32 v20, v19, 2, v15
v_lshl_add_u32 v20, v18, 4, v20
v_lshl_add_u32 v21, v18, 2, v15
v_bfe_u32 v22, v17, 1, 2
v_lshl_add_u32 v23, v17, 7, v16
v_xor_b32 v36, 0, v22
v_lshl_add_u32 v24, v36, 5, v23
v_xor_b32 v36, 1, v22
v_lshl_add_u32 v25, v36, 5, v23
v_xor_b32 v36, 2, v22
v_lshl_add_u32 v26, v36, 5, v23
v_xor_b32 v36, 3, v22
v_lshl_add_u32 v27, v36, 5, v23
v_bfe_u32 v22, v20, 1, 2
v_lshl_add_u32 v23, v20, 7, v16
v_xor_b32 v36, 0, v22
v_lshl_add_u32 v28, v36, 5, v23
v_xor_b32 v36, 1, v22
v_lshl_add_u32 v29, v36, 5, v23
v_xor_b32 v36, 2, v22
v_lshl_add_u32 v30, v36, 5, v23
v_xor_b32 v36, 3, v22
v_lshl_add_u32 v31, v36, 5, v23
v_bfe_u32 v22, v21, 1, 2
v_lshlrev_b32 v23, 1, v19
v_xor_b32 v22, v22, v23
v_lshl_add_u32 v23, v21, 7, v16
v_lshl_add_u32 v23, v19, 12, v23
v_xor_b32 v36, 0, v22
v_lshl_add_u32 v32, v36, 5, v23
v_xor_b32 v36, 1, v22
v_lshl_add_u32 v33, v36, 5, v23
v_xor_b32 v36, 2, v22
v_lshl_add_u32 v34, v36, 5, v23
v_xor_b32 v36, 3, v22
v_lshl_add_u32 v35, v36, 5, v23
ds_read_b64_tr_b16 v[48:49], v24 offset:32768
ds_read_b64_tr_b16 v[50:51], v24 offset:34816
ds_read_b64_tr_b16 v[52:53], v25 offset:32768
ds_read_b64_tr_b16 v[54:55], v25 offset:34816
ds_read_b64_tr_b16 v[56:57], v26 offset:32768
ds_read_b64_tr_b16 v[58:59], v26 offset:34816
ds_read_b64_tr_b16 v[60:61], v27 offset:32768
ds_read_b64_tr_b16 v[62:63], v27 offset:34816
s_add_u32 s29, s96, 0
s_waitcnt lgkmcnt(6)
buffer_store_dwordx4 v[48:51], v2, s[8:11], s29 offen sc1
s_add_u32 s29, s96, 20480
s_waitcnt lgkmcnt(4)
buffer_store_dwordx4 v[52:55], v2, s[8:11], s29 offen sc1
s_add_u32 s29, s96, 40960
s_waitcnt lgkmcnt(2)
buffer_store_dwordx4 v[56:59], v2, s[8:11], s29 offen sc1
s_add_u32 s29, s96, 61440
s_waitcnt lgkmcnt(0)
buffer_store_dwordx4 v[60:63], v2, s[8:11], s29 offen sc1
s_mov_b32 s22, 0x3f803f80
v_mov_b32 v40, 0
v_mov_b32 v41, 0
v_dot2_f32_bf16 v40, v128, s22, v40
v_dot2_f32_bf16 v41, v129, s22, v41
v_dot2_f32_bf16 v40, v130, s22, v40
v_dot2_f32_bf16 v41, v131, s22, v41
v_dot2_f32_bf16 v40, v132, s22, v40
v_dot2_f32_bf16 v41, v133, s22, v41
v_dot2_f32_bf16 v40, v134, s22, v40
v_dot2_f32_bf16 v41, v135, s22, v41
v_dot2_f32_bf16 v40, v136, s22, v40
v_dot2_f32_bf16 v41, v137, s22, v41
v_dot2_f32_bf16 v40, v138, s22, v40
v_dot2_f32_bf16 v41, v139, s22, v41
v_dot2_f32_bf16 v40, v140, s22, v40
v_dot2_f32_bf16 v41, v141, s22, v41
v_dot2_f32_bf16 v40, v142, s22, v40
v_dot2_f32_bf16 v41, v143, s22, v41
v_dot2_f32_bf16 v40, v144, s22, v40
v_dot2_f32_bf16 v41, v145, s22, v41
v_dot2_f32_bf16 v40, v146, s22, v40
v_dot2_f32_bf16 v41, v147, s22, v41
s_nop 3
v_add_f32 v40, v40, v41
s_nop 1
v_add_f32_dpp v40, v40, v40 row_ror:8 row_mask:0xf bank_mask:0xf
s_nop 1
v_add_f32_dpp v40, v40, v40 row_ror:4 row_mask:0xf bank_mask:0xf
s_nop 1
v_add_f32_dpp v40, v40, v40 row_ror:2 row_mask:0xf bank_mask:0xf
s_nop 1
v_add_f32_dpp v40, v40, v40 row_ror:1 row_mask:0xf bank_mask:0xf
v_mul_f32 v40, 0x3acccccd, v40
v_cvt_pk_bf16_f32 v40, v40, v40
v_add_u32 v44, s43, v14
v_add_u32 v44, 0, v44
v_lshrrev_b32 v45, 5, v44
v_lshlrev_b32 v45, 10, v45
v_bfe_u32 v46, v44, 2, 2
v_lshl_add_u32 v45, v46, 8, v45
v_lshl_add_u32 v45, v116, 4, v45
v_bfe_u32 v46, v44, 4, 1
v_lshl_add_u32 v45, v46, 3, v45
v_and_b32 v46, 3, v44
v_lshl_add_u32 v45, v46, 1, v45
v_cmp_gt_u32 vcc, 640, v44
v_mov_b32 v46, 2130706432
s_nop 0
v_cndmask_b32 v45, v46, v45, vcc
s_mov_b32 s20, 13139968
buffer_store_short v40, v45, s[8:11], s20 offen sc1
s_add_u32 s24, s18, 0
s_mul_hi_u32 s26, s24, 159072863
s_mul_i32 s25, s26, 27
s_sub_u32 s25, s24, s25
s_cmp_eq_u32 s18, s18
s_cselect_b32 s27, 0, 2130706432
s_mul_i32 s28, s26, 110592
s_lshl_b32 s29, s25, 7
s_add_u32 s28, s28, s29
s_add_u32 s28, s28, s27
s_mul_i32 s29, s25, 163840
s_lshl_b32 s26, s26, 11
s_add_u32 s29, s29, s26
s_add_u32 s29, s29, s27
s_add_u32 s97, s29, 13160448
s_add_u32 s30, s19, 0
s_mov_b32 m0, s30
s_add_u32 s31, s28, 0
buffer_load_dwordx4 v12, s[68:71], s31 offen  lds
s_add_u32 s30, s19, 1024
s_mov_b32 m0, s30
s_add_u32 s31, s28, 27648
buffer_load_dwordx4 v12, s[68:71], s31 offen  lds
s_add_u32 s30, s19, 2048
s_mov_b32 m0, s30
s_add_u32 s31, s28, 55296
buffer_load_dwordx4 v12, s[68:71], s31 offen  lds
s_add_u32 s30, s19, 3072
s_mov_b32 m0, s30
s_add_u32 s31, s28, 82944
buffer_load_dwordx4 v12, s[68:71], s31 offen  lds
s_add_u32 s30, s19, 4096
s_mov_b32 m0, s30
s_add_u32 s31, s28, 0
buffer_load_dwordx4 v13, s[72:75], s31 offen  lds
s_add_u32 s30, s19, 5120
s_mov_b32 m0, s30
s_add_u32 s31, s28, 27648
buffer_load_dwordx4 v13, s[72:75], s31 offen  lds
s_add_u32 s30, s19, 6144
s_mov_b32 m0, s30
s_add_u32 s31, s28, 55296
buffer_load_dwordx4 v13, s[72:75], s31 offen  lds
s_add_u32 s30, s19, 7168
s_mov_b32 m0, s30
s_add_u32 s31, s28, 82944
buffer_load_dwordx4 v13, s[72:75], s31 offen  lds
s_add_u32 s24, s18, 256
s_mul_hi_u32 s26, s24, 159072863
s_mul_i32 s25, s26, 27
s_sub_u32 s25, s24, s25
s_cmp_eq_u32 s18, s18
s_cselect_b32 s27, 0, 2130706432
s_mul_i32 s28, s26, 110592
s_lshl_b32 s29, s25, 7
s_add_u32 s28, s28, s29
s_add_u32 s28, s28, s27
s_mul_i32 s29, s25, 163840
s_lshl_b32 s26, s26, 11
s_add_u32 s29, s29, s26
s_add_u32 s29, s29, s27
s_add_u32 s98, s29, 13160448
s_add_u32 s30, s19, 8192
s_mov_b32 m0, s30
s_add_u32 s31, s28, 0
buffer_load_dwordx4 v12, s[68:71], s31 offen  lds
s_add_u32 s30, s19, 9216
s_mov_b32 m0, s30
s_add_u32 s31, s28, 27648
buffer_load_dwordx4 v12, s[68:71], s31 offen  lds
s_add_u32 s30, s19, 10240
s_mov_b32 m0, s30
s_add_u32 s31, s28, 55296
buffer_load_dwordx4 v12, s[68:71], s31 offen  lds
s_add_u32 s30, s19, 11264
s_mov_b32 m0, s30
s_add_u32 s31, s28, 82944
buffer_load_dwordx4 v12, s[68:71], s31 offen  lds
s_add_u32 s30, s19, 12288
s_mov_b32 m0, s30
s_add_u32 s31, s28, 0
buffer_load_dwordx4 v13, s[72:75], s31 offen  lds
s_add_u32 s30, s19, 13312
s_mov_b32 m0, s30
s_add_u32 s31, s28, 27648
buffer_load_dwordx4 v13, s[72:75], s31 offen  lds
s_add_u32 s30, s19, 14336
s_mov_b32 m0, s30
s_add_u32 s31, s28, 55296
buffer_load_dwordx4 v13, s[72:75], s31 offen  lds
s_add_u32 s30, s19, 15360
s_mov_b32 m0, s30
s_add_u32 s31, s28, 82944
buffer_load_dwordx4 v13, s[72:75], s31 offen  lds
s_add_u32 s24, s18, 0
s_mul_hi_u32 s26, s24, 429496730
s_mul_i32 s25, s26, 10
s_sub_u32 s25, s24, s25
s_cmp_eq_u32 s18, s18
s_cselect_b32 s27, 0, 2130706432
s_mul_i32 s28, s26, 40960
s_lshl_b32 s29, s25, 7
s_add_u32 s28, s28, s29
s_add_u32 s28, s28, s27
s_mul_i32 s29, s25, 221184
s_lshl_b32 s26, s26, 10
s_add_u32 s29, s29, s26
s_add_u32 s29, s29, s27
s_add_u32 s99, s29, 17584128
s_add_u32 s30, s19, 16384
s_mov_b32 m0, s30
s_add_u32 s31, s28, 0
buffer_load_dwordx4 v11, s[44:47], s31 offen  lds
s_add_u32 s30, s19, 17408
s_mov_b32 m0, s30
s_add_u32 s31, s28, 10240
buffer_load_dwordx4 v11, s[44:47], s31 offen  lds
s_add_u32 s30, s19, 18432
s_mov_b32 m0, s30
s_add_u32 s31, s28, 20480
buffer_load_dwordx4 v11, s[44:47], s31 offen  lds
s_add_u32 s30, s19, 19456
s_mov_b32 m0, s30
s_add_u32 s31, s28, 30720
buffer_load_dwordx4 v11, s[44:47], s31 offen  lds
s_add_u32 s24, s18, 228
s_mul_hi_u32 s26, s24, 429496730
s_mul_i32 s25, s26, 10
s_sub_u32 s25, s24, s25
s_sub_u32 s27, s18, 28
s_cmp_lt_u32 s27, 28
s_cselect_b32 s27, 0, 2130706432
s_mul_i32 s28, s26, 40960
s_lshl_b32 s29, s25, 7
s_add_u32 s28, s28, s29
s_add_u32 s28, s28, s27
s_mul_i32 s29, s25, 221184
s_lshl_b32 s26, s26, 10
s_add_u32 s29, s29, s26
s_add_u32 s29, s29, s27
s_add_u32 s100, s29, 17584128
s_add_u32 s30, s19, 20480
s_mov_b32 m0, s30
s_add_u32 s31, s28, 0
buffer_load_dwordx4 v11, s[44:47], s31 offen  lds
s_add_u32 s30, s19, 21504
s_mov_b32 m0, s30
s_add_u32 s31, s28, 10240
buffer_load_dwordx4 v11, s[44:47], s31 offen  lds
s_add_u32 s30, s19, 22528
s_mov_b32 m0, s30
s_add_u32 s31, s28, 20480
buffer_load_dwordx4 v11, s[44:47], s31 offen  lds
s_add_u32 s30, s19, 23552
s_mov_b32 m0, s30
s_add_u32 s31, s28, 30720
buffer_load_dwordx4 v11, s[44:47], s31 offen  lds
s_add_u32 s24, s18, 512
s_mul_hi_u32 s26, s24, 159072863
s_mul_i32 s25, s26, 27
s_sub_u32 s25, s24, s25
s_cmp_lt_u32 s18, 28
s_cselect_b32 s27, 0, 2130706432
s_mul_i32 s28, s26, 110592
s_lshl_b32 s29, s25, 7
s_add_u32 s28, s28, s29
s_add_u32 s28, s28, s27
s_mul_i32 s29, s25, 163840
s_lshl_b32 s26, s26, 11
s_add_u32 s29, s29, s26
s_add_u32 s29, s29, s27
s_add_u32 s101, s29, 13160448
s_add_u32 s30, s19, 24576
s_mov_b32 m0, s30
s_add_u32 s31, s28, 0
buffer_load_dwordx4 v12, s[68:71], s31 offen  lds
s_add_u32 s30, s19, 25600
s_mov_b32 m0, s30
s_add_u32 s31, s28, 27648
buffer_load_dwordx4 v12, s[68:71], s31 offen  lds
s_add_u32 s30, s19, 26624
s_mov_b32 m0, s30
s_add_u32 s31, s28, 55296
buffer_load_dwordx4 v12, s[68:71], s31 offen  lds
s_add_u32 s30, s19, 27648
s_mov_b32 m0, s30
s_add_u32 s31, s28, 82944
buffer_load_dwordx4 v12, s[68:71], s31 offen  lds
s_add_u32 s30, s19, 28672
s_mov_b32 m0, s30
s_add_u32 s31, s28, 0
buffer_load_dwordx4 v13, s[72:75], s31 offen  lds
s_add_u32 s30, s19, 29696
s_mov_b32 m0, s30
s_add_u32 s31, s28, 27648
buffer_load_dwordx4 v13, s[72:75], s31 offen  lds
s_add_u32 s30, s19, 30720
s_mov_b32 m0, s30
s_add_u32 s31, s28, 55296
buffer_load_dwordx4 v13, s[72:75], s31 offen  lds
s_add_u32 s30, s19, 31744
s_mov_b32 m0, s30
s_add_u32 s31, s28, 82944
buffer_load_dwordx4 v13, s[72:75], s31 offen  lds
s_waitcnt vmcnt(24)
ds_read_b64_tr_b16 v[80:81], v32 offset:0
ds_read_b64_tr_b16 v[82:83], v32 offset:1024
ds_read_b64_tr_b16 v[84:85], v32 offset:2048
ds_read_b64_tr_b16 v[86:87], v32 offset:3072
ds_read_b64_tr_b16 v[88:89], v33 offset:0
ds_read_b64_tr_b16 v[90:91], v33 offset:1024
ds_read_b64_tr_b16 v[92:93], v33 offset:2048
ds_read_b64_tr_b16 v[94:95], v33 offset:3072
ds_read_b64_tr_b16 v[96:97], v34 offset:0
ds_read_b64_tr_b16 v[98:99], v34 offset:1024
ds_read_b64_tr_b16 v[100:101], v34 offset:2048
ds_read_b64_tr_b16 v[102:103], v34 offset:3072
ds_read_b64_tr_b16 v[104:105], v35 offset:0
ds_read_b64_tr_b16 v[106:107], v35 offset:1024
ds_read_b64_tr_b16 v[108:109], v35 offset:2048
s_waitcnt lgkmcnt(14)
ds_read_b64_tr_b16 v[110:111], v35 offset:3072
s_add_u32 s29, s97, 0
s_waitcnt lgkmcnt(14)
buffer_store_dwordx4 v[80:83], v2, s[8:11], s29 offen offset:0 sc1
s_waitcnt lgkmcnt(12)
buffer_store_dwordx4 v[84:87], v2, s[8:11], s29 offen offset:1024 sc1
s_add_u32 s29, s97, 40960
s_waitcnt lgkmcnt(10)
buffer_store_dwordx4 v[88:91], v2, s[8:11], s29 offen offset:0 sc1
s_waitcnt lgkmcnt(8)
buffer_store_dwordx4 v[92:95], v2, s[8:11], s29 offen offset:1024 sc1
s_add_u32 s29, s97, 81920
s_waitcnt lgkmcnt(6)
buffer_store_dwordx4 v[96:99], v2, s[8:11], s29 offen offset:0 sc1
s_waitcnt lgkmcnt(4)
buffer_store_dwordx4 v[100:103], v2, s[8:11], s29 offen offset:1024 sc1
s_add_u32 s29, s97, 122880
s_waitcnt lgkmcnt(2)
buffer_store_dwordx4 v[104:107], v2, s[8:11], s29 offen offset:0 sc1
s_waitcnt lgkmcnt(0)
buffer_store_dwordx4 v[108:111], v2, s[8:11], s29 offen offset:1024 sc1
buffer_load_dword v118, v5, s[60:63], 0 offen sc1
s_waitcnt vmcnt(25)
ds_read_b64_tr_b16 v[192:193], v32 offset:8192
ds_read_b64_tr_b16 v[194:195], v32 offset:9216
ds_read_b64_tr_b16 v[196:197], v32 offset:10240
ds_read_b64_tr_b16 v[198:199], v32 offset:11264
ds_read_b64_tr_b16 v[200:201], v33 offset:8192
ds_read_b64_tr_b16 v[202:203], v33 offset:9216
ds_read_b64_tr_b16 v[204:205], v33 offset:10240
ds_read_b64_tr_b16 v[206:207], v33 offset:11264
ds_read_b64_tr_b16 v[208:209], v34 offset:8192
ds_read_b64_tr_b16 v[210:211], v34 offset:9216
ds_read_b64_tr_b16 v[212:213], v34 offset:10240
ds_read_b64_tr_b16 v[214:215], v34 offset:11264
ds_read_b64_tr_b16 v[216:217], v35 offset:8192
ds_read_b64_tr_b16 v[218:219], v35 offset:9216
ds_read_b64_tr_b16 v[220:221], v35 offset:10240
s_waitcnt lgkmcnt(14)
ds_read_b64_tr_b16 v[222:223], v35 offset:11264
s_add_u32 s29, s98, 0
s_waitcnt lgkmcnt(14)
buffer_store_dwordx4 v[192:195], v2, s[8:11], s29 offen offset:0 sc1
s_waitcnt lgkmcnt(12)
buffer_store_dwordx4 v[196:199], v2, s[8:11], s29 offen offset:1024 sc1
s_add_u32 s29, s98, 40960
s_waitcnt lgkmcnt(10)
buffer_store_dwordx4 v[200:203], v2, s[8:11], s29 offen offset:0 sc1
s_waitcnt lgkmcnt(8)
buffer_store_dwordx4 v[204:207], v2, s[8:11], s29 offen offset:1024 sc1
s_add_u32 s29, s98, 81920
s_waitcnt lgkmcnt(6)
buffer_store_dwordx4 v[208:211], v2, s[8:11], s29 offen offset:0 sc1
s_waitcnt lgkmcnt(4)
buffer_store_dwordx4 v[212:215], v2, s[8:11], s29 offen offset:1024 sc1
s_add_u32 s29, s98, 122880
s_waitcnt lgkmcnt(2)
buffer_store_dwordx4 v[216:219], v2, s[8:11], s29 offen offset:0 sc1
s_waitcnt lgkmcnt(0)
buffer_store_dwordx4 v[220:223], v2, s[8:11], s29 offen offset:1024 sc1
s_waitcnt vmcnt(8)
v_readfirstlane_b32 s38, v118
s_nop 1
s_cmp_ge_u32 s38, 64
s_cbranch_scc1 L_spin_aux_sequential_preLN__linear_attn_block__swiglu_ffn__prompt_kernel_ok
s_mov_b32 s39, 0
L_spin_aux_sequential_preLN__linear_attn_block__swiglu_ffn__prompt_kernel_loop:
s_sleep 8
buffer_load_dword v118, v5, s[60:63], 0 offen sc1
s_waitcnt vmcnt(0)
v_readfirstlane_b32 s38, v118
s_add_u32 s39, s39, 1
s_cmp_ge_u32 s39, 0x40000
s_cbranch_scc1 L_spin_aux_sequential_preLN__linear_attn_block__swiglu_ffn__prompt_kernel_ok
s_cmp_lt_u32 s38, 64
s_cbranch_scc1 L_spin_aux_sequential_preLN__linear_attn_block__swiglu_ffn__prompt_kernel_loop
L_spin_aux_sequential_preLN__linear_attn_block__swiglu_ffn__prompt_kernel_ok:
s_nop 1
s_barrier
s_lshl_b32 s20, s17, 2
s_add_u32 s20, s20, 19928064
s_cmp_eq_u32 s16, 0
s_cselect_b32 s20, s20, 2130706432
s_mov_b32 s21, 69888
v_mul_lo_u32 v6, v1, s21
s_mov_b64 exec, 0xffff
buffer_store_dword v4, v6, s[8:11], s20 offen sc1
s_mov_b64 exec, -1
ds_read_b64_tr_b16 v[224:225], v28 offset:16384
ds_read_b64_tr_b16 v[226:227], v28 offset:17408
ds_read_b64_tr_b16 v[228:229], v29 offset:16384
ds_read_b64_tr_b16 v[230:231], v29 offset:17408
ds_read_b64_tr_b16 v[232:233], v30 offset:16384
ds_read_b64_tr_b16 v[234:235], v30 offset:17408
ds_read_b64_tr_b16 v[236:237], v31 offset:16384
ds_read_b64_tr_b16 v[238:239], v31 offset:17408
s_add_u32 s29, s99, 0
s_waitcnt lgkmcnt(6)
buffer_store_dwordx4 v[224:227], v2, s[8:11], s29 offen sc1
s_add_u32 s29, s99, 55296
s_waitcnt lgkmcnt(4)
buffer_store_dwordx4 v[228:231], v2, s[8:11], s29 offen sc1
s_add_u32 s29, s99, 110592
s_waitcnt lgkmcnt(2)
buffer_store_dwordx4 v[232:235], v2, s[8:11], s29 offen sc1
s_add_u32 s29, s99, 165888
s_waitcnt lgkmcnt(0)
buffer_store_dwordx4 v[236:239], v2, s[8:11], s29 offen sc1
ds_read_b64_tr_b16 v[48:49], v28 offset:20480
ds_read_b64_tr_b16 v[50:51], v28 offset:21504
ds_read_b64_tr_b16 v[52:53], v29 offset:20480
ds_read_b64_tr_b16 v[54:55], v29 offset:21504
ds_read_b64_tr_b16 v[56:57], v30 offset:20480
ds_read_b64_tr_b16 v[58:59], v30 offset:21504
ds_read_b64_tr_b16 v[60:61], v31 offset:20480
ds_read_b64_tr_b16 v[62:63], v31 offset:21504
s_add_u32 s29, s100, 0
s_waitcnt lgkmcnt(6)
buffer_store_dwordx4 v[48:51], v2, s[8:11], s29 offen sc1
s_add_u32 s29, s100, 55296
s_waitcnt lgkmcnt(4)
buffer_store_dwordx4 v[52:55], v2, s[8:11], s29 offen sc1
s_add_u32 s29, s100, 110592
s_waitcnt lgkmcnt(2)
buffer_store_dwordx4 v[56:59], v2, s[8:11], s29 offen sc1
s_add_u32 s29, s100, 165888
s_waitcnt lgkmcnt(0)
buffer_store_dwordx4 v[60:63], v2, s[8:11], s29 offen sc1
ds_read_b64_tr_b16 v[80:81], v32 offset:24576
ds_read_b64_tr_b16 v[82:83], v32 offset:25600
ds_read_b64_tr_b16 v[84:85], v32 offset:26624
ds_read_b64_tr_b16 v[86:87], v32 offset:27648
ds_read_b64_tr_b16 v[88:89], v33 offset:24576
ds_read_b64_tr_b16 v[90:91], v33 offset:25600
ds_read_b64_tr_b16 v[92:93], v33 offset:26624
ds_read_b64_tr_b16 v[94:95], v33 offset:27648
ds_read_b64_tr_b16 v[96:97], v34 offset:24576
ds_read_b64_tr_b16 v[98:99], v34 offset:25600
ds_read_b64_tr_b16 v[100:101], v34 offset:26624
ds_read_b64_tr_b16 v[102:103], v34 offset:27648
ds_read_b64_tr_b16 v[104:105], v35 offset:24576
ds_read_b64_tr_b16 v[106:107], v35 offset:25600
ds_read_b64_tr_b16 v[108:109], v35 offset:26624
s_waitcnt lgkmcnt(14)
ds_read_b64_tr_b16 v[110:111], v35 offset:27648
s_add_u32 s29, s101, 0
s_waitcnt lgkmcnt(14)
buffer_store_dwordx4 v[80:83], v2, s[8:11], s29 offen offset:0 sc1
s_waitcnt lgkmcnt(12)
buffer_store_dwordx4 v[84:87], v2, s[8:11], s29 offen offset:1024 sc1
s_add_u32 s29, s101, 40960
s_waitcnt lgkmcnt(10)
buffer_store_dwordx4 v[88:91], v2, s[8:11], s29 offen offset:0 sc1
s_waitcnt lgkmcnt(8)
buffer_store_dwordx4 v[92:95], v2, s[8:11], s29 offen offset:1024 sc1
s_add_u32 s29, s101, 81920
s_waitcnt lgkmcnt(6)
buffer_store_dwordx4 v[96:99], v2, s[8:11], s29 offen offset:0 sc1
s_waitcnt lgkmcnt(4)
buffer_store_dwordx4 v[100:103], v2, s[8:11], s29 offen offset:1024 sc1
s_add_u32 s29, s101, 122880
s_waitcnt lgkmcnt(2)
buffer_store_dwordx4 v[104:107], v2, s[8:11], s29 offen offset:0 sc1
s_waitcnt lgkmcnt(0)
buffer_store_dwordx4 v[108:111], v2, s[8:11], s29 offen offset:1024 sc1
s_branch L_fin_sequential_preLN__linear_attn_block__swiglu_ffn__prompt_kernel
L_gemm_sequential_preLN__linear_attn_block__swiglu_ffn__prompt_kernel:
s_nop 12
s_sub_u32 s20, s20, 8
s_mul_i32 s21, s20, 43
s_lshr_b32 s21, s21, 8
s_mul_i32 s22, s21, 6
s_sub_u32 s22, s20, s22
s_lshr_b32 s17, s19, 1
s_lshl_b32 s17, s17, 2
s_add_u32 s17, s17, s21
s_and_b32 s23, s19, 1
s_nop 0
s_cmp_lt_u32 s22, 2
s_cbranch_scc0 L_kv_sequential_preLN__linear_attn_block__swiglu_ffn__prompt_kernel
s_lshl_b32 s18, s23, 1
s_add_u32 s18, s18, s22
v_lshrrev_b32 v96, 3, v1
v_and_b32 v97, 7, v1
v_lshrrev_b32 v98, 4, v1
s_movk_i32 s20, 1280
v_add_u32 v99, 0, v96
v_mul_lo_u32 v99, v99, s20
v_add_u32 v100, 0, v98
v_and_b32 v100, 7, v100
v_xor_b32 v100, v100, v97
v_lshl_add_u32 v99, v100, 4, v99
v_subrev_u32 v4, 0, v99
v_add_u32 v99, 8, v96
v_mul_lo_u32 v99, v99, s20
v_add_u32 v100, 4, v98
v_and_b32 v100, 7, v100
v_xor_b32 v100, v100, v97
v_lshl_add_u32 v99, v100, 4, v99
v_subrev_u32 v5, 1024, v99
v_add_u32 v99, 16, v96
v_mul_lo_u32 v99, v99, s20
v_add_u32 v100, 8, v98
v_and_b32 v100, 7, v100
v_xor_b32 v100, v100, v97
v_lshl_add_u32 v99, v100, 4, v99
v_subrev_u32 v6, 2048, v99
v_add_u32 v99, 24, v96
v_mul_lo_u32 v99, v99, s20
v_add_u32 v100, 12, v98
v_and_b32 v100, 7, v100
v_xor_b32 v100, v100, v97
v_lshl_add_u32 v99, v100, 4, v99
v_subrev_u32 v7, 3072, v99
s_mov_b32 s20, 52429
s_movk_i32 s21, 3840
v_add_u32 v99, 0, v1
v_mul_lo_u32 v100, v99, s20
v_lshrrev_b32 v100, 20, v100
v_mul_u32_u24 v101, 20, v100
v_sub_u32 v99, v99, v101
v_mul_lo_u32 v100, v100, s21
v_lshl_add_u32 v100, v99, 4, v100
v_cmp_le_u32 vcc, 10, v99
v_mov_b32 v101, 0
s_nop 0
v_cndmask_b32 v101, 0, v101, vcc
v_add_u32 v100, v100, v101
v_subrev_u32 v8, 0, v100
v_add_u32 v99, 64, v1
v_mul_lo_u32 v100, v99, s20
v_lshrrev_b32 v100, 20, v100
v_mul_u32_u24 v101, 20, v100
v_sub_u32 v99, v99, v101
v_mul_lo_u32 v100, v100, s21
v_lshl_add_u32 v100, v99, 4, v100
v_cmp_le_u32 vcc, 10, v99
v_mov_b32 v101, 0
s_nop 0
v_cndmask_b32 v101, 0, v101, vcc
v_add_u32 v100, v100, v101
v_subrev_u32 v9, 1024, v100
v_add_u32 v99, 128, v1
v_mul_lo_u32 v100, v99, s20
v_lshrrev_b32 v100, 20, v100
v_mul_u32_u24 v101, 20, v100
v_sub_u32 v99, v99, v101
v_mul_lo_u32 v100, v100, s21
v_lshl_add_u32 v100, v99, 4, v100
v_cmp_le_u32 vcc, 10, v99
v_mov_b32 v101, 0
s_nop 0
v_cndmask_b32 v101, 0, v101, vcc
v_add_u32 v100, v100, v101
v_subrev_u32 v10, 2048, v100
v_add_u32 v99, 192, v1
v_mul_lo_u32 v100, v99, s20
v_lshrrev_b32 v100, 20, v100
v_mul_u32_u24 v101, 20, v100
v_sub_u32 v99, v99, v101
v_mul_lo_u32 v100, v100, s21
v_lshl_add_u32 v100, v99, 4, v100
v_cmp_le_u32 vcc, 10, v99
v_mov_b32 v101, 0
s_nop 0
v_cndmask_b32 v101, 0, v101, vcc
v_add_u32 v100, v100, v101
v_subrev_u32 v11, 3072, v100
v_add_u32 v99, 256, v1
v_mul_lo_u32 v100, v99, s20
v_lshrrev_b32 v100, 20, v100
v_mul_u32_u24 v101, 20, v100
v_sub_u32 v99, v99, v101
v_mul_lo_u32 v100, v100, s21
v_lshl_add_u32 v100, v99, 4, v100
v_cmp_le_u32 vcc, 10, v99
v_mov_b32 v101, 0
s_nop 0
v_cndmask_b32 v101, 0, v101, vcc
v_add_u32 v100, v100, v101
v_subrev_u32 v12, 0, v100
s_waitcnt lgkmcnt(0)
s_mov_b32 s12, s4
s_and_b32 s13, s5, 0xffff
s_mov_b32 s56, s6
s_and_b32 s57, s7, 0xffff
s_mov_b32 s60, s24
s_and_b32 s61, s25, 0xffff
s_mov_b32 s8, s26
s_and_b32 s9, s27, 0xffff
s_lshl_b32 s26, s17, 2
s_add_u32 s26, s26, s16
s_mul_i32 s26, s26, 40960
s_mul_i32 s27, s16, 61440
s_mul_i32 s20, s18, 320
s_add_u32 s27, s27, s20
s_mul_i32 s30, s16, 5120
s_lshl_b32 s31, s16, 12
s_add_u32 s31, s31, 20480
s_mov_b32 s33, 0
s_mov_b32 s29, 0
s_mov_b32 s28, 0x7f000000
s_add_u32 s34, s30, s33
s_mov_b32 m0, s34
s_add_u32 s34, s34, 4096
buffer_load_dwordx4 v8, s[56:59], s27 offen offset:0 lds
buffer_load_dwordx4 v9, s[56:59], s27 offen offset:1024 lds
buffer_load_dwordx4 v10, s[56:59], s27 offen offset:2048 lds
buffer_load_dwordx4 v11, s[56:59], s27 offen offset:3072 lds
s_mov_b32 m0, s34
s_add_u32 s34, s31, s33
buffer_load_dwordx4 v12, s[56:59], s27 offen lds
s_mov_b32 m0, s34
s_add_u32 s27, s27, 245760
buffer_load_dwordx4 v4, s[12:15], s26 offen offset:0 lds
buffer_load_dwordx4 v5, s[12:15], s26 offen offset:1024 lds
buffer_load_dwordx4 v6, s[12:15], s26 offen offset:2048 lds
buffer_load_dwordx4 v7, s[12:15], s26 offen offset:3072 lds
s_cmp_eq_u32 s29, 7
s_cselect_b32 s35, s28, 128
s_add_u32 s26, s26, s35
s_add_u32 s33, s33, 36864
s_cmp_eq_u32 s33, 147456
s_cselect_b32 s33, 0, s33
s_add_u32 s34, s30, s33
s_mov_b32 m0, s34
s_add_u32 s34, s34, 4096
buffer_load_dwordx4 v8, s[56:59], s27 offen offset:0 lds
buffer_load_dwordx4 v9, s[56:59], s27 offen offset:1024 lds
buffer_load_dwordx4 v10, s[56:59], s27 offen offset:2048 lds
buffer_load_dwordx4 v11, s[56:59], s27 offen offset:3072 lds
s_mov_b32 m0, s34
s_add_u32 s34, s31, s33
buffer_load_dwordx4 v12, s[56:59], s27 offen lds
s_mov_b32 m0, s34
s_add_u32 s27, s27, 245760
buffer_load_dwordx4 v4, s[12:15], s26 offen offset:0 lds
buffer_load_dwordx4 v5, s[12:15], s26 offen offset:1024 lds
buffer_load_dwordx4 v6, s[12:15], s26 offen offset:2048 lds
buffer_load_dwordx4 v7, s[12:15], s26 offen offset:3072 lds
s_cmp_eq_u32 s29, 7
s_cselect_b32 s35, s28, 128
s_add_u32 s26, s26, s35
s_add_u32 s33, s33, 36864
s_cmp_eq_u32 s33, 147456
s_cselect_b32 s33, 0, s33
v_and_b32 v96, 31, v1
v_lshrrev_b32 v97, 5, v1
v_bfe_u32 v103, v1, 1, 3
v_lshlrev_b32 v102, 7, v96
s_lshl_b32 s20, s16, 12
v_add_u32 v102, s20, v102
v_add_u32 v104, 0, v97
v_xor_b32 v104, v104, v103
v_lshl_add_u32 v98, v104, 4, v102
v_add_u32 v104, 2, v97
v_xor_b32 v104, v104, v103
v_lshl_add_u32 v99, v104, 4, v102
v_add_u32 v104, 4, v97
v_xor_b32 v104, v104, v103
v_lshl_add_u32 v100, v104, 4, v102
v_add_u32 v104, 6, v97
v_xor_b32 v104, v104, v103
v_lshl_add_u32 v101, v104, 4, v102
v_bfe_u32 v103, v1, 2, 2
v_lshl_add_u32 v103, v97, 3, v103
v_mul_u32_u24 v103, 320, v103
v_bfe_u32 v104, v1, 4, 1
v_lshl_add_u32 v103, v104, 5, v103
v_and_b32 v104, 3, v1
v_lshl_add_u32 v102, v104, 3, v103
v_mov_b32 v114, 0
v_mov_b32 v104, v98
v_mov_b32 v105, v99
v_mov_b32 v106, v100
v_mov_b32 v107, v101
v_mov_b32 v112, v102
v_mov_b32 v16, 0
v_mov_b32 v17, 0
v_mov_b32 v18, 0
v_mov_b32 v19, 0
v_mov_b32 v20, 0
v_mov_b32 v21, 0
v_mov_b32 v22, 0
v_mov_b32 v23, 0
v_mov_b32 v24, 0
v_mov_b32 v25, 0
v_mov_b32 v26, 0
v_mov_b32 v27, 0
v_mov_b32 v28, 0
v_mov_b32 v29, 0
v_mov_b32 v30, 0
v_mov_b32 v31, 0
v_mov_b32 v32, 0
v_mov_b32 v33, 0
v_mov_b32 v34, 0
v_mov_b32 v35, 0
v_mov_b32 v36, 0
v_mov_b32 v37, 0
v_mov_b32 v38, 0
v_mov_b32 v39, 0
v_mov_b32 v40, 0
v_mov_b32 v41, 0
v_mov_b32 v42, 0
v_mov_b32 v43, 0
v_mov_b32 v44, 0
v_mov_b32 v45, 0
v_mov_b32 v46, 0
v_mov_b32 v47, 0
v_mov_b32 v48, 0
v_mov_b32 v49, 0
v_mov_b32 v50, 0
v_mov_b32 v51, 0
v_mov_b32 v52, 0
v_mov_b32 v53, 0
v_mov_b32 v54, 0
v_mov_b32 v55, 0
v_mov_b32 v56, 0
v_mov_b32 v57, 0
v_mov_b32 v58, 0
v_mov_b32 v59, 0
v_mov_b32 v60, 0
v_mov_b32 v61, 0
v_mov_b32 v62, 0
v_mov_b32 v63, 0
v_mov_b32 v64, 0
v_mov_b32 v65, 0
v_mov_b32 v66, 0
v_mov_b32 v67, 0
v_mov_b32 v68, 0
v_mov_b32 v69, 0
v_mov_b32 v70, 0
v_mov_b32 v71, 0
v_mov_b32 v72, 0
v_mov_b32 v73, 0
v_mov_b32 v74, 0
v_mov_b32 v75, 0
v_mov_b32 v76, 0
v_mov_b32 v77, 0
v_mov_b32 v78, 0
v_mov_b32 v79, 0
v_mov_b32 v80, 0
v_mov_b32 v81, 0
v_mov_b32 v82, 0
v_mov_b32 v83, 0
v_mov_b32 v84, 0
v_mov_b32 v85, 0
v_mov_b32 v86, 0
v_mov_b32 v87, 0
v_mov_b32 v88, 0
v_mov_b32 v89, 0
v_mov_b32 v90, 0
v_mov_b32 v91, 0
v_mov_b32 v92, 0
v_mov_b32 v93, 0
v_mov_b32 v94, 0
v_mov_b32 v95, 0
v_mov_b32 v190, 0
v_mov_b32 v191, 0
s_lshl_b32 s36, s17, 2
s_add_u32 s36, s36, s16
s_lshl_b32 s36, s36, 7
s_add_u32 s36, s36, 21045248
s_add_u32 s43, s36, 8192
v_lshlrev_b32 v115, 2, v96
v_lshlrev_b32 v116, 26, v97
v_lshl_add_u32 v116, v116, 4, v115
v_lshlrev_b32 v119, 4, v97
s_mov_b32 s42, 0x3fb8aa3b
s_mul_i32 s37, s18, 640
s_add_u32 s37, s37, 21061632
s_add_u32 s34, s30, s33
s_mov_b32 m0, s34
s_add_u32 s34, s34, 4096
buffer_load_dwordx4 v8, s[56:59], s27 offen offset:0 lds
buffer_load_dwordx4 v9, s[56:59], s27 offen offset:1024 lds
buffer_load_dwordx4 v10, s[56:59], s27 offen offset:2048 lds
buffer_load_dwordx4 v11, s[56:59], s27 offen offset:3072 lds
s_waitcnt vmcnt(13)
s_barrier
s_mov_b32 s29, 0
s_mov_b32 s32, 0
ds_read_b128 a[0:3], v104 offset:20480
ds_read_b64_tr_b16 a[8:9], v112 offset:0
ds_read_b64_tr_b16 a[10:11], v112 offset:1280
ds_read_b64_tr_b16 a[12:13], v112 offset:64
ds_read_b64_tr_b16 a[14:15], v112 offset:1344
ds_read_b64_tr_b16 a[16:17], v112 offset:128
ds_read_b64_tr_b16 a[18:19], v112 offset:1408
ds_read_b64_tr_b16 a[20:21], v112 offset:192
ds_read_b64_tr_b16 a[22:23], v112 offset:1472
ds_read_b64_tr_b16 a[24:25], v112 offset:256
ds_read_b64_tr_b16 a[26:27], v112 offset:1536
L_lp_q_sequential_preLN__linear_attn_block__swiglu_ffn__prompt_kernel:
s_cmp_eq_u32 s29, 2
s_cbranch_scc1 L_lp_q_sequential_preLN__linear_attn_block__swiglu_ffn__prompt_kernel_x2
s_cmp_eq_u32 s29, 3
s_cbranch_scc1 L_lp_q_sequential_preLN__linear_attn_block__swiglu_ffn__prompt_kernel_x3
s_cmp_eq_u32 s29, 6
s_cbranch_scc1 L_lp_q_sequential_preLN__linear_attn_block__swiglu_ffn__prompt_kernel_x6
s_cmp_eq_u32 s29, 7
s_cbranch_scc1 L_lp_q_sequential_preLN__linear_attn_block__swiglu_ffn__prompt_kernel_x7
s_cmp_eq_u32 s29, 9
s_cbranch_scc1 L_lp_q_sequential_preLN__linear_attn_block__swiglu_ffn__prompt_kernel_x9
L_lp_q_sequential_preLN__linear_attn_block__swiglu_ffn__prompt_kernel_r:
s_add_u32 s32, s32, 36864
s_cmp_eq_u32 s32, 147456
s_cselect_b32 s32, 0, s32
v_add_u32 v108, s32, v98
v_add_u32 v113, s32, v102
s_waitcnt lgkmcnt(8)
v_mfma_f32_32x32x16_bf16 v[16:31], a[8:11], a[0:3], v[16:31]
ds_read_b128 a[4:7], v105 offset:20480
ds_read_b64_tr_b16 a[28:29], v112 offset:5120
s_mov_b32 m0, s34
s_waitcnt lgkmcnt(8)
v_mfma_f32_32x32x16_bf16 v[32:47], a[12:15], a[0:3], v[32:47]
ds_read_b64_tr_b16 a[30:31], v112 offset:6400
ds_read_b64_tr_b16 a[32:33], v112 offset:5184
s_add_u32 s34, s31, s33
ds_read_b64_tr_b16 a[34:35], v112 offset:6464
s_waitcnt lgkmcnt(9)
v_mfma_f32_32x32x16_bf16 v[48:63], a[16:19], a[0:3], v[48:63]
buffer_load_dwordx4 v12, s[56:59], s27 offen lds
ds_read_b64_tr_b16 a[36:37], v112 offset:5248
ds_read_b64_tr_b16 a[38:39], v112 offset:6528
s_waitcnt lgkmcnt(9)
v_mfma_f32_32x32x16_bf16 v[64:79], a[20:23], a[0:3], v[64:79]
s_mov_b32 m0, s34
ds_read_b64_tr_b16 a[40:41], v112 offset:5312
s_add_u32 s27, s27, 245760
ds_read_b64_tr_b16 a[42:43], v112 offset:6592
s_waitcnt lgkmcnt(9)
v_mfma_f32_32x32x16_bf16 v[80:95], a[24:27], a[0:3], v[80:95]
ds_read_b64_tr_b16 a[44:45], v112 offset:5376
buffer_load_dwordx4 v4, s[12:15], s26 offen offset:0 lds
ds_read_b64_tr_b16 a[46:47], v112 offset:6656
buffer_load_dwordx4 v5, s[12:15], s26 offen offset:1024 lds
s_waitcnt lgkmcnt(8)
v_mfma_f32_32x32x16_bf16 v[16:31], a[28:31], a[4:7], v[16:31]
ds_read_b128 a[0:3], v106 offset:20480
ds_read_b64_tr_b16 a[8:9], v112 offset:10240
buffer_load_dwordx4 v6, s[12:15], s26 offen offset:2048 lds
s_waitcnt lgkmcnt(8)
v_mfma_f32_32x32x16_bf16 v[32:47], a[32:35], a[4:7], v[32:47]
ds_read_b64_tr_b16 a[10:11], v112 offset:11520
buffer_load_dwordx4 v7, s[12:15], s26 offen offset:3072 lds
ds_read_b64_tr_b16 a[12:13], v112 offset:10304
ds_read_b64_tr_b16 a[14:15], v112 offset:11584
s_waitcnt lgkmcnt(9)
v_mfma_f32_32x32x16_bf16 v[48:63], a[36:39], a[4:7], v[48:63]
s_cmp_eq_u32 s29, 7
ds_read_b64_tr_b16 a[16:17], v112 offset:10368
s_cselect_b32 s35, s28, 128
ds_read_b64_tr_b16 a[18:19], v112 offset:11648
s_waitcnt lgkmcnt(9)
v_mfma_f32_32x32x16_bf16 v[64:79], a[40:43], a[4:7], v[64:79]
s_add_u32 s26, s26, s35
ds_read_b64_tr_b16 a[20:21], v112 offset:10432
ds_read_b64_tr_b16 a[22:23], v112 offset:11712
s_add_u32 s33, s33, 36864
s_waitcnt lgkmcnt(9)
v_mfma_f32_32x32x16_bf16 v[80:95], a[44:47], a[4:7], v[80:95]
ds_read_b64_tr_b16 a[24:25], v112 offset:10496
s_cmp_eq_u32 s33, 147456
ds_read_b64_tr_b16 a[26:27], v112 offset:11776
s_cselect_b32 s33, 0, s33
s_waitcnt lgkmcnt(8)
v_mfma_f32_32x32x16_bf16 v[16:31], a[8:11], a[0:3], v[16:31]
ds_read_b128 a[4:7], v107 offset:20480
ds_read_b64_tr_b16 a[28:29], v112 offset:15360
s_waitcnt lgkmcnt(8)
v_mfma_f32_32x32x16_bf16 v[32:47], a[12:15], a[0:3], v[32:47]
ds_read_b64_tr_b16 a[30:31], v112 offset:16640
ds_read_b64_tr_b16 a[32:33], v112 offset:15424
s_waitcnt lgkmcnt(8)
v_mfma_f32_32x32x16_bf16 v[48:63], a[16:19], a[0:3], v[48:63]
ds_read_b64_tr_b16 a[34:35], v112 offset:16704
ds_read_b64_tr_b16 a[36:37], v112 offset:15488
s_waitcnt lgkmcnt(8)
v_mfma_f32_32x32x16_bf16 v[64:79], a[20:23], a[0:3], v[64:79]
ds_read_b64_tr_b16 a[38:39], v112 offset:16768
ds_read_b64_tr_b16 a[40:41], v112 offset:15552
s_waitcnt lgkmcnt(8)
v_mfma_f32_32x32x16_bf16 v[80:95], a[24:27], a[0:3], v[80:95]
ds_read_b64_tr_b16 a[42:43], v112 offset:16832
ds_read_b64_tr_b16 a[44:45], v112 offset:15616
ds_read_b64_tr_b16 a[46:47], v112 offset:16896
s_waitcnt vmcnt(9)
s_barrier
s_waitcnt lgkmcnt(8)
v_mfma_f32_32x32x16_bf16 v[16:31], a[28:31], a[4:7], v[16:31]
ds_read_b128 a[0:3], v108 offset:20480
ds_read_b64_tr_b16 a[8:9], v113 offset:0
s_add_u32 s34, s30, s33
ds_read_b64_tr_b16 a[10:11], v113 offset:1280
s_waitcnt lgkmcnt(9)
v_mfma_f32_32x32x16_bf16 v[32:47], a[32:35], a[4:7], v[32:47]
ds_read_b64_tr_b16 a[12:13], v113 offset:64
s_mov_b32 m0, s34
ds_read_b64_tr_b16 a[14:15], v113 offset:1344
s_add_u32 s34, s34, 4096
ds_read_b64_tr_b16 a[16:17], v113 offset:128
s_waitcnt lgkmcnt(10)
v_mfma_f32_32x32x16_bf16 v[48:63], a[36:39], a[4:7], v[48:63]
ds_read_b64_tr_b16 a[18:19], v113 offset:1408
buffer_load_dwordx4 v8, s[56:59], s27 offen offset:0 lds
ds_read_b64_tr_b16 a[20:21], v113 offset:192
buffer_load_dwordx4 v9, s[56:59], s27 offen offset:1024 lds
s_waitcnt lgkmcnt(10)
v_mfma_f32_32x32x16_bf16 v[64:79], a[40:43], a[4:7], v[64:79]
ds_read_b64_tr_b16 a[22:23], v113 offset:1472
ds_read_b64_tr_b16 a[24:25], v113 offset:256
buffer_load_dwordx4 v10, s[56:59], s27 offen offset:2048 lds
ds_read_b64_tr_b16 a[26:27], v113 offset:1536
buffer_load_dwordx4 v11, s[56:59], s27 offen offset:3072 lds
s_waitcnt lgkmcnt(11)
v_mfma_f32_32x32x16_bf16 v[80:95], a[44:47], a[4:7], v[80:95]
v_add_u32 v104, s32, v98
v_add_u32 v105, s32, v99
v_add_u32 v106, s32, v100
v_add_u32 v107, s32, v101
v_mov_b32 v112, v113
s_add_u32 s29, s29, 1
s_cmp_lt_u32 s29, 10
s_cbranch_scc1 L_lp_q_sequential_preLN__linear_attn_block__swiglu_ffn__prompt_kernel
s_branch L_lp_q_sequential_preLN__linear_attn_block__swiglu_ffn__prompt_kernel_done
L_lp_q_sequential_preLN__linear_attn_block__swiglu_ffn__prompt_kernel_x2:
v_bfe_u32 v190, v1, 4, 1
v_lshlrev_b32 v190, 10, v190
v_lshl_add_u32 v190, v97, 8, v190
v_and_b32 v191, 15, v1
v_lshl_add_u32 v190, v191, 4, v190
s_lshl_b32 s48, s17, 1
s_lshr_b32 s49, s16, 1
s_add_u32 s48, s48, s49
s_nop 1
s_branch L_lp_q_sequential_preLN__linear_attn_block__swiglu_ffn__prompt_kernel_r
L_lp_q_sequential_preLN__linear_attn_block__swiglu_ffn__prompt_kernel_x3:
s_mul_i32 s48, s48, 20
s_mul_i32 s49, s18, 5
s_add_u32 s48, s48, s49
s_lshl_b32 s48, s48, 2
s_and_b32 s49, s16, 1
s_lshl_b32 s49, s49, 1
s_add_u32 s48, s48, s49
s_lshl_b32 s48, s48, 10
s_add_u32 s48, s48, 0
s_nop 1
s_branch L_lp_q_sequential_preLN__linear_attn_block__swiglu_ffn__prompt_kernel_r
L_lp_q_sequential_preLN__linear_attn_block__swiglu_ffn__prompt_kernel_x6:
buffer_load_dword v118, v114, s[60:63], 0 offen sc1
s_branch L_lp_q_sequential_preLN__linear_attn_block__swiglu_ffn__prompt_kernel_r
L_lp_q_sequential_preLN__linear_attn_block__swiglu_ffn__prompt_kernel_x7:
s_waitcnt vmcnt(9)
v_readfirstlane_b32 s38, v118
s_nop 1
s_cmp_ge_u32 s38, 64
s_cbranch_scc1 L_spin_q_sequential_preLN__linear_attn_block__swiglu_ffn__prompt_kernel_ok
s_mov_b32 s39, 0
L_spin_q_sequential_preLN__linear_attn_block__swiglu_ffn__prompt_kernel_loop:
s_sleep 8
buffer_load_dword v118, v114, s[60:63], 0 offen sc1
s_waitcnt vmcnt(0)
v_readfirstlane_b32 s38, v118
s_add_u32 s39, s39, 1
s_cmp_ge_u32 s39, 0x40000
s_cbranch_scc1 L_spin_q_sequential_preLN__linear_attn_block__swiglu_ffn__prompt_kernel_ok
s_cmp_lt_u32 s38, 64
s_cbranch_scc1 L_spin_q_sequential_preLN__linear_attn_block__swiglu_ffn__prompt_kernel_loop
L_spin_q_sequential_preLN__linear_attn_block__swiglu_ffn__prompt_kernel_ok:
s_nop 1
buffer_load_dword v157, v115, s[8:11], s43 offen sc1
buffer_load_dword v152, v116, s[8:11], s37 offen offset:0 sc1
buffer_load_dword v153, v116, s[8:11], s37 offen offset:128 sc1
buffer_load_dword v154, v116, s[8:11], s37 offen offset:256 sc1
buffer_load_dword v155, v116, s[8:11], s37 offen offset:384 sc1
buffer_load_dword v156, v116, s[8:11], s37 offen offset:512 sc1
buffer_load_dword v120, v115, s[8:11], s36 offen sc1
s_branch L_lp_q_sequential_preLN__linear_attn_block__swiglu_ffn__prompt_kernel_r
L_lp_q_sequential_preLN__linear_attn_block__swiglu_ffn__prompt_kernel_x9:
s_waitcnt vmcnt(13)
v_cvt_pk_bf16_f32 v160, v152, v152
v_lshlrev_b32 v161, 16, v160
v_sub_f32 v161, v152, v161
v_cvt_pk_bf16_f32 v161, v161, 0
v_mov_b32 v162, 0
v_mov_b32 v163, 0
v_cvt_pk_bf16_f32 v164, v153, v153
v_lshlrev_b32 v165, 16, v164
v_sub_f32 v165, v153, v165
v_cvt_pk_bf16_f32 v165, v165, 0
v_mov_b32 v166, 0
v_mov_b32 v167, 0
v_cvt_pk_bf16_f32 v168, v154, v154
v_lshlrev_b32 v169, 16, v168
v_sub_f32 v169, v154, v169
v_cvt_pk_bf16_f32 v169, v169, 0
v_mov_b32 v170, 0
v_mov_b32 v171, 0
v_cvt_pk_bf16_f32 v172, v155, v155
v_lshlrev_b32 v173, 16, v172
v_sub_f32 v173, v155, v173
v_cvt_pk_bf16_f32 v173, v173, 0
v_mov_b32 v174, 0
v_mov_b32 v175, 0
v_cvt_pk_bf16_f32 v176, v156, v156
v_lshlrev_b32 v177, 16, v176
v_sub_f32 v177, v156, v177
v_cvt_pk_bf16_f32 v177, v177, 0
v_mov_b32 v178, 0
v_mov_b32 v179, 0
v_sub_f32 v157, 0, v157
v_cvt_pk_bf16_f32 v181, v157, 0
v_lshlrev_b32 v180, 16, v181
v_sub_f32 v180, v157, v180
v_cvt_pk_bf16_f32 v180, v157, v180
v_mov_b32 v182, 0
v_mov_b32 v183, 0
s_nop 1
s_branch L_lp_q_sequential_preLN__linear_attn_block__swiglu_ffn__prompt_kernel_r
L_lp_q_sequential_preLN__linear_attn_block__swiglu_ffn__prompt_kernel_done:
s_waitcnt vmcnt(0)
s_waitcnt lgkmcnt(0)
L_epi_q_sequential_preLN__linear_attn_block__swiglu_ffn__prompt_kernel:
v_mov_b32 v184, 1.0
v_mov_b32 v185, 1.0
v_mov_b32 v186, s42
v_mov_b32 v187, s42
v_mov_b32 v188, 0x358637bd
v_mov_b32 v189, 0x358637bd
s_load_dwordx2 s[64:65], s[0:1], 16
s_load_dwordx2 s[66:67], s[0:1], 48
s_lshl_b32 s20, s17, 2
s_add_u32 s20, s20, s18
s_lshl_b32 s20, s20, 2
s_add_u32 s20, s20, s16
s_add_u32 s20, s20, 284
s_cmp_lt_u32 s20, 0
s_cselect_b32 s52, 20, 54
s_cselect_b32 s53, 8, 16
s_cselect_b32 s54, 16, 8
s_mov_b32 s21, 17584128
s_cselect_b32 s55, 12320768, s21
s_mov_b32 s21, 2211840
s_cselect_b32 s70, 819200, s21
s_mov_b32 s71, 0x20000
s_waitcnt lgkmcnt(0)
s_cselect_b32 s68, s64, s66
s_cselect_b32 s69, s65, s67
s_and_b32 s69, s69, 0xffff
s_mul_hi_u32 s22, s20, 429496730
s_mul_i32 s21, s22, 10
s_sub_u32 s21, s20, s21
s_mul_i32 s23, s22, 40960
s_lshl_b32 s24, s21, 7
s_add_u32 s23, s23, s24
s_mul_i32 s21, s21, s52
s_lshl_b32 s21, s21, 2
s_add_u32 s21, s21, s22
s_lshl_b32 s21, s21, 10
s_add_u32 s55, s55, s21
s_lshl_b32 s52, s52, 10
s_lshl_b32 s54, s54, 7
s_lshl_b32 s24, s16, 12
s_add_u32 s24, s24, 147456
s_mov_b32 m0, s24
v_lshrrev_b32 v4, 3, v1
v_and_b32 v5, 7, v1
v_bfe_u32 v6, v1, 4, 2
v_lshlrev_b32 v7, 1, v6
v_xor_b32 v5, v5, v7
v_mul_u32_u24 v4, 1280, v4
v_lshl_add_u32 v4, v5, 4, v4
buffer_load_dwordx4 v4, s[68:71], s23 offen offset:0 lds
s_add_u32 s23, s23, 9216
buffer_load_dwordx4 v4, s[68:71], s23 offen offset:1024 lds
s_add_u32 s23, s23, 9216
buffer_load_dwordx4 v4, s[68:71], s23 offen offset:2048 lds
s_add_u32 s23, s23, 9216
buffer_load_dwordx4 v4, s[68:71], s23 offen offset:3072 lds
s_add_u32 s23, s23, 9216
v_lshrrev_b32 v5, 1, v6
v_mul_lo_u32 v5, v5, s53
v_and_b32 v7, 1, v6
v_lshl_add_u32 v5, v7, 2, v5
v_bfe_u32 v7, v1, 2, 2
v_add_u32 v5, v5, v7
v_bfe_u32 v7, v5, 1, 2
v_and_b32 v8, 3, v1
v_lshlrev_b32 v8, 3, v8
v_lshl_add_u32 v5, v5, 7, v8
v_add_u32 v5, s24, v5
v_lshlrev_b32 v13, 4, v1
v_xor_b32 v8, 0, v7
v_lshl_add_u32 v104, v8, 5, v5
v_add_u32 v108, s54, v104
v_xor_b32 v8, 1, v7
v_lshl_add_u32 v105, v8, 5, v5
v_add_u32 v109, s54, v105
v_xor_b32 v8, 2, v7
v_lshl_add_u32 v106, v8, 5, v5
v_add_u32 v110, s54, v106
v_xor_b32 v8, 3, v7
v_lshl_add_u32 v107, v8, 5, v5
v_add_u32 v111, s54, v107
v_mov_b32 v122, v120
v_mov_b32 v123, v120
v_mfma_f32_32x32x16_bf16 v[16:31], v[160:163], v[180:183], v[16:31]
v_mfma_f32_32x32x16_bf16 v[32:47], v[164:167], v[180:183], v[32:47]
v_mfma_f32_32x32x16_bf16 v[48:63], v[168:171], v[180:183], v[48:63]
v_mfma_f32_32x32x16_bf16 v[64:79], v[172:175], v[180:183], v[64:79]
v_mfma_f32_32x32x16_bf16 v[80:95], v[176:179], v[180:183], v[80:95]
s_nop 7
v_pk_fma_f32 v[16:17], v[16:17], v[122:123], v[184:185]
v_pk_fma_f32 v[18:19], v[18:19], v[122:123], v[184:185]
v_pk_fma_f32 v[20:21], v[20:21], v[122:123], v[184:185]
v_pk_fma_f32 v[22:23], v[22:23], v[122:123], v[184:185]
v_pk_fma_f32 v[208:209], v[16:17], v[186:187], v[186:187] neg_lo:[0,0,1] neg_hi:[0,0,1]
v_pk_fma_f32 v[210:211], v[18:19], v[186:187], v[186:187] neg_lo:[0,0,1] neg_hi:[0,0,1]
v_pk_fma_f32 v[212:213], v[20:21], v[186:187], v[186:187] neg_lo:[0,0,1] neg_hi:[0,0,1]
v_pk_fma_f32 v[214:215], v[22:23], v[186:187], v[186:187] neg_lo:[0,0,1] neg_hi:[0,0,1]
v_exp_f32 v208, v208
v_exp_f32 v209, v209
v_exp_f32 v210, v210
v_exp_f32 v211, v211
v_exp_f32 v212, v212
v_exp_f32 v213, v213
v_exp_f32 v214, v214
v_exp_f32 v215, v215
v_med3_f32 v16, v208, v16, 1.0
v_med3_f32 v17, v209, v17, 1.0
v_med3_f32 v18, v210, v18, 1.0
v_med3_f32 v19, v211, v19, 1.0
v_med3_f32 v20, v212, v20, 1.0
v_med3_f32 v21, v213, v21, 1.0
v_med3_f32 v22, v214, v22, 1.0
v_med3_f32 v23, v215, v23, 1.0
v_pk_add_f32 v[16:17], v[16:17], v[188:189]
v_pk_add_f32 v[18:19], v[18:19], v[188:189]
v_pk_add_f32 v[20:21], v[20:21], v[188:189]
v_pk_add_f32 v[22:23], v[22:23], v[188:189]
v_pk_fma_f32 v[24:25], v[24:25], v[122:123], v[184:185]
v_pk_fma_f32 v[26:27], v[26:27], v[122:123], v[184:185]
v_pk_fma_f32 v[28:29], v[28:29], v[122:123], v[184:185]
v_pk_fma_f32 v[30:31], v[30:31], v[122:123], v[184:185]
v_pk_fma_f32 v[208:209], v[24:25], v[186:187], v[186:187] neg_lo:[0,0,1] neg_hi:[0,0,1]
v_pk_fma_f32 v[210:211], v[26:27], v[186:187], v[186:187] neg_lo:[0,0,1] neg_hi:[0,0,1]
v_pk_fma_f32 v[212:213], v[28:29], v[186:187], v[186:187] neg_lo:[0,0,1] neg_hi:[0,0,1]
v_pk_fma_f32 v[214:215], v[30:31], v[186:187], v[186:187] neg_lo:[0,0,1] neg_hi:[0,0,1]
v_exp_f32 v208, v208
v_exp_f32 v209, v209
v_exp_f32 v210, v210
v_exp_f32 v211, v211
v_exp_f32 v212, v212
v_exp_f32 v213, v213
v_exp_f32 v214, v214
v_exp_f32 v215, v215
v_med3_f32 v24, v208, v24, 1.0
v_med3_f32 v25, v209, v25, 1.0
v_med3_f32 v26, v210, v26, 1.0
v_med3_f32 v27, v211, v27, 1.0
v_med3_f32 v28, v212, v28, 1.0
v_med3_f32 v29, v213, v29, 1.0
v_med3_f32 v30, v214, v30, 1.0
v_med3_f32 v31, v215, v31, 1.0
v_pk_add_f32 v[24:25], v[24:25], v[188:189]
v_pk_add_f32 v[26:27], v[26:27], v[188:189]
v_pk_add_f32 v[28:29], v[28:29], v[188:189]
v_pk_add_f32 v[30:31], v[30:31], v[188:189]
v_cvt_pk_bf16_f32 v224, v16, v17
v_cvt_pk_bf16_f32 v225, v18, v19
v_cvt_pk_bf16_f32 v228, v20, v21
v_cvt_pk_bf16_f32 v229, v22, v23
v_cvt_pk_bf16_f32 v226, v24, v25
v_cvt_pk_bf16_f32 v227, v26, v27
v_cvt_pk_bf16_f32 v230, v28, v29
v_cvt_pk_bf16_f32 v231, v30, v31
s_add_u32 s51, s48, 0
buffer_store_dwordx4 v[224:227], v190, s[8:11], s51 offen sc1
buffer_store_dwordx4 v[228:231], v190, s[8:11], s51 offen offset:512 sc1
v_pk_fma_f32 v[32:33], v[32:33], v[122:123], v[184:185]
v_pk_fma_f32 v[34:35], v[34:35], v[122:123], v[184:185]
v_pk_fma_f32 v[36:37], v[36:37], v[122:123], v[184:185]
v_pk_fma_f32 v[38:39], v[38:39], v[122:123], v[184:185]
v_pk_fma_f32 v[208:209], v[32:33], v[186:187], v[186:187] neg_lo:[0,0,1] neg_hi:[0,0,1]
v_pk_fma_f32 v[210:211], v[34:35], v[186:187], v[186:187] neg_lo:[0,0,1] neg_hi:[0,0,1]
v_pk_fma_f32 v[212:213], v[36:37], v[186:187], v[186:187] neg_lo:[0,0,1] neg_hi:[0,0,1]
v_pk_fma_f32 v[214:215], v[38:39], v[186:187], v[186:187] neg_lo:[0,0,1] neg_hi:[0,0,1]
v_exp_f32 v208, v208
v_exp_f32 v209, v209
v_exp_f32 v210, v210
v_exp_f32 v211, v211
v_exp_f32 v212, v212
v_exp_f32 v213, v213
v_exp_f32 v214, v214
v_exp_f32 v215, v215
v_med3_f32 v32, v208, v32, 1.0
v_med3_f32 v33, v209, v33, 1.0
v_med3_f32 v34, v210, v34, 1.0
v_med3_f32 v35, v211, v35, 1.0
v_med3_f32 v36, v212, v36, 1.0
v_med3_f32 v37, v213, v37, 1.0
v_med3_f32 v38, v214, v38, 1.0
v_med3_f32 v39, v215, v39, 1.0
v_pk_add_f32 v[32:33], v[32:33], v[188:189]
v_pk_add_f32 v[34:35], v[34:35], v[188:189]
v_pk_add_f32 v[36:37], v[36:37], v[188:189]
v_pk_add_f32 v[38:39], v[38:39], v[188:189]
v_pk_fma_f32 v[40:41], v[40:41], v[122:123], v[184:185]
v_pk_fma_f32 v[42:43], v[42:43], v[122:123], v[184:185]
v_pk_fma_f32 v[44:45], v[44:45], v[122:123], v[184:185]
v_pk_fma_f32 v[46:47], v[46:47], v[122:123], v[184:185]
v_pk_fma_f32 v[208:209], v[40:41], v[186:187], v[186:187] neg_lo:[0,0,1] neg_hi:[0,0,1]
v_pk_fma_f32 v[210:211], v[42:43], v[186:187], v[186:187] neg_lo:[0,0,1] neg_hi:[0,0,1]
v_pk_fma_f32 v[212:213], v[44:45], v[186:187], v[186:187] neg_lo:[0,0,1] neg_hi:[0,0,1]
v_pk_fma_f32 v[214:215], v[46:47], v[186:187], v[186:187] neg_lo:[0,0,1] neg_hi:[0,0,1]
v_exp_f32 v208, v208
v_exp_f32 v209, v209
v_exp_f32 v210, v210
v_exp_f32 v211, v211
v_exp_f32 v212, v212
v_exp_f32 v213, v213
v_exp_f32 v214, v214
v_exp_f32 v215, v215
v_med3_f32 v40, v208, v40, 1.0
v_med3_f32 v41, v209, v41, 1.0
v_med3_f32 v42, v210, v42, 1.0
v_med3_f32 v43, v211, v43, 1.0
v_med3_f32 v44, v212, v44, 1.0
v_med3_f32 v45, v213, v45, 1.0
v_med3_f32 v46, v214, v46, 1.0
v_med3_f32 v47, v215, v47, 1.0
v_pk_add_f32 v[40:41], v[40:41], v[188:189]
v_pk_add_f32 v[42:43], v[42:43], v[188:189]
v_pk_add_f32 v[44:45], v[44:45], v[188:189]
v_pk_add_f32 v[46:47], v[46:47], v[188:189]
v_cvt_pk_bf16_f32 v232, v32, v33
v_cvt_pk_bf16_f32 v233, v34, v35
v_cvt_pk_bf16_f32 v236, v36, v37
v_cvt_pk_bf16_f32 v237, v38, v39
v_cvt_pk_bf16_f32 v234, v40, v41
v_cvt_pk_bf16_f32 v235, v42, v43
v_cvt_pk_bf16_f32 v238, v44, v45
v_cvt_pk_bf16_f32 v239, v46, v47
s_add_u32 s51, s48, 4096
buffer_store_dwordx4 v[232:235], v190, s[8:11], s51 offen sc1
buffer_store_dwordx4 v[236:239], v190, s[8:11], s51 offen offset:512 sc1
v_pk_fma_f32 v[48:49], v[48:49], v[122:123], v[184:185]
v_pk_fma_f32 v[50:51], v[50:51], v[122:123], v[184:185]
v_pk_fma_f32 v[52:53], v[52:53], v[122:123], v[184:185]
v_pk_fma_f32 v[54:55], v[54:55], v[122:123], v[184:185]
v_pk_fma_f32 v[208:209], v[48:49], v[186:187], v[186:187] neg_lo:[0,0,1] neg_hi:[0,0,1]
v_pk_fma_f32 v[210:211], v[50:51], v[186:187], v[186:187] neg_lo:[0,0,1] neg_hi:[0,0,1]
v_pk_fma_f32 v[212:213], v[52:53], v[186:187], v[186:187] neg_lo:[0,0,1] neg_hi:[0,0,1]
v_pk_fma_f32 v[214:215], v[54:55], v[186:187], v[186:187] neg_lo:[0,0,1] neg_hi:[0,0,1]
v_exp_f32 v208, v208
v_exp_f32 v209, v209
v_exp_f32 v210, v210
v_exp_f32 v211, v211
v_exp_f32 v212, v212
v_exp_f32 v213, v213
v_exp_f32 v214, v214
v_exp_f32 v215, v215
v_med3_f32 v48, v208, v48, 1.0
v_med3_f32 v49, v209, v49, 1.0
v_med3_f32 v50, v210, v50, 1.0
v_med3_f32 v51, v211, v51, 1.0
v_med3_f32 v52, v212, v52, 1.0
v_med3_f32 v53, v213, v53, 1.0
v_med3_f32 v54, v214, v54, 1.0
v_med3_f32 v55, v215, v55, 1.0
v_pk_add_f32 v[48:49], v[48:49], v[188:189]
v_pk_add_f32 v[50:51], v[50:51], v[188:189]
v_pk_add_f32 v[52:53], v[52:53], v[188:189]
v_pk_add_f32 v[54:55], v[54:55], v[188:189]
v_pk_fma_f32 v[56:57], v[56:57], v[122:123], v[184:185]
v_pk_fma_f32 v[58:59], v[58:59], v[122:123], v[184:185]
v_pk_fma_f32 v[60:61], v[60:61], v[122:123], v[184:185]
v_pk_fma_f32 v[62:63], v[62:63], v[122:123], v[184:185]
v_pk_fma_f32 v[208:209], v[56:57], v[186:187], v[186:187] neg_lo:[0,0,1] neg_hi:[0,0,1]
v_pk_fma_f32 v[210:211], v[58:59], v[186:187], v[186:187] neg_lo:[0,0,1] neg_hi:[0,0,1]
v_pk_fma_f32 v[212:213], v[60:61], v[186:187], v[186:187] neg_lo:[0,0,1] neg_hi:[0,0,1]
v_pk_fma_f32 v[214:215], v[62:63], v[186:187], v[186:187] neg_lo:[0,0,1] neg_hi:[0,0,1]
v_exp_f32 v208, v208
v_exp_f32 v209, v209
v_exp_f32 v210, v210
v_exp_f32 v211, v211
v_exp_f32 v212, v212
v_exp_f32 v213, v213
v_exp_f32 v214, v214
v_exp_f32 v215, v215
v_med3_f32 v56, v208, v56, 1.0
v_med3_f32 v57, v209, v57, 1.0
v_med3_f32 v58, v210, v58, 1.0
v_med3_f32 v59, v211, v59, 1.0
v_med3_f32 v60, v212, v60, 1.0
v_med3_f32 v61, v213, v61, 1.0
v_med3_f32 v62, v214, v62, 1.0
v_med3_f32 v63, v215, v63, 1.0
v_pk_add_f32 v[56:57], v[56:57], v[188:189]
v_pk_add_f32 v[58:59], v[58:59], v[188:189]
v_pk_add_f32 v[60:61], v[60:61], v[188:189]
v_pk_add_f32 v[62:63], v[62:63], v[188:189]
v_cvt_pk_bf16_f32 v224, v48, v49
v_cvt_pk_bf16_f32 v225, v50, v51
v_cvt_pk_bf16_f32 v228, v52, v53
v_cvt_pk_bf16_f32 v229, v54, v55
v_cvt_pk_bf16_f32 v226, v56, v57
v_cvt_pk_bf16_f32 v227, v58, v59
v_cvt_pk_bf16_f32 v230, v60, v61
v_cvt_pk_bf16_f32 v231, v62, v63
s_add_u32 s51, s48, 8192
buffer_store_dwordx4 v[224:227], v190, s[8:11], s51 offen sc1
buffer_store_dwordx4 v[228:231], v190, s[8:11], s51 offen offset:512 sc1
s_waitcnt vmcnt(6)
ds_read_b64_tr_b16 v[136:137], v104
ds_read_b64_tr_b16 v[138:139], v108
ds_read_b64_tr_b16 v[140:141], v105
ds_read_b64_tr_b16 v[142:143], v109
ds_read_b64_tr_b16 v[144:145], v106
ds_read_b64_tr_b16 v[146:147], v110
ds_read_b64_tr_b16 v[148:149], v107
ds_read_b64_tr_b16 v[150:151], v111
v_pk_fma_f32 v[64:65], v[64:65], v[122:123], v[184:185]
v_pk_fma_f32 v[66:67], v[66:67], v[122:123], v[184:185]
v_pk_fma_f32 v[68:69], v[68:69], v[122:123], v[184:185]
v_pk_fma_f32 v[70:71], v[70:71], v[122:123], v[184:185]
v_pk_fma_f32 v[208:209], v[64:65], v[186:187], v[186:187] neg_lo:[0,0,1] neg_hi:[0,0,1]
v_pk_fma_f32 v[210:211], v[66:67], v[186:187], v[186:187] neg_lo:[0,0,1] neg_hi:[0,0,1]
v_pk_fma_f32 v[212:213], v[68:69], v[186:187], v[186:187] neg_lo:[0,0,1] neg_hi:[0,0,1]
v_pk_fma_f32 v[214:215], v[70:71], v[186:187], v[186:187] neg_lo:[0,0,1] neg_hi:[0,0,1]
v_exp_f32 v208, v208
v_exp_f32 v209, v209
v_exp_f32 v210, v210
v_exp_f32 v211, v211
v_exp_f32 v212, v212
v_exp_f32 v213, v213
v_exp_f32 v214, v214
v_exp_f32 v215, v215
v_med3_f32 v64, v208, v64, 1.0
v_med3_f32 v65, v209, v65, 1.0
v_med3_f32 v66, v210, v66, 1.0
v_med3_f32 v67, v211, v67, 1.0
v_med3_f32 v68, v212, v68, 1.0
v_med3_f32 v69, v213, v69, 1.0
v_med3_f32 v70, v214, v70, 1.0
v_med3_f32 v71, v215, v71, 1.0
v_pk_add_f32 v[64:65], v[64:65], v[188:189]
v_pk_add_f32 v[66:67], v[66:67], v[188:189]
v_pk_add_f32 v[68:69], v[68:69], v[188:189]
v_pk_add_f32 v[70:71], v[70:71], v[188:189]
v_pk_fma_f32 v[72:73], v[72:73], v[122:123], v[184:185]
v_pk_fma_f32 v[74:75], v[74:75], v[122:123], v[184:185]
v_pk_fma_f32 v[76:77], v[76:77], v[122:123], v[184:185]
v_pk_fma_f32 v[78:79], v[78:79], v[122:123], v[184:185]
v_pk_fma_f32 v[208:209], v[72:73], v[186:187], v[186:187] neg_lo:[0,0,1] neg_hi:[0,0,1]
v_pk_fma_f32 v[210:211], v[74:75], v[186:187], v[186:187] neg_lo:[0,0,1] neg_hi:[0,0,1]
v_pk_fma_f32 v[212:213], v[76:77], v[186:187], v[186:187] neg_lo:[0,0,1] neg_hi:[0,0,1]
v_pk_fma_f32 v[214:215], v[78:79], v[186:187], v[186:187] neg_lo:[0,0,1] neg_hi:[0,0,1]
v_exp_f32 v208, v208
v_exp_f32 v209, v209
v_exp_f32 v210, v210
v_exp_f32 v211, v211
v_exp_f32 v212, v212
v_exp_f32 v213, v213
v_exp_f32 v214, v214
v_exp_f32 v215, v215
v_med3_f32 v72, v208, v72, 1.0
v_med3_f32 v73, v209, v73, 1.0
v_med3_f32 v74, v210, v74, 1.0
v_med3_f32 v75, v211, v75, 1.0
v_med3_f32 v76, v212, v76, 1.0
v_med3_f32 v77, v213, v77, 1.0
v_med3_f32 v78, v214, v78, 1.0
v_med3_f32 v79, v215, v79, 1.0
v_pk_add_f32 v[72:73], v[72:73], v[188:189]
v_pk_add_f32 v[74:75], v[74:75], v[188:189]
v_pk_add_f32 v[76:77], v[76:77], v[188:189]
v_pk_add_f32 v[78:79], v[78:79], v[188:189]
v_cvt_pk_bf16_f32 v232, v64, v65
v_cvt_pk_bf16_f32 v233, v66, v67
v_cvt_pk_bf16_f32 v236, v68, v69
v_cvt_pk_bf16_f32 v237, v70, v71
v_cvt_pk_bf16_f32 v234, v72, v73
v_cvt_pk_bf16_f32 v235, v74, v75
v_cvt_pk_bf16_f32 v238, v76, v77
v_cvt_pk_bf16_f32 v239, v78, v79
s_add_u32 s51, s48, 12288
buffer_store_dwordx4 v[232:235], v190, s[8:11], s51 offen sc1
buffer_store_dwordx4 v[236:239], v190, s[8:11], s51 offen offset:512 sc1
s_waitcnt lgkmcnt(6)
buffer_store_dwordx4 v[136:139], v13, s[8:11], s55 offen sc1
s_add_u32 s55, s55, s52
s_waitcnt lgkmcnt(4)
buffer_store_dwordx4 v[140:143], v13, s[8:11], s55 offen sc1
s_add_u32 s55, s55, s52
s_waitcnt lgkmcnt(2)
buffer_store_dwordx4 v[144:147], v13, s[8:11], s55 offen sc1
s_add_u32 s55, s55, s52
s_waitcnt lgkmcnt(0)
buffer_store_dwordx4 v[148:151], v13, s[8:11], s55 offen sc1
s_add_u32 s55, s55, s52
v_pk_fma_f32 v[80:81], v[80:81], v[122:123], v[184:185]
v_pk_fma_f32 v[82:83], v[82:83], v[122:123], v[184:185]
v_pk_fma_f32 v[84:85], v[84:85], v[122:123], v[184:185]
v_pk_fma_f32 v[86:87], v[86:87], v[122:123], v[184:185]
v_pk_fma_f32 v[208:209], v[80:81], v[186:187], v[186:187] neg_lo:[0,0,1] neg_hi:[0,0,1]
v_pk_fma_f32 v[210:211], v[82:83], v[186:187], v[186:187] neg_lo:[0,0,1] neg_hi:[0,0,1]
v_pk_fma_f32 v[212:213], v[84:85], v[186:187], v[186:187] neg_lo:[0,0,1] neg_hi:[0,0,1]
v_pk_fma_f32 v[214:215], v[86:87], v[186:187], v[186:187] neg_lo:[0,0,1] neg_hi:[0,0,1]
v_exp_f32 v208, v208
v_exp_f32 v209, v209
v_exp_f32 v210, v210
v_exp_f32 v211, v211
v_exp_f32 v212, v212
v_exp_f32 v213, v213
v_exp_f32 v214, v214
v_exp_f32 v215, v215
v_med3_f32 v80, v208, v80, 1.0
v_med3_f32 v81, v209, v81, 1.0
v_med3_f32 v82, v210, v82, 1.0
v_med3_f32 v83, v211, v83, 1.0
v_med3_f32 v84, v212, v84, 1.0
v_med3_f32 v85, v213, v85, 1.0
v_med3_f32 v86, v214, v86, 1.0
v_med3_f32 v87, v215, v87, 1.0
v_pk_add_f32 v[80:81], v[80:81], v[188:189]
v_pk_add_f32 v[82:83], v[82:83], v[188:189]
v_pk_add_f32 v[84:85], v[84:85], v[188:189]
v_pk_add_f32 v[86:87], v[86:87], v[188:189]
v_pk_fma_f32 v[88:89], v[88:89], v[122:123], v[184:185]
v_pk_fma_f32 v[90:91], v[90:91], v[122:123], v[184:185]
v_pk_fma_f32 v[92:93], v[92:93], v[122:123], v[184:185]
v_pk_fma_f32 v[94:95], v[94:95], v[122:123], v[184:185]
v_pk_fma_f32 v[208:209], v[88:89], v[186:187], v[186:187] neg_lo:[0,0,1] neg_hi:[0,0,1]
v_pk_fma_f32 v[210:211], v[90:91], v[186:187], v[186:187] neg_lo:[0,0,1] neg_hi:[0,0,1]
v_pk_fma_f32 v[212:213], v[92:93], v[186:187], v[186:187] neg_lo:[0,0,1] neg_hi:[0,0,1]
v_pk_fma_f32 v[214:215], v[94:95], v[186:187], v[186:187] neg_lo:[0,0,1] neg_hi:[0,0,1]
v_exp_f32 v208, v208
v_exp_f32 v209, v209
v_exp_f32 v210, v210
v_exp_f32 v211, v211
v_exp_f32 v212, v212
v_exp_f32 v213, v213
v_exp_f32 v214, v214
v_exp_f32 v215, v215
v_med3_f32 v88, v208, v88, 1.0
v_med3_f32 v89, v209, v89, 1.0
v_med3_f32 v90, v210, v90, 1.0
v_med3_f32 v91, v211, v91, 1.0
v_med3_f32 v92, v212, v92, 1.0
v_med3_f32 v93, v213, v93, 1.0
v_med3_f32 v94, v214, v94, 1.0
v_med3_f32 v95, v215, v95, 1.0
v_pk_add_f32 v[88:89], v[88:89], v[188:189]
v_pk_add_f32 v[90:91], v[90:91], v[188:189]
v_pk_add_f32 v[92:93], v[92:93], v[188:189]
v_pk_add_f32 v[94:95], v[94:95], v[188:189]
v_cvt_pk_bf16_f32 v224, v80, v81
v_cvt_pk_bf16_f32 v225, v82, v83
v_cvt_pk_bf16_f32 v228, v84, v85
v_cvt_pk_bf16_f32 v229, v86, v87
v_cvt_pk_bf16_f32 v226, v88, v89
v_cvt_pk_bf16_f32 v227, v90, v91
v_cvt_pk_bf16_f32 v230, v92, v93
v_cvt_pk_bf16_f32 v231, v94, v95
s_add_u32 s51, s48, 16384
buffer_store_dwordx4 v[224:227], v190, s[8:11], s51 offen sc1
buffer_store_dwordx4 v[228:231], v190, s[8:11], s51 offen offset:512 sc1
s_mul_i32 s77, s17, 69888
s_lshl_b32 s21, s18, 2
s_add_u32 s77, s77, s21
s_add_u32 s77, s77, 19928320
s_branch L_fin_sequential_preLN__linear_attn_block__swiglu_ffn__prompt_kernel
L_kv_sequential_preLN__linear_attn_block__swiglu_ffn__prompt_kernel:
s_nop 12
s_lshl_b32 s18, s23, 2
s_add_u32 s18, s18, s22
s_add_u32 s18, s18, 2
v_lshrrev_b32 v96, 3, v1
v_and_b32 v97, 7, v1
v_lshrrev_b32 v98, 4, v1
s_movk_i32 s20, 1280
v_add_u32 v99, 0, v96
v_mul_lo_u32 v99, v99, s20
v_add_u32 v100, 0, v98
v_and_b32 v100, 7, v100
v_xor_b32 v100, v100, v97
v_lshl_add_u32 v99, v100, 4, v99
v_subrev_u32 v4, 0, v99
v_add_u32 v99, 8, v96
v_mul_lo_u32 v99, v99, s20
v_add_u32 v100, 4, v98
v_and_b32 v100, 7, v100
v_xor_b32 v100, v100, v97
v_lshl_add_u32 v99, v100, 4, v99
v_subrev_u32 v5, 1024, v99
v_add_u32 v99, 16, v96
v_mul_lo_u32 v99, v99, s20
v_add_u32 v100, 8, v98
v_and_b32 v100, 7, v100
v_xor_b32 v100, v100, v97
v_lshl_add_u32 v99, v100, 4, v99
v_subrev_u32 v6, 2048, v99
v_add_u32 v99, 24, v96
v_mul_lo_u32 v99, v99, s20
v_add_u32 v100, 12, v98
v_and_b32 v100, 7, v100
v_xor_b32 v100, v100, v97
v_lshl_add_u32 v99, v100, 4, v99
v_subrev_u32 v7, 3072, v99
s_mov_b32 s20, 52429
s_movk_i32 s21, 3840
v_add_u32 v99, 0, v1
v_mul_lo_u32 v100, v99, s20
v_lshrrev_b32 v100, 20, v100
v_mul_u32_u24 v101, 20, v100
v_sub_u32 v99, v99, v101
v_mul_lo_u32 v100, v100, s21
v_lshl_add_u32 v100, v99, 4, v100
v_cmp_le_u32 vcc, 10, v99
v_mov_b32 v101, 1120
s_nop 0
v_cndmask_b32 v101, 0, v101, vcc
v_add_u32 v100, v100, v101
v_subrev_u32 v8, 0, v100
v_add_u32 v99, 64, v1
v_mul_lo_u32 v100, v99, s20
v_lshrrev_b32 v100, 20, v100
v_mul_u32_u24 v101, 20, v100
v_sub_u32 v99, v99, v101
v_mul_lo_u32 v100, v100, s21
v_lshl_add_u32 v100, v99, 4, v100
v_cmp_le_u32 vcc, 10, v99
v_mov_b32 v101, 1120
s_nop 0
v_cndmask_b32 v101, 0, v101, vcc
v_add_u32 v100, v100, v101
v_subrev_u32 v9, 1024, v100
v_add_u32 v99, 128, v1
v_mul_lo_u32 v100, v99, s20
v_lshrrev_b32 v100, 20, v100
v_mul_u32_u24 v101, 20, v100
v_sub_u32 v99, v99, v101
v_mul_lo_u32 v100, v100, s21
v_lshl_add_u32 v100, v99, 4, v100
v_cmp_le_u32 vcc, 10, v99
v_mov_b32 v101, 1120
s_nop 0
v_cndmask_b32 v101, 0, v101, vcc
v_add_u32 v100, v100, v101
v_subrev_u32 v10, 2048, v100
v_add_u32 v99, 192, v1
v_mul_lo_u32 v100, v99, s20
v_lshrrev_b32 v100, 20, v100
v_mul_u32_u24 v101, 20, v100
v_sub_u32 v99, v99, v101
v_mul_lo_u32 v100, v100, s21
v_lshl_add_u32 v100, v99, 4, v100
v_cmp_le_u32 vcc, 10, v99
v_mov_b32 v101, 1120
s_nop 0
v_cndmask_b32 v101, 0, v101, vcc
v_add_u32 v100, v100, v101
v_subrev_u32 v11, 3072, v100
v_add_u32 v99, 256, v1
v_mul_lo_u32 v100, v99, s20
v_lshrrev_b32 v100, 20, v100
v_mul_u32_u24 v101, 20, v100
v_sub_u32 v99, v99, v101
v_mul_lo_u32 v100, v100, s21
v_lshl_add_u32 v100, v99, 4, v100
v_cmp_le_u32 vcc, 10, v99
v_mov_b32 v101, 1120
s_nop 0
v_cndmask_b32 v101, 0, v101, vcc
v_add_u32 v100, v100, v101
v_subrev_u32 v12, 0, v100
s_waitcnt lgkmcnt(0)
s_mov_b32 s12, s4
s_and_b32 s13, s5, 0xffff
s_mov_b32 s56, s6
s_and_b32 s57, s7, 0xffff
s_mov_b32 s60, s24
s_and_b32 s61, s25, 0xffff
s_mov_b32 s8, s26
s_and_b32 s9, s27, 0xffff
s_lshl_b32 s26, s17, 2
s_add_u32 s26, s26, s16
s_mul_i32 s26, s26, 40960
s_mul_i32 s27, s16, 61440
s_mul_i32 s20, s18, 160
s_add_u32 s20, s20, 640
s_add_u32 s27, s27, s20
s_mul_i32 s30, s16, 5120
s_lshl_b32 s31, s16, 12
s_add_u32 s31, s31, 20480
s_mov_b32 s33, 0
s_mov_b32 s29, 0
s_mov_b32 s28, 0x7f000000
s_add_u32 s34, s30, s33
s_mov_b32 m0, s34
s_add_u32 s34, s34, 4096
buffer_load_dwordx4 v8, s[56:59], s27 offen offset:0 lds
buffer_load_dwordx4 v9, s[56:59], s27 offen offset:1024 lds
buffer_load_dwordx4 v10, s[56:59], s27 offen offset:2048 lds
buffer_load_dwordx4 v11, s[56:59], s27 offen offset:3072 lds
s_mov_b32 m0, s34
s_add_u32 s34, s31, s33
buffer_load_dwordx4 v12, s[56:59], s27 offen lds
s_mov_b32 m0, s34
s_add_u32 s27, s27, 245760
buffer_load_dwordx4 v4, s[12:15], s26 offen offset:0 lds
buffer_load_dwordx4 v5, s[12:15], s26 offen offset:1024 lds
buffer_load_dwordx4 v6, s[12:15], s26 offen offset:2048 lds
buffer_load_dwordx4 v7, s[12:15], s26 offen offset:3072 lds
s_cmp_eq_u32 s29, 7
s_cselect_b32 s35, s28, 128
s_add_u32 s26, s26, s35
s_add_u32 s33, s33, 36864
s_cmp_eq_u32 s33, 147456
s_cselect_b32 s33, 0, s33
s_add_u32 s34, s30, s33
s_mov_b32 m0, s34
s_add_u32 s34, s34, 4096
buffer_load_dwordx4 v8, s[56:59], s27 offen offset:0 lds
buffer_load_dwordx4 v9, s[56:59], s27 offen offset:1024 lds
buffer_load_dwordx4 v10, s[56:59], s27 offen offset:2048 lds
buffer_load_dwordx4 v11, s[56:59], s27 offen offset:3072 lds
s_mov_b32 m0, s34
s_add_u32 s34, s31, s33
buffer_load_dwordx4 v12, s[56:59], s27 offen lds
s_mov_b32 m0, s34
s_add_u32 s27, s27, 245760
buffer_load_dwordx4 v4, s[12:15], s26 offen offset:0 lds
buffer_load_dwordx4 v5, s[12:15], s26 offen offset:1024 lds
buffer_load_dwordx4 v6, s[12:15], s26 offen offset:2048 lds
buffer_load_dwordx4 v7, s[12:15], s26 offen offset:3072 lds
s_cmp_eq_u32 s29, 7
s_cselect_b32 s35, s28, 128
s_add_u32 s26, s26, s35
s_add_u32 s33, s33, 36864
s_cmp_eq_u32 s33, 147456
s_cselect_b32 s33, 0, s33
v_and_b32 v96, 31, v1
v_lshrrev_b32 v97, 5, v1
v_bfe_u32 v103, v1, 1, 3
v_lshlrev_b32 v102, 7, v96
s_lshl_b32 s20, s16, 12
v_add_u32 v102, s20, v102
v_add_u32 v104, 0, v97
v_xor_b32 v104, v104, v103
v_lshl_add_u32 v98, v104, 4, v102
v_add_u32 v104, 2, v97
v_xor_b32 v104, v104, v103
v_lshl_add_u32 v99, v104, 4, v102
v_add_u32 v104, 4, v97
v_xor_b32 v104, v104, v103
v_lshl_add_u32 v100, v104, 4, v102
v_add_u32 v104, 6, v97
v_xor_b32 v104, v104, v103
v_lshl_add_u32 v101, v104, 4, v102
v_bfe_u32 v103, v1, 2, 2
v_lshl_add_u32 v103, v97, 3, v103
v_mul_u32_u24 v103, 320, v103
v_bfe_u32 v104, v1, 4, 1
v_lshl_add_u32 v103, v104, 5, v103
v_and_b32 v104, 3, v1
v_lshl_add_u32 v102, v104, 3, v103
v_mov_b32 v114, 0
v_mov_b32 v104, v98
v_mov_b32 v105, v99
v_mov_b32 v106, v100
v_mov_b32 v107, v101
v_mov_b32 v112, v102
v_mov_b32 v16, 0
v_mov_b32 v17, 0
v_mov_b32 v18, 0
v_mov_b32 v19, 0
v_mov_b32 v20, 0
v_mov_b32 v21, 0
v_mov_b32 v22, 0
v_mov_b32 v23, 0
v_mov_b32 v24, 0
v_mov_b32 v25, 0
v_mov_b32 v26, 0
v_mov_b32 v27, 0
v_mov_b32 v28, 0
v_mov_b32 v29, 0
v_mov_b32 v30, 0
v_mov_b32 v31, 0
v_mov_b32 v32, 0
v_mov_b32 v33, 0
v_mov_b32 v34, 0
v_mov_b32 v35, 0
v_mov_b32 v36, 0
v_mov_b32 v37, 0
v_mov_b32 v38, 0
v_mov_b32 v39, 0
v_mov_b32 v40, 0
v_mov_b32 v41, 0
v_mov_b32 v42, 0
v_mov_b32 v43, 0
v_mov_b32 v44, 0
v_mov_b32 v45, 0
v_mov_b32 v46, 0
v_mov_b32 v47, 0
v_mov_b32 v48, 0
v_mov_b32 v49, 0
v_mov_b32 v50, 0
v_mov_b32 v51, 0
v_mov_b32 v52, 0
v_mov_b32 v53, 0
v_mov_b32 v54, 0
v_mov_b32 v55, 0
v_mov_b32 v56, 0
v_mov_b32 v57, 0
v_mov_b32 v58, 0
v_mov_b32 v59, 0
v_mov_b32 v60, 0
v_mov_b32 v61, 0
v_mov_b32 v62, 0
v_mov_b32 v63, 0
v_mov_b32 v64, 0
v_mov_b32 v65, 0
v_mov_b32 v66, 0
v_mov_b32 v67, 0
v_mov_b32 v68, 0
v_mov_b32 v69, 0
v_mov_b32 v70, 0
v_mov_b32 v71, 0
v_mov_b32 v72, 0
v_mov_b32 v73, 0
v_mov_b32 v74, 0
v_mov_b32 v75, 0
v_mov_b32 v76, 0
v_mov_b32 v77, 0
v_mov_b32 v78, 0
v_mov_b32 v79, 0
v_mov_b32 v80, 0
v_mov_b32 v81, 0
v_mov_b32 v82, 0
v_mov_b32 v83, 0
v_mov_b32 v84, 0
v_mov_b32 v85, 0
v_mov_b32 v86, 0
v_mov_b32 v87, 0
v_mov_b32 v88, 0
v_mov_b32 v89, 0
v_mov_b32 v90, 0
v_mov_b32 v91, 0
v_mov_b32 v92, 0
v_mov_b32 v93, 0
v_mov_b32 v94, 0
v_mov_b32 v95, 0
v_mov_b32 v190, 0
v_mov_b32 v191, 0
v_mov_b32 v240, 0
v_mov_b32 v241, 0
v_mov_b32 v242, 0
v_mov_b32 v243, 0
v_mov_b32 v244, 0
v_mov_b32 v245, 0
v_mov_b32 v246, 0
v_mov_b32 v247, 0
v_mov_b32 v248, 0
v_mov_b32 v249, 0
v_mov_b32 v250, 0
v_mov_b32 v251, 0
v_mov_b32 v252, 0
v_mov_b32 v253, 0
v_mov_b32 v254, 0
v_mov_b32 v255, 0
s_lshl_b32 s36, s17, 2
s_add_u32 s36, s36, s16
s_lshl_b32 s36, s36, 7
s_add_u32 s36, s36, 21045248
s_add_u32 s43, s36, 8192
v_lshlrev_b32 v115, 2, v96
v_lshlrev_b32 v116, 26, v97
v_lshl_add_u32 v116, v116, 4, v115
v_lshlrev_b32 v119, 4, v97
s_mov_b32 s42, 0x3fb8aa3b
v_cmp_le_u32 vcc, 16, v96
v_mov_b32 v117, 2240
s_nop 0
v_cndmask_b32 v117, 0, v117, vcc
v_add_u32 v117, v117, v116
s_mul_i32 s37, s18, 320
s_add_u32 s37, s37, 21062912
s_add_u32 s34, s30, s33
s_mov_b32 m0, s34
s_add_u32 s34, s34, 4096
buffer_load_dwordx4 v8, s[56:59], s27 offen offset:0 lds
buffer_load_dwordx4 v9, s[56:59], s27 offen offset:1024 lds
buffer_load_dwordx4 v10, s[56:59], s27 offen offset:2048 lds
buffer_load_dwordx4 v11, s[56:59], s27 offen offset:3072 lds
s_waitcnt vmcnt(13)
s_barrier
s_mov_b32 s29, 0
s_mov_b32 s32, 0
ds_read_b128 a[0:3], v104 offset:20480
ds_read_b64_tr_b16 a[8:9], v112 offset:0
ds_read_b64_tr_b16 a[10:11], v112 offset:1280
ds_read_b64_tr_b16 a[12:13], v112 offset:64
ds_read_b64_tr_b16 a[14:15], v112 offset:1344
ds_read_b64_tr_b16 a[16:17], v112 offset:128
ds_read_b64_tr_b16 a[18:19], v112 offset:1408
ds_read_b64_tr_b16 a[20:21], v112 offset:192
ds_read_b64_tr_b16 a[22:23], v112 offset:1472
ds_read_b64_tr_b16 a[24:25], v112 offset:256
ds_read_b64_tr_b16 a[26:27], v112 offset:1536
L_lp_kv_sequential_preLN__linear_attn_block__swiglu_ffn__prompt_kernel:
s_cmp_eq_u32 s29, 2
s_cbranch_scc1 L_lp_kv_sequential_preLN__linear_attn_block__swiglu_ffn__prompt_kernel_x2
s_cmp_eq_u32 s29, 3
s_cbranch_scc1 L_lp_kv_sequential_preLN__linear_attn_block__swiglu_ffn__prompt_kernel_x3
s_cmp_eq_u32 s29, 6
s_cbranch_scc1 L_lp_kv_sequential_preLN__linear_attn_block__swiglu_ffn__prompt_kernel_x6
s_cmp_eq_u32 s29, 7
s_cbranch_scc1 L_lp_kv_sequential_preLN__linear_attn_block__swiglu_ffn__prompt_kernel_x7
s_cmp_eq_u32 s29, 9
s_cbranch_scc1 L_lp_kv_sequential_preLN__linear_attn_block__swiglu_ffn__prompt_kernel_x9
L_lp_kv_sequential_preLN__linear_attn_block__swiglu_ffn__prompt_kernel_r:
s_add_u32 s32, s32, 36864
s_cmp_eq_u32 s32, 147456
s_cselect_b32 s32, 0, s32
v_add_u32 v108, s32, v98
v_add_u32 v113, s32, v102
s_waitcnt lgkmcnt(8)
v_mfma_f32_32x32x16_bf16 v[16:31], a[0:3], a[8:11], v[16:31]
ds_read_b128 a[4:7], v105 offset:20480
ds_read_b64_tr_b16 a[28:29], v112 offset:5120
s_mov_b32 m0, s34
s_waitcnt lgkmcnt(8)
v_mfma_f32_32x32x16_bf16 v[32:47], a[0:3], a[12:15], v[32:47]
ds_read_b64_tr_b16 a[30:31], v112 offset:6400
ds_read_b64_tr_b16 a[32:33], v112 offset:5184
s_add_u32 s34, s31, s33
ds_read_b64_tr_b16 a[34:35], v112 offset:6464
s_waitcnt lgkmcnt(9)
v_mfma_f32_32x32x16_bf16 v[48:63], a[0:3], a[16:19], v[48:63]
buffer_load_dwordx4 v12, s[56:59], s27 offen lds
ds_read_b64_tr_b16 a[36:37], v112 offset:5248
ds_read_b64_tr_b16 a[38:39], v112 offset:6528
s_waitcnt lgkmcnt(9)
v_mfma_f32_32x32x16_bf16 v[64:79], a[0:3], a[20:23], v[64:79]
s_mov_b32 m0, s34
ds_read_b64_tr_b16 a[40:41], v112 offset:5312
s_add_u32 s27, s27, 245760
ds_read_b64_tr_b16 a[42:43], v112 offset:6592
s_waitcnt lgkmcnt(9)
v_mfma_f32_32x32x16_bf16 v[80:95], a[0:3], a[24:27], v[80:95]
ds_read_b64_tr_b16 a[44:45], v112 offset:5376
buffer_load_dwordx4 v4, s[12:15], s26 offen offset:0 lds
ds_read_b64_tr_b16 a[46:47], v112 offset:6656
buffer_load_dwordx4 v5, s[12:15], s26 offen offset:1024 lds
s_waitcnt lgkmcnt(8)
v_mfma_f32_32x32x16_bf16 v[16:31], a[4:7], a[28:31], v[16:31]
ds_read_b128 a[0:3], v106 offset:20480
ds_read_b64_tr_b16 a[8:9], v112 offset:10240
buffer_load_dwordx4 v6, s[12:15], s26 offen offset:2048 lds
s_waitcnt lgkmcnt(8)
v_mfma_f32_32x32x16_bf16 v[32:47], a[4:7], a[32:35], v[32:47]
ds_read_b64_tr_b16 a[10:11], v112 offset:11520
buffer_load_dwordx4 v7, s[12:15], s26 offen offset:3072 lds
ds_read_b64_tr_b16 a[12:13], v112 offset:10304
ds_read_b64_tr_b16 a[14:15], v112 offset:11584
s_waitcnt lgkmcnt(9)
v_mfma_f32_32x32x16_bf16 v[48:63], a[4:7], a[36:39], v[48:63]
s_cmp_eq_u32 s29, 7
ds_read_b64_tr_b16 a[16:17], v112 offset:10368
s_cselect_b32 s35, s28, 128
ds_read_b64_tr_b16 a[18:19], v112 offset:11648
s_waitcnt lgkmcnt(9)
v_mfma_f32_32x32x16_bf16 v[64:79], a[4:7], a[40:43], v[64:79]
s_add_u32 s26, s26, s35
ds_read_b64_tr_b16 a[20:21], v112 offset:10432
ds_read_b64_tr_b16 a[22:23], v112 offset:11712
s_add_u32 s33, s33, 36864
s_waitcnt lgkmcnt(9)
v_mfma_f32_32x32x16_bf16 v[80:95], a[4:7], a[44:47], v[80:95]
ds_read_b64_tr_b16 a[24:25], v112 offset:10496
s_cmp_eq_u32 s33, 147456
ds_read_b64_tr_b16 a[26:27], v112 offset:11776
s_cselect_b32 s33, 0, s33
s_waitcnt lgkmcnt(8)
v_mfma_f32_32x32x16_bf16 v[16:31], a[0:3], a[8:11], v[16:31]
ds_read_b128 a[4:7], v107 offset:20480
ds_read_b64_tr_b16 a[28:29], v112 offset:15360
s_waitcnt lgkmcnt(8)
v_mfma_f32_32x32x16_bf16 v[32:47], a[0:3], a[12:15], v[32:47]
ds_read_b64_tr_b16 a[30:31], v112 offset:16640
ds_read_b64_tr_b16 a[32:33], v112 offset:15424
s_waitcnt lgkmcnt(8)
v_mfma_f32_32x32x16_bf16 v[48:63], a[0:3], a[16:19], v[48:63]
ds_read_b64_tr_b16 a[34:35], v112 offset:16704
ds_read_b64_tr_b16 a[36:37], v112 offset:15488
s_waitcnt lgkmcnt(8)
v_mfma_f32_32x32x16_bf16 v[64:79], a[0:3], a[20:23], v[64:79]
ds_read_b64_tr_b16 a[38:39], v112 offset:16768
ds_read_b64_tr_b16 a[40:41], v112 offset:15552
s_waitcnt lgkmcnt(8)
v_mfma_f32_32x32x16_bf16 v[80:95], a[0:3], a[24:27], v[80:95]
ds_read_b64_tr_b16 a[42:43], v112 offset:16832
ds_read_b64_tr_b16 a[44:45], v112 offset:15616
ds_read_b64_tr_b16 a[46:47], v112 offset:16896
s_waitcnt vmcnt(9)
s_barrier
s_waitcnt lgkmcnt(8)
v_mfma_f32_32x32x16_bf16 v[16:31], a[4:7], a[28:31], v[16:31]
ds_read_b128 a[0:3], v108 offset:20480
ds_read_b64_tr_b16 a[8:9], v113 offset:0
s_add_u32 s34, s30, s33
ds_read_b64_tr_b16 a[10:11], v113 offset:1280
s_waitcnt lgkmcnt(9)
v_mfma_f32_32x32x16_bf16 v[32:47], a[4:7], a[32:35], v[32:47]
ds_read_b64_tr_b16 a[12:13], v113 offset:64
s_mov_b32 m0, s34
ds_read_b64_tr_b16 a[14:15], v113 offset:1344
s_add_u32 s34, s34, 4096
ds_read_b64_tr_b16 a[16:17], v113 offset:128
s_waitcnt lgkmcnt(10)
v_mfma_f32_32x32x16_bf16 v[48:63], a[4:7], a[36:39], v[48:63]
ds_read_b64_tr_b16 a[18:19], v113 offset:1408
buffer_load_dwordx4 v8, s[56:59], s27 offen offset:0 lds
ds_read_b64_tr_b16 a[20:21], v113 offset:192
buffer_load_dwordx4 v9, s[56:59], s27 offen offset:1024 lds
s_waitcnt lgkmcnt(10)
v_mfma_f32_32x32x16_bf16 v[64:79], a[4:7], a[40:43], v[64:79]
ds_read_b64_tr_b16 a[22:23], v113 offset:1472
ds_read_b64_tr_b16 a[24:25], v113 offset:256
buffer_load_dwordx4 v10, s[56:59], s27 offen offset:2048 lds
ds_read_b64_tr_b16 a[26:27], v113 offset:1536
buffer_load_dwordx4 v11, s[56:59], s27 offen offset:3072 lds
s_waitcnt lgkmcnt(11)
v_mfma_f32_32x32x16_bf16 v[80:95], a[4:7], a[44:47], v[80:95]
v_add_u32 v104, s32, v98
v_add_u32 v105, s32, v99
v_add_u32 v106, s32, v100
v_add_u32 v107, s32, v101
v_mov_b32 v112, v113
s_add_u32 s29, s29, 1
s_cmp_lt_u32 s29, 10
s_cbranch_scc1 L_lp_kv_sequential_preLN__linear_attn_block__swiglu_ffn__prompt_kernel
s_branch L_lp_kv_sequential_preLN__linear_attn_block__swiglu_ffn__prompt_kernel_done
L_lp_kv_sequential_preLN__linear_attn_block__swiglu_ffn__prompt_kernel_x2:
s_mul_i32 s44, s16, 5
s_mul_i32 s45, s16, 20
s_mov_b32 s46, 52429
s_sub_u32 s47, s18, 4
s_mul_i32 s48, s47, 13312
s_add_u32 s48, s48, 19795968
s_mul_i32 s49, s47, 320
s_add_u32 s49, s49, 19902464
s_sub_u32 s49, s49, s48
s_mul_i32 s50, s16, 20992
s_add_u32 s50, s50, 73728
v_add_u32 v184, 0, v1
v_mul_lo_u32 v185, v184, s46
v_lshrrev_b32 v185, 22, v185
v_mul_u32_u24 v186, 80, v185
v_sub_u32 v184, v184, v186
v_add_u32 v185, s44, v185
v_lshrrev_b32 v186, 2, v184
v_add_u32 v186, s45, v186
v_lshrrev_b32 v187, 3, v185
v_min_u32 v187, 1, v187
v_lshlrev_b32 v187, 5, v187
v_sub_u32 v187, v186, v187
v_add_u32 v187, 16, v187
v_lshl_add_u32 v187, v185, 6, v187
v_and_b32 v184, 3, v184
v_lshl_add_u32 v187, v187, 2, v184
v_lshlrev_b32 v240, 2, v187
v_lshrrev_b32 v187, 2, v185
v_lshrrev_b32 v188, 4, v186
v_lshl_add_u32 v187, v187, 1, v188
v_and_b32 v185, 3, v185
v_lshl_add_u32 v187, v187, 2, v185
v_and_b32 v186, 15, v186
v_lshl_add_u32 v187, v187, 4, v186
v_lshl_add_u32 v187, v187, 2, v184
v_lshlrev_b32 v248, 2, v187
v_add_u32 v184, 64, v1
v_mul_lo_u32 v185, v184, s46
v_lshrrev_b32 v185, 22, v185
v_mul_u32_u24 v186, 80, v185
v_sub_u32 v184, v184, v186
v_add_u32 v185, s44, v185
v_lshrrev_b32 v186, 2, v184
v_add_u32 v186, s45, v186
v_lshrrev_b32 v187, 3, v185
v_min_u32 v187, 1, v187
v_lshlrev_b32 v187, 5, v187
v_sub_u32 v187, v186, v187
v_add_u32 v187, 16, v187
v_lshl_add_u32 v187, v185, 6, v187
v_and_b32 v184, 3, v184
v_lshl_add_u32 v187, v187, 2, v184
v_lshlrev_b32 v241, 2, v187
v_lshrrev_b32 v187, 2, v185
v_lshrrev_b32 v188, 4, v186
v_lshl_add_u32 v187, v187, 1, v188
v_and_b32 v185, 3, v185
v_lshl_add_u32 v187, v187, 2, v185
v_and_b32 v186, 15, v186
v_lshl_add_u32 v187, v187, 4, v186
v_lshl_add_u32 v187, v187, 2, v184
v_lshlrev_b32 v249, 2, v187
v_add_u32 v184, 128, v1
v_mul_lo_u32 v185, v184, s46
v_lshrrev_b32 v185, 22, v185
v_mul_u32_u24 v186, 80, v185
v_sub_u32 v184, v184, v186
v_add_u32 v185, s44, v185
v_lshrrev_b32 v186, 2, v184
v_add_u32 v186, s45, v186
v_lshrrev_b32 v187, 3, v185
v_min_u32 v187, 1, v187
v_lshlrev_b32 v187, 5, v187
v_sub_u32 v187, v186, v187
v_add_u32 v187, 16, v187
v_lshl_add_u32 v187, v185, 6, v187
v_and_b32 v184, 3, v184
v_lshl_add_u32 v187, v187, 2, v184
v_lshlrev_b32 v242, 2, v187
v_lshrrev_b32 v187, 2, v185
v_lshrrev_b32 v188, 4, v186
v_lshl_add_u32 v187, v187, 1, v188
v_and_b32 v185, 3, v185
v_lshl_add_u32 v187, v187, 2, v185
v_and_b32 v186, 15, v186
v_lshl_add_u32 v187, v187, 4, v186
v_lshl_add_u32 v187, v187, 2, v184
v_lshlrev_b32 v250, 2, v187
v_add_u32 v184, 192, v1
v_mul_lo_u32 v185, v184, s46
v_lshrrev_b32 v185, 22, v185
v_mul_u32_u24 v186, 80, v185
v_sub_u32 v184, v184, v186
v_add_u32 v185, s44, v185
v_lshrrev_b32 v186, 2, v184
v_add_u32 v186, s45, v186
v_lshrrev_b32 v187, 3, v185
v_min_u32 v187, 1, v187
v_lshlrev_b32 v187, 5, v187
v_sub_u32 v187, v186, v187
v_add_u32 v187, 16, v187
v_lshl_add_u32 v187, v185, 6, v187
s_nop 1
s_branch L_lp_kv_sequential_preLN__linear_attn_block__swiglu_ffn__prompt_kernel_r
L_lp_kv_sequential_preLN__linear_attn_block__swiglu_ffn__prompt_kernel_x3:
v_and_b32 v184, 3, v184
v_lshl_add_u32 v187, v187, 2, v184
v_lshlrev_b32 v243, 2, v187
v_lshrrev_b32 v187, 2, v185
v_lshrrev_b32 v188, 4, v186
v_lshl_add_u32 v187, v187, 1, v188
v_and_b32 v185, 3, v185
v_lshl_add_u32 v187, v187, 2, v185
v_and_b32 v186, 15, v186
v_lshl_add_u32 v187, v187, 4, v186
v_lshl_add_u32 v187, v187, 2, v184
v_lshlrev_b32 v251, 2, v187
v_add_u32 v184, 256, v1
v_mul_lo_u32 v185, v184, s46
v_lshrrev_b32 v185, 22, v185
v_mul_u32_u24 v186, 80, v185
v_sub_u32 v184, v184, v186
v_add_u32 v185, s44, v185
v_lshrrev_b32 v186, 2, v184
v_add_u32 v186, s45, v186
v_lshrrev_b32 v187, 3, v185
v_min_u32 v187, 1, v187
v_lshlrev_b32 v187, 5, v187
v_sub_u32 v187, v186, v187
v_add_u32 v187, 16, v187
v_lshl_add_u32 v187, v185, 6, v187
v_and_b32 v184, 3, v184
v_lshl_add_u32 v187, v187, 2, v184
v_lshlrev_b32 v244, 2, v187
v_lshrrev_b32 v187, 2, v185
v_lshrrev_b32 v188, 4, v186
v_lshl_add_u32 v187, v187, 1, v188
v_and_b32 v185, 3, v185
v_lshl_add_u32 v187, v187, 2, v185
v_and_b32 v186, 15, v186
v_lshl_add_u32 v187, v187, 4, v186
v_lshl_add_u32 v187, v187, 2, v184
v_lshlrev_b32 v252, 2, v187
v_add_u32 v184, 320, v1
v_mul_lo_u32 v185, v184, s46
v_lshrrev_b32 v185, 22, v185
v_mul_u32_u24 v186, 80, v185
v_sub_u32 v184, v184, v186
v_add_u32 v185, s44, v185
v_lshrrev_b32 v186, 2, v184
v_add_u32 v186, s45, v186
v_lshrrev_b32 v187, 3, v185
v_min_u32 v187, 1, v187
v_lshlrev_b32 v187, 5, v187
v_sub_u32 v187, v186, v187
v_add_u32 v187, 16, v187
v_lshl_add_u32 v187, v185, 6, v187
v_and_b32 v184, 3, v184
v_lshl_add_u32 v187, v187, 2, v184
v_lshlrev_b32 v245, 2, v187
v_lshrrev_b32 v187, 2, v185
v_lshrrev_b32 v188, 4, v186
v_lshl_add_u32 v187, v187, 1, v188
v_and_b32 v185, 3, v185
v_lshl_add_u32 v187, v187, 2, v185
v_and_b32 v186, 15, v186
v_lshl_add_u32 v187, v187, 4, v186
v_lshl_add_u32 v187, v187, 2, v184
v_lshlrev_b32 v253, 2, v187
v_add_u32 v184, 384, v1
v_mul_lo_u32 v185, v184, s46
v_lshrrev_b32 v185, 22, v185
v_mul_u32_u24 v186, 80, v185
v_sub_u32 v184, v184, v186
v_add_u32 v185, s44, v185
v_lshrrev_b32 v186, 2, v184
v_add_u32 v186, s45, v186
v_lshrrev_b32 v187, 3, v185
v_min_u32 v187, 1, v187
v_lshlrev_b32 v187, 5, v187
v_sub_u32 v187, v186, v187
v_add_u32 v187, 16, v187
v_lshl_add_u32 v187, v185, 6, v187
v_and_b32 v184, 3, v184
v_lshl_add_u32 v187, v187, 2, v184
v_lshlrev_b32 v246, 2, v187
v_lshrrev_b32 v187, 2, v185
v_lshrrev_b32 v188, 4, v186
v_lshl_add_u32 v187, v187, 1, v188
v_and_b32 v185, 3, v185
v_lshl_add_u32 v187, v187, 2, v185
v_and_b32 v186, 15, v186
v_lshl_add_u32 v187, v187, 4, v186
v_lshl_add_u32 v187, v187, 2, v184
v_lshlrev_b32 v254, 2, v187
v_subrev_u32 v184, 16, v1
v_add_u32 v184, s45, v184
v_lshlrev_b32 v184, 2, v184
v_add_u32 v185, 20480, v184
v_add_u32 v184, s49, v184
v_cmp_le_u32 s[40:41], 16, v1
s_nop 1
v_cndmask_b32 v246, v246, v185, s[40:41]
v_cndmask_b32 v254, v254, v184, s[40:41]
v_lshlrev_b32 v190, 10, v97
v_lshl_add_u32 v190, v96, 4, v190
v_add_u32 v190, s50, v190
v_lshlrev_b32 v191, 2, v96
v_add_u32 v191, s50, v191
s_nop 1
s_branch L_lp_kv_sequential_preLN__linear_attn_block__swiglu_ffn__prompt_kernel_r
L_lp_kv_sequential_preLN__linear_attn_block__swiglu_ffn__prompt_kernel_x6:
buffer_load_dword v118, v114, s[60:63], 0 offen sc1
s_branch L_lp_kv_sequential_preLN__linear_attn_block__swiglu_ffn__prompt_kernel_r
L_lp_kv_sequential_preLN__linear_attn_block__swiglu_ffn__prompt_kernel_x7:
s_waitcnt vmcnt(9)
v_readfirstlane_b32 s38, v118
s_nop 1
s_cmp_ge_u32 s38, 64
s_cbranch_scc1 L_spin_kv_sequential_preLN__linear_attn_block__swiglu_ffn__prompt_kernel_ok
s_mov_b32 s39, 0
L_spin_kv_sequential_preLN__linear_attn_block__swiglu_ffn__prompt_kernel_loop:
s_sleep 8
buffer_load_dword v118, v114, s[60:63], 0 offen sc1
s_waitcnt vmcnt(0)
v_readfirstlane_b32 s38, v118
s_add_u32 s39, s39, 1
s_cmp_ge_u32 s39, 0x40000
s_cbranch_scc1 L_spin_kv_sequential_preLN__linear_attn_block__swiglu_ffn__prompt_kernel_ok
s_cmp_lt_u32 s38, 64
s_cbranch_scc1 L_spin_kv_sequential_preLN__linear_attn_block__swiglu_ffn__prompt_kernel_loop
L_spin_kv_sequential_preLN__linear_attn_block__swiglu_ffn__prompt_kernel_ok:
s_nop 1
buffer_load_dword v157, v115, s[8:11], s43 offen sc1
buffer_load_dword v152, v116, s[8:11], s37 offen offset:0 sc1
buffer_load_dword v153, v116, s[8:11], s37 offen offset:128 sc1
buffer_load_dword v154, v117, s[8:11], s37 offen offset:256 sc1
buffer_load_dword v155, v116, s[8:11], s37 offen offset:2624 sc1
buffer_load_dword v156, v116, s[8:11], s37 offen offset:2752 sc1
buffer_load_dwordx4 v[120:123], v119, s[8:11], s36 offen offset:0 sc1
buffer_load_dwordx4 v[124:127], v119, s[8:11], s36 offen offset:32 sc1
buffer_load_dwordx4 v[128:131], v119, s[8:11], s36 offen offset:64 sc1
buffer_load_dwordx4 v[132:135], v119, s[8:11], s36 offen offset:96 sc1
s_branch L_lp_kv_sequential_preLN__linear_attn_block__swiglu_ffn__prompt_kernel_r
L_lp_kv_sequential_preLN__linear_attn_block__swiglu_ffn__prompt_kernel_x9:
s_waitcnt vmcnt(13)
v_cvt_pk_bf16_f32 v160, v152, v152
v_lshlrev_b32 v161, 16, v160
v_sub_f32 v161, v152, v161
v_cvt_pk_bf16_f32 v161, v161, 0
v_mov_b32 v162, 0
v_mov_b32 v163, 0
v_cvt_pk_bf16_f32 v164, v153, v153
v_lshlrev_b32 v165, 16, v164
v_sub_f32 v165, v153, v165
v_cvt_pk_bf16_f32 v165, v165, 0
v_mov_b32 v166, 0
v_mov_b32 v167, 0
v_cvt_pk_bf16_f32 v168, v154, v154
v_lshlrev_b32 v169, 16, v168
v_sub_f32 v169, v154, v169
v_cvt_pk_bf16_f32 v169, v169, 0
v_mov_b32 v170, 0
v_mov_b32 v171, 0
v_cvt_pk_bf16_f32 v172, v155, v155
v_lshlrev_b32 v173, 16, v172
v_sub_f32 v173, v155, v173
v_cvt_pk_bf16_f32 v173, v173, 0
v_mov_b32 v174, 0
v_mov_b32 v175, 0
v_cvt_pk_bf16_f32 v176, v156, v156
v_lshlrev_b32 v177, 16, v176
v_sub_f32 v177, v156, v177
v_cvt_pk_bf16_f32 v177, v177, 0
v_mov_b32 v178, 0
v_mov_b32 v179, 0
v_sub_f32 v157, 0, v157
v_cvt_pk_bf16_f32 v181, v157, 0
v_lshlrev_b32 v180, 16, v181
v_sub_f32 v180, v157, v180
v_cvt_pk_bf16_f32 v180, v157, v180
v_mov_b32 v182, 0
v_mov_b32 v183, 0
s_nop 1
s_branch L_lp_kv_sequential_preLN__linear_attn_block__swiglu_ffn__prompt_kernel_r
L_lp_kv_sequential_preLN__linear_attn_block__swiglu_ffn__prompt_kernel_done:
s_waitcnt vmcnt(0)
s_waitcnt lgkmcnt(0)
L_epi_kv_sequential_preLN__linear_attn_block__swiglu_ffn__prompt_kernel:
v_mov_b32 v184, 1.0
v_mov_b32 v185, 1.0
v_mov_b32 v186, s42
v_mov_b32 v187, s42
v_mov_b32 v188, 0x358637bd
v_mov_b32 v189, 0x358637bd
s_mov_b32 s40, 0x0000ffff
s_mov_b32 s41, 0x0000ffff
v_mfma_f32_32x32x16_bf16 v[16:31], v[180:183], v[160:163], v[16:31]
v_mfma_f32_32x32x16_bf16 v[48:63], v[180:183], v[168:171], v[48:63]
v_mfma_f32_32x32x16_bf16 v[64:79], v[180:183], v[172:175], v[64:79]
v_mfma_f32_32x32x16_bf16 v[80:95], v[180:183], v[176:179], v[80:95]
v_mfma_f32_32x32x16_bf16 v[32:47], v[180:183], v[164:167], v[32:47]
v_mov_b32 v232, 0x3f803f80
v_mov_b32 v233, 0x3f803f80
v_mov_b32 v234, 0x3f803f80
v_mov_b32 v235, 0x3f803f80
s_barrier
s_nop 2
v_pk_fma_f32 v[16:17], v[16:17], v[120:121], v[184:185]
v_pk_fma_f32 v[18:19], v[18:19], v[122:123], v[184:185]
v_pk_fma_f32 v[20:21], v[20:21], v[124:125], v[184:185]
v_pk_fma_f32 v[22:23], v[22:23], v[126:127], v[184:185]
v_pk_fma_f32 v[208:209], v[16:17], v[186:187], v[186:187] neg_lo:[0,0,1] neg_hi:[0,0,1]
v_pk_fma_f32 v[210:211], v[18:19], v[186:187], v[186:187] neg_lo:[0,0,1] neg_hi:[0,0,1]
v_pk_fma_f32 v[212:213], v[20:21], v[186:187], v[186:187] neg_lo:[0,0,1] neg_hi:[0,0,1]
v_pk_fma_f32 v[214:215], v[22:23], v[186:187], v[186:187] neg_lo:[0,0,1] neg_hi:[0,0,1]
v_exp_f32 v208, v208
v_exp_f32 v209, v209
v_exp_f32 v210, v210
v_exp_f32 v211, v211
v_exp_f32 v212, v212
v_exp_f32 v213, v213
v_exp_f32 v214, v214
v_exp_f32 v215, v215
v_med3_f32 v16, v208, v16, 1.0
v_med3_f32 v17, v209, v17, 1.0
v_med3_f32 v18, v210, v18, 1.0
v_med3_f32 v19, v211, v19, 1.0
v_med3_f32 v20, v212, v20, 1.0
v_med3_f32 v21, v213, v21, 1.0
v_med3_f32 v22, v214, v22, 1.0
v_med3_f32 v23, v215, v23, 1.0
v_pk_add_f32 v[16:17], v[16:17], v[188:189]
v_pk_add_f32 v[18:19], v[18:19], v[188:189]
v_pk_add_f32 v[20:21], v[20:21], v[188:189]
v_pk_add_f32 v[22:23], v[22:23], v[188:189]
v_cvt_pk_bf16_f32 v136, v16, v17
v_cvt_pk_bf16_f32 v137, v18, v19
v_cvt_pk_bf16_f32 v138, v20, v21
v_cvt_pk_bf16_f32 v139, v22, v23
v_pk_fma_f32 v[24:25], v[24:25], v[128:129], v[184:185]
v_pk_fma_f32 v[26:27], v[26:27], v[130:131], v[184:185]
v_pk_fma_f32 v[28:29], v[28:29], v[132:133], v[184:185]
v_pk_fma_f32 v[30:31], v[30:31], v[134:135], v[184:185]
v_pk_fma_f32 v[208:209], v[24:25], v[186:187], v[186:187] neg_lo:[0,0,1] neg_hi:[0,0,1]
v_pk_fma_f32 v[210:211], v[26:27], v[186:187], v[186:187] neg_lo:[0,0,1] neg_hi:[0,0,1]
v_pk_fma_f32 v[212:213], v[28:29], v[186:187], v[186:187] neg_lo:[0,0,1] neg_hi:[0,0,1]
v_pk_fma_f32 v[214:215], v[30:31], v[186:187], v[186:187] neg_lo:[0,0,1] neg_hi:[0,0,1]
v_exp_f32 v208, v208
v_exp_f32 v209, v209
v_exp_f32 v210, v210
v_exp_f32 v211, v211
v_exp_f32 v212, v212
v_exp_f32 v213, v213
v_exp_f32 v214, v214
v_exp_f32 v215, v215
v_med3_f32 v24, v208, v24, 1.0
v_med3_f32 v25, v209, v25, 1.0
v_med3_f32 v26, v210, v26, 1.0
v_med3_f32 v27, v211, v27, 1.0
v_med3_f32 v28, v212, v28, 1.0
v_med3_f32 v29, v213, v29, 1.0
v_med3_f32 v30, v214, v30, 1.0
v_med3_f32 v31, v215, v31, 1.0
v_pk_add_f32 v[24:25], v[24:25], v[188:189]
v_pk_add_f32 v[26:27], v[26:27], v[188:189]
v_pk_add_f32 v[28:29], v[28:29], v[188:189]
v_pk_add_f32 v[30:31], v[30:31], v[188:189]
v_cvt_pk_bf16_f32 v140, v24, v25
v_cvt_pk_bf16_f32 v141, v26, v27
v_cvt_pk_bf16_f32 v142, v28, v29
v_cvt_pk_bf16_f32 v143, v30, v31
v_pk_fma_f32 v[216:217], v[48:49], v[120:121], v[184:185]
v_pk_fma_f32 v[218:219], v[50:51], v[122:123], v[184:185]
v_pk_fma_f32 v[220:221], v[52:53], v[124:125], v[184:185]
v_pk_fma_f32 v[222:223], v[54:55], v[126:127], v[184:185]
v_pk_fma_f32 v[208:209], v[216:217], v[186:187], v[186:187] neg_lo:[0,0,1] neg_hi:[0,0,1]
v_pk_fma_f32 v[210:211], v[218:219], v[186:187], v[186:187] neg_lo:[0,0,1] neg_hi:[0,0,1]
v_pk_fma_f32 v[212:213], v[220:221], v[186:187], v[186:187] neg_lo:[0,0,1] neg_hi:[0,0,1]
v_pk_fma_f32 v[214:215], v[222:223], v[186:187], v[186:187] neg_lo:[0,0,1] neg_hi:[0,0,1]
v_exp_f32 v208, v208
v_exp_f32 v209, v209
v_exp_f32 v210, v210
v_exp_f32 v211, v211
v_exp_f32 v212, v212
v_exp_f32 v213, v213
v_exp_f32 v214, v214
v_exp_f32 v215, v215
v_med3_f32 v216, v208, v216, 1.0
v_med3_f32 v217, v209, v217, 1.0
v_med3_f32 v218, v210, v218, 1.0
v_med3_f32 v219, v211, v219, 1.0
v_med3_f32 v220, v212, v220, 1.0
v_med3_f32 v221, v213, v221, 1.0
v_med3_f32 v222, v214, v222, 1.0
v_med3_f32 v223, v215, v223, 1.0
v_pk_add_f32 v[216:217], v[216:217], v[188:189]
v_pk_add_f32 v[218:219], v[218:219], v[188:189]
v_pk_add_f32 v[220:221], v[220:221], v[188:189]
v_pk_add_f32 v[222:223], v[222:223], v[188:189]
v_pk_mul_f32 v[48:49], v[48:49], v[120:121]
v_pk_mul_f32 v[50:51], v[50:51], v[122:123]
v_pk_mul_f32 v[52:53], v[52:53], v[124:125]
v_pk_mul_f32 v[54:55], v[54:55], v[126:127]
v_cndmask_b32 v48, v48, v216, s[40:41]
v_cndmask_b32 v49, v49, v217, s[40:41]
v_cndmask_b32 v50, v50, v218, s[40:41]
v_cndmask_b32 v51, v51, v219, s[40:41]
v_cndmask_b32 v52, v52, v220, s[40:41]
v_cndmask_b32 v53, v53, v221, s[40:41]
v_cndmask_b32 v54, v54, v222, s[40:41]
v_cndmask_b32 v55, v55, v223, s[40:41]
v_cvt_pk_bf16_f32 v192, v48, v49
v_cvt_pk_bf16_f32 v193, v50, v51
v_cvt_pk_bf16_f32 v194, v52, v53
v_cvt_pk_bf16_f32 v195, v54, v55
v_pk_fma_f32 v[216:217], v[56:57], v[128:129], v[184:185]
v_pk_fma_f32 v[218:219], v[58:59], v[130:131], v[184:185]
v_pk_fma_f32 v[220:221], v[60:61], v[132:133], v[184:185]
v_pk_fma_f32 v[222:223], v[62:63], v[134:135], v[184:185]
v_pk_fma_f32 v[208:209], v[216:217], v[186:187], v[186:187] neg_lo:[0,0,1] neg_hi:[0,0,1]
v_pk_fma_f32 v[210:211], v[218:219], v[186:187], v[186:187] neg_lo:[0,0,1] neg_hi:[0,0,1]
v_pk_fma_f32 v[212:213], v[220:221], v[186:187], v[186:187] neg_lo:[0,0,1] neg_hi:[0,0,1]
v_pk_fma_f32 v[214:215], v[222:223], v[186:187], v[186:187] neg_lo:[0,0,1] neg_hi:[0,0,1]
v_exp_f32 v208, v208
v_exp_f32 v209, v209
v_exp_f32 v210, v210
v_exp_f32 v211, v211
v_exp_f32 v212, v212
v_exp_f32 v213, v213
v_exp_f32 v214, v214
v_exp_f32 v215, v215
v_med3_f32 v216, v208, v216, 1.0
v_med3_f32 v217, v209, v217, 1.0
v_med3_f32 v218, v210, v218, 1.0
v_med3_f32 v219, v211, v219, 1.0
v_med3_f32 v220, v212, v220, 1.0
v_med3_f32 v221, v213, v221, 1.0
v_med3_f32 v222, v214, v222, 1.0
v_med3_f32 v223, v215, v223, 1.0
v_pk_add_f32 v[216:217], v[216:217], v[188:189]
v_pk_add_f32 v[218:219], v[218:219], v[188:189]
v_pk_add_f32 v[220:221], v[220:221], v[188:189]
v_pk_add_f32 v[222:223], v[222:223], v[188:189]
v_pk_mul_f32 v[56:57], v[56:57], v[128:129]
v_pk_mul_f32 v[58:59], v[58:59], v[130:131]
v_pk_mul_f32 v[60:61], v[60:61], v[132:133]
v_pk_mul_f32 v[62:63], v[62:63], v[134:135]
v_cndmask_b32 v56, v56, v216, s[40:41]
v_cndmask_b32 v57, v57, v217, s[40:41]
v_cndmask_b32 v58, v58, v218, s[40:41]
v_cndmask_b32 v59, v59, v219, s[40:41]
v_cndmask_b32 v60, v60, v220, s[40:41]
v_cndmask_b32 v61, v61, v221, s[40:41]
v_cndmask_b32 v62, v62, v222, s[40:41]
v_cndmask_b32 v63, v63, v223, s[40:41]
v_cvt_pk_bf16_f32 v196, v56, v57
v_cvt_pk_bf16_f32 v197, v58, v59
v_cvt_pk_bf16_f32 v198, v60, v61
v_cvt_pk_bf16_f32 v199, v62, v63
v_mfma_f32_32x32x16_bf16 v[16:31], v[136:139], v[192:195], 0
v_pk_mul_f32 v[64:65], v[64:65], v[120:121]
v_pk_mul_f32 v[66:67], v[66:67], v[122:123]
v_pk_mul_f32 v[68:69], v[68:69], v[124:125]
v_pk_mul_f32 v[70:71], v[70:71], v[126:127]
v_cvt_pk_bf16_f32 v200, v64, v65
v_mfma_f32_32x32x16_bf16 v[16:31], v[140:143], v[196:199], v[16:31]
v_cvt_pk_bf16_f32 v201, v66, v67
v_cvt_pk_bf16_f32 v202, v68, v69
v_cvt_pk_bf16_f32 v203, v70, v71
v_pk_mul_f32 v[72:73], v[72:73], v[128:129]
v_pk_mul_f32 v[74:75], v[74:75], v[130:131]
v_mfma_f32_32x32x16_bf16 v[160:175], v[232:235], v[136:139], 0
v_pk_mul_f32 v[76:77], v[76:77], v[132:133]
v_pk_mul_f32 v[78:79], v[78:79], v[134:135]
v_cvt_pk_bf16_f32 v204, v72, v73
v_cvt_pk_bf16_f32 v205, v74, v75
v_cvt_pk_bf16_f32 v206, v76, v77
v_cvt_pk_bf16_f32 v207, v78, v79
v_mfma_f32_32x32x16_bf16 v[160:175], v[232:235], v[140:143], v[160:175]
v_pk_mul_f32 v[80:81], v[80:81], v[120:121]
v_pk_mul_f32 v[82:83], v[82:83], v[122:123]
v_pk_mul_f32 v[84:85], v[84:85], v[124:125]
v_pk_mul_f32 v[86:87], v[86:87], v[126:127]
v_cvt_pk_bf16_f32 v224, v80, v81
v_mfma_f32_32x32x16_bf16 v[48:63], v[232:235], v[192:195], 0
v_cvt_pk_bf16_f32 v225, v82, v83
v_cvt_pk_bf16_f32 v226, v84, v85
v_cvt_pk_bf16_f32 v227, v86, v87
v_pk_mul_f32 v[88:89], v[88:89], v[128:129]
v_pk_mul_f32 v[90:91], v[90:91], v[130:131]
v_mfma_f32_32x32x16_bf16 v[48:63], v[232:235], v[196:199], v[48:63]
v_pk_mul_f32 v[92:93], v[92:93], v[132:133]
v_pk_mul_f32 v[94:95], v[94:95], v[134:135]
v_cvt_pk_bf16_f32 v228, v88, v89
v_cvt_pk_bf16_f32 v229, v90, v91
v_cvt_pk_bf16_f32 v230, v92, v93
v_cvt_pk_bf16_f32 v231, v94, v95
v_mfma_f32_32x32x16_bf16 v[64:79], v[136:139], v[200:203], 0
v_pk_fma_f32 v[32:33], v[32:33], v[120:121], v[184:185]
v_pk_fma_f32 v[34:35], v[34:35], v[122:123], v[184:185]
v_pk_fma_f32 v[36:37], v[36:37], v[124:125], v[184:185]
v_pk_fma_f32 v[38:39], v[38:39], v[126:127], v[184:185]
v_pk_fma_f32 v[208:209], v[32:33], v[186:187], v[186:187] neg_lo:[0,0,1] neg_hi:[0,0,1]
v_pk_fma_f32 v[210:211], v[34:35], v[186:187], v[186:187] neg_lo:[0,0,1] neg_hi:[0,0,1]
v_pk_fma_f32 v[212:213], v[36:37], v[186:187], v[186:187] neg_lo:[0,0,1] neg_hi:[0,0,1]
v_pk_fma_f32 v[214:215], v[38:39], v[186:187], v[186:187] neg_lo:[0,0,1] neg_hi:[0,0,1]
v_mfma_f32_32x32x16_bf16 v[64:79], v[140:143], v[204:207], v[64:79]
v_exp_f32 v208, v208
v_exp_f32 v209, v209
ds_write_b128 v190, v[16:19] offset:0
v_exp_f32 v210, v210
v_exp_f32 v211, v211
v_exp_f32 v212, v212
v_exp_f32 v213, v213
v_exp_f32 v214, v214
v_mfma_f32_32x32x16_bf16 v[80:95], v[192:195], v[224:227], 0
v_exp_f32 v215, v215
v_med3_f32 v32, v208, v32, 1.0
v_med3_f32 v33, v209, v33, 1.0
v_med3_f32 v34, v210, v34, 1.0
v_med3_f32 v35, v211, v35, 1.0
ds_write_b128 v190, v[20:23] offset:2048
v_med3_f32 v36, v212, v36, 1.0
v_med3_f32 v37, v213, v37, 1.0
v_mfma_f32_32x32x16_bf16 v[80:95], v[196:199], v[228:231], v[80:95]
v_med3_f32 v38, v214, v38, 1.0
v_med3_f32 v39, v215, v39, 1.0
v_pk_add_f32 v[32:33], v[32:33], v[188:189]
v_pk_add_f32 v[34:35], v[34:35], v[188:189]
v_pk_add_f32 v[36:37], v[36:37], v[188:189]
v_pk_add_f32 v[38:39], v[38:39], v[188:189]
v_cvt_pk_bf16_f32 v144, v32, v33
v_cvt_pk_bf16_f32 v145, v34, v35
ds_write_b128 v190, v[24:27] offset:4096
v_cvt_pk_bf16_f32 v146, v36, v37
v_cvt_pk_bf16_f32 v147, v38, v39
v_pk_fma_f32 v[40:41], v[40:41], v[128:129], v[184:185]
v_pk_fma_f32 v[42:43], v[42:43], v[130:131], v[184:185]
v_pk_fma_f32 v[44:45], v[44:45], v[132:133], v[184:185]
v_pk_fma_f32 v[46:47], v[46:47], v[134:135], v[184:185]
ds_write_b32 v191, v160 offset:20480
v_pk_fma_f32 v[208:209], v[40:41], v[186:187], v[186:187] neg_lo:[0,0,1] neg_hi:[0,0,1]
v_pk_fma_f32 v[210:211], v[42:43], v[186:187], v[186:187] neg_lo:[0,0,1] neg_hi:[0,0,1]
v_pk_fma_f32 v[212:213], v[44:45], v[186:187], v[186:187] neg_lo:[0,0,1] neg_hi:[0,0,1]
v_pk_fma_f32 v[214:215], v[46:47], v[186:187], v[186:187] neg_lo:[0,0,1] neg_hi:[0,0,1]
v_exp_f32 v208, v208
v_exp_f32 v209, v209
ds_write_b32 v191, v48 offset:20736
v_exp_f32 v210, v210
v_exp_f32 v211, v211
v_exp_f32 v212, v212
v_exp_f32 v213, v213
v_exp_f32 v214, v214
ds_write_b128 v190, v[64:67] offset:512
v_exp_f32 v215, v215
v_med3_f32 v40, v208, v40, 1.0
v_med3_f32 v41, v209, v41, 1.0
v_med3_f32 v42, v210, v42, 1.0
v_med3_f32 v43, v211, v43, 1.0
v_med3_f32 v44, v212, v44, 1.0
ds_write_b128 v190, v[68:71] offset:2560
v_med3_f32 v45, v213, v45, 1.0
v_med3_f32 v46, v214, v46, 1.0
v_med3_f32 v47, v215, v47, 1.0
v_pk_add_f32 v[40:41], v[40:41], v[188:189]
v_pk_add_f32 v[42:43], v[42:43], v[188:189]
v_pk_add_f32 v[44:45], v[44:45], v[188:189]
ds_write_b128 v190, v[72:75] offset:4608
v_pk_add_f32 v[46:47], v[46:47], v[188:189]
v_cvt_pk_bf16_f32 v148, v40, v41
v_cvt_pk_bf16_f32 v149, v42, v43
v_cvt_pk_bf16_f32 v150, v44, v45
v_cvt_pk_bf16_f32 v151, v46, v47
ds_write_b128 v190, v[76:79] offset:6656
v_mfma_f32_32x32x16_bf16 v[32:47], v[144:147], v[200:203], 0
v_mfma_f32_32x32x16_bf16 v[32:47], v[148:151], v[204:207], v[32:47]
v_mfma_f32_32x32x16_bf16 v[100:115], v[144:147], v[224:227], 0
ds_write_b128 v190, v[80:83] offset:16896
v_mfma_f32_32x32x16_bf16 v[100:115], v[148:151], v[228:231], v[100:115]
v_mfma_f32_32x32x16_bf16 v[48:63], v[232:235], v[144:147], 0
v_mfma_f32_32x32x16_bf16 v[48:63], v[232:235], v[148:151], v[48:63]
ds_write_b128 v190, v[84:87] offset:18944
s_nop 5
ds_write_b128 v190, v[32:35] offset:8192
ds_write_b128 v190, v[36:39] offset:10240
ds_write_b128 v190, v[40:43] offset:12288
ds_write_b128 v190, v[44:47] offset:14336
s_waitcnt lgkmcnt(14)
ds_write_b128 v190, v[104:107] offset:10752
s_waitcnt lgkmcnt(14)
ds_write_b128 v190, v[108:111] offset:12800
s_waitcnt lgkmcnt(14)
ds_write_b128 v190, v[112:115] offset:14848
s_waitcnt lgkmcnt(14)
ds_write_b32 v191, v48 offset:20608
v_add_u32 v136, 115712, v240
v_add_u32 v144, 73728, v240
v_add_u32 v137, 115712, v241
v_add_u32 v145, 73728, v241
v_add_u32 v138, 115712, v242
v_add_u32 v146, 73728, v242
v_add_u32 v139, 115712, v243
v_add_u32 v147, 73728, v243
v_add_u32 v140, 115712, v244
v_add_u32 v148, 73728, v244
v_add_u32 v141, 115712, v245
v_add_u32 v149, 73728, v245
v_add_u32 v142, 115712, v246
v_add_u32 v150, 73728, v246
s_waitcnt lgkmcnt(0)
s_barrier
ds_read_b32 v32, v144 offset:0
ds_read_b32 v33, v144 offset:20992
ds_read_b32 v34, v136 offset:0
ds_read_b32 v35, v136 offset:20992
ds_read_b32 v36, v145 offset:0
ds_read_b32 v37, v145 offset:20992
ds_read_b32 v38, v137 offset:0
ds_read_b32 v39, v137 offset:20992
ds_read_b32 v40, v146 offset:0
ds_read_b32 v41, v146 offset:20992
ds_read_b32 v42, v138 offset:0
ds_read_b32 v43, v138 offset:20992
ds_read_b32 v44, v147 offset:0
ds_read_b32 v45, v147 offset:20992
ds_read_b32 v46, v139 offset:0
s_waitcnt lgkmcnt(14)
ds_read_b32 v47, v139 offset:20992
s_waitcnt lgkmcnt(14)
ds_read_b32 v48, v148 offset:0
s_waitcnt lgkmcnt(14)
ds_read_b32 v49, v148 offset:20992
s_waitcnt lgkmcnt(14)
ds_read_b32 v50, v140 offset:0
s_waitcnt lgkmcnt(14)
ds_read_b32 v51, v140 offset:20992
s_waitcnt lgkmcnt(14)
ds_read_b32 v52, v149 offset:0
s_waitcnt lgkmcnt(14)
ds_read_b32 v53, v149 offset:20992
s_waitcnt lgkmcnt(14)
ds_read_b32 v54, v141 offset:0
s_waitcnt lgkmcnt(14)
ds_read_b32 v55, v141 offset:20992
s_waitcnt lgkmcnt(14)
ds_read_b32 v56, v150 offset:0
s_waitcnt lgkmcnt(14)
ds_read_b32 v57, v150 offset:20992
s_waitcnt lgkmcnt(14)
ds_read_b32 v58, v142 offset:0
s_waitcnt lgkmcnt(14)
ds_read_b32 v59, v142 offset:20992
v_add_f32 v32, v32, v33
v_add_f32 v34, v34, v35
v_add_f32 v32, v32, v34
buffer_atomic_add_f32 v32, v248, s[8:11], s48 offen
v_add_f32 v36, v36, v37
v_add_f32 v38, v38, v39
v_add_f32 v36, v36, v38
buffer_atomic_add_f32 v36, v249, s[8:11], s48 offen
v_add_f32 v40, v40, v41
v_add_f32 v42, v42, v43
v_add_f32 v40, v40, v42
buffer_atomic_add_f32 v40, v250, s[8:11], s48 offen
s_waitcnt lgkmcnt(14)
v_add_f32 v44, v44, v45
s_waitcnt lgkmcnt(12)
v_add_f32 v46, v46, v47
v_add_f32 v44, v44, v46
buffer_atomic_add_f32 v44, v251, s[8:11], s48 offen
s_waitcnt lgkmcnt(10)
v_add_f32 v48, v48, v49
s_waitcnt lgkmcnt(8)
v_add_f32 v50, v50, v51
v_add_f32 v48, v48, v50
buffer_atomic_add_f32 v48, v252, s[8:11], s48 offen
s_waitcnt lgkmcnt(6)
v_add_f32 v52, v52, v53
s_waitcnt lgkmcnt(4)
v_add_f32 v54, v54, v55
v_add_f32 v52, v52, v54
buffer_atomic_add_f32 v52, v253, s[8:11], s48 offen
s_waitcnt lgkmcnt(2)
v_add_f32 v56, v56, v57
s_waitcnt lgkmcnt(0)
v_add_f32 v58, v58, v59
v_add_f32 v56, v56, v58
s_mov_b32 exec_hi, 15
buffer_atomic_add_f32 v56, v254, s[8:11], s48 offen
s_mov_b64 exec, -1
L_fin_sequential_preLN__linear_attn_block__swiglu_ffn__prompt_kernel:
s_nop 12
s_load_dwordx2 s[4:5], s[0:1], 72
s_load_dwordx2 s[6:7], s[0:1], 0
s_load_dwordx2 s[52:53], s[0:1], 56
s_waitcnt vmcnt(0)
s_barrier
s_lshl_b32 s78, s2, 2
s_add_u32 s78, s78, 19927040
s_cmp_eq_u32 s16, 0
s_mov_b32 s20, 0x7f000000
s_cselect_b32 s20, s78, s20
s_mov_b32 s21, 69888
v_mul_lo_u32 v10, v1, s21
v_mov_b32 v11, 1
s_mov_b64 exec, 0xffff
buffer_store_dword v11, v10, s[8:11], s20 offen sc1
s_mov_b64 exec, -1
s_and_b32 s19, s2, 7
s_lshr_b32 s20, s2, 3
s_lshr_b32 s62, s20, 3
s_and_b32 s18, s20, 7
s_lshr_b32 s60, s19, 1
s_lshl_b32 s60, s60, 2
s_add_u32 s60, s60, s62
s_and_b32 s21, s19, 1
s_lshl_b32 s17, s60, 1
s_add_u32 s17, s17, s21
s_lshl_b32 s61, s21, 3
s_add_u32 s61, s61, s18
s_lshl_b32 s64, s60, 7
s_lshl_b32 s63, s61, 2
s_add_u32 s63, s63, s64
s_mul_i32 s59, s61, 286720
s_add_u32 s59, s59, 13160448
s_mul_i32 s67, s16, 10240
s_mul_i32 s66, s16, 5120
s_add_u32 s66, s66, s59
s_add_u32 s59, s59, s67
s_and_b32 s57, s61, 1
s_mov_b32 s56, 0x7f000000
s_mul_i32 s22, s57, 40960
s_add_u32 s66, s66, s22
s_xor_b32 s22, s57, 1
s_mul_i32 s22, s22, 245760
s_add_u32 s59, s59, s22
s_mul_i32 s21, s16, 14
s_mul_i32 s70, s17, 54
s_add_u32 s70, s70, s21
s_lshl_b32 s70, s70, 12
s_add_u32 s70, s70, 5242880
s_mul_i32 s71, s18, 270
s_add_u32 s71, s71, s21
s_lshl_b32 s71, s71, 10
s_add_u32 s71, s71, 17584128
s_cmp_eq_u32 s16, 3
s_cselect_b32 s72, s56, s71
s_cselect_b32 s74, s56, s70
s_mov_b32 s19, 0
s_add_u32 s19, s19, s16
s_and_b32 s19, s19, 3
v_lshlrev_b32 v2, 4, v1
v_add_u32 v3, 0x1000, v2
v_lshrrev_b32 v8, 4, v1
v_lshlrev_b32 v157, 4, v8
s_mul_i32 s22, s19, 5
s_mul_i32 s27, s19, 26624
s_add_u32 s27, s27, 19795968
s_mul_i32 s28, s19, 640
s_add_u32 s28, s28, 19902464
s_waitcnt lgkmcnt(0)
s_mov_b32 s8, s4
s_and_b32 s9, s5, 0xffff
s_mov_b32 s10, 268435456
s_mov_b32 s11, 0x20000
v_mov_b32 v15, 0x7f000000
s_mul_i32 s22, s16, 5
s_mov_b32 s12, s6
s_and_b32 s13, s7, 0xffff
s_mov_b32 s14, 2621440
s_mov_b32 s15, 0x20000
s_mov_b32 s36, s4
s_and_b32 s37, s5, 0xffff
s_mov_b32 s38, 17584128
s_mov_b32 s39, 0x20000
s_mov_b32 s96, s52
s_and_b32 s97, s53, 0xffff
s_mov_b32 s98, 2621440
s_mov_b32 s99, 0x20000
s_add_u32 s23, s16, 1
s_and_b32 s23, s23, 3
s_lshl_b32 s23, s23, 10
v_add_u32 v4, s23, v2
s_add_u32 s23, s16, 2
s_and_b32 s23, s23, 3
s_lshl_b32 s23, s23, 10
v_add_u32 v5, s23, v2
s_add_u32 s23, s16, 3
s_and_b32 s23, s23, 3
s_lshl_b32 s23, s23, 10
v_add_u32 v6, s23, v2
s_add_u32 s23, s16, 0
s_and_b32 s23, s23, 3
s_lshl_b32 s23, s23, 10
v_add_u32 v7, s23, v2
s_mul_i32 s24, s17, 20
s_add_u32 s24, s24, s22
s_lshl_b32 s24, s24, 12
s_add_u32 s24, s24, 0
s_mul_i32 s25, s18, 100
s_add_u32 s25, s25, s22
s_lshl_b32 s25, s25, 10
s_add_u32 s25, s25, 12320768
s_lshl_b32 s26, s22, 10
s_add_u32 s26, s26, 13139968
s_mul_i32 s75, s60, 69888
s_add_u32 s75, s75, 19927040
v_lshlrev_b32 v10, 2, v1
v_and_b32 v11, 12, v10
s_cmp_lg_u32 s16, 0
s_cbranch_scc1 L_g0_w
s_mov_b32 s21, 0
L_g0_p:
buffer_load_dword v12, v10, s[8:11], s75 offen offset:1024 sc1
s_waitcnt vmcnt(0)
v_cmp_ne_u32 vcc, 1, v12
s_add_u32 s21, s21, 1
s_cmp_ge_u32 s21, 0x40000
s_cbranch_scc1 L_g0_w
s_cbranch_vccz L_g0_w
s_sleep 8
s_branch L_g0_p
L_g0_w:
s_barrier
s_nop 1
s_add_u32 s30, s25, 0
buffer_load_dwordx4 a[96:99], v2, s[8:11], s30 offen offset:0 sc1
buffer_load_dwordx4 a[120:123], v2, s[8:11], s30 offen offset:1024 sc1
buffer_load_dwordx4 a[144:147], v2, s[8:11], s30 offen offset:2048 sc1
buffer_load_dwordx4 a[168:171], v2, s[8:11], s30 offen offset:3072 sc1
buffer_load_dwordx4 a[192:195], v3, s[8:11], s30 offen offset:0 sc1
s_add_u32 s30, s25, 20480
buffer_load_dwordx4 a[100:103], v2, s[8:11], s30 offen offset:0 sc1
buffer_load_dwordx4 a[124:127], v2, s[8:11], s30 offen offset:1024 sc1
buffer_load_dwordx4 a[148:151], v2, s[8:11], s30 offen offset:2048 sc1
buffer_load_dwordx4 a[172:175], v2, s[8:11], s30 offen offset:3072 sc1
buffer_load_dwordx4 a[196:199], v3, s[8:11], s30 offen offset:0 sc1
s_add_u32 s30, s25, 40960
buffer_load_dwordx4 a[104:107], v2, s[8:11], s30 offen offset:0 sc1
buffer_load_dwordx4 a[128:131], v2, s[8:11], s30 offen offset:1024 sc1
buffer_load_dwordx4 a[152:155], v2, s[8:11], s30 offen offset:2048 sc1
buffer_load_dwordx4 a[176:179], v2, s[8:11], s30 offen offset:3072 sc1
buffer_load_dwordx4 a[200:203], v3, s[8:11], s30 offen offset:0 sc1
s_add_u32 s30, s25, 61440
buffer_load_dwordx4 a[108:111], v2, s[8:11], s30 offen offset:0 sc1
buffer_load_dwordx4 a[132:135], v2, s[8:11], s30 offen offset:1024 sc1
buffer_load_dwordx4 a[156:159], v2, s[8:11], s30 offen offset:2048 sc1
buffer_load_dwordx4 a[180:183], v2, s[8:11], s30 offen offset:3072 sc1
buffer_load_dwordx4 a[204:207], v3, s[8:11], s30 offen offset:0 sc1
s_add_u32 s30, s25, 81920
buffer_load_dwordx4 a[112:115], v2, s[8:11], s30 offen offset:0 sc1
buffer_load_dwordx4 a[136:139], v2, s[8:11], s30 offen offset:1024 sc1
buffer_load_dwordx4 a[160:163], v2, s[8:11], s30 offen offset:2048 sc1
buffer_load_dwordx4 a[184:187], v2, s[8:11], s30 offen offset:3072 sc1
buffer_load_dwordx4 a[208:211], v3, s[8:11], s30 offen offset:0 sc1
s_add_u32 s30, s26, 0
buffer_load_dwordx4 a[116:119], v2, s[8:11], s30 offen offset:0 sc1
buffer_load_dwordx4 a[140:143], v2, s[8:11], s30 offen offset:1024 sc1
buffer_load_dwordx4 a[164:167], v2, s[8:11], s30 offen offset:2048 sc1
buffer_load_dwordx4 a[188:191], v2, s[8:11], s30 offen offset:3072 sc1
buffer_load_dwordx4 a[212:215], v3, s[8:11], s30 offen offset:0 sc1
s_mov_b32 s40, 0xffff0000
s_mov_b32 s41, 0xffffffff
s_cmp_lg_u32 s16, 0
s_cbranch_scc1 L_gp_w
s_mov_b32 s21, 0
L_gp_p:
buffer_load_dwordx4 v[10:13], v2, s[8:11], s75 offen sc1
s_waitcnt vmcnt(0)
v_and_b32 v10, v10, v11
v_and_b32 v10, v10, v12
v_and_b32 v10, v10, v13
v_cmp_ne_u32 vcc, 1, v10
s_add_u32 s21, s21, 1
s_cmp_ge_u32 s21, 0x40000
s_cbranch_scc1 L_gp_w
s_and_b64 vcc, vcc, s[40:41]
s_cbranch_scc0 L_gp_w
s_sleep 8
s_branch L_gp_p
L_gp_w:
s_barrier
s_nop 1
buffer_load_dwordx4 v[120:123], v157, s[8:11], s28 offen offset:0 sc1
buffer_load_dwordx4 v[124:127], v157, s[8:11], s28 offen offset:64 sc1
buffer_load_dwordx4 v[128:131], v157, s[8:11], s28 offen offset:128 sc1
buffer_load_dwordx4 v[132:135], v157, s[8:11], s28 offen offset:192 sc1
buffer_load_dwordx4 v[136:139], v157, s[8:11], s28 offen offset:256 sc1
s_add_u32 s29, s27, 0
buffer_load_dwordx4 v[16:19], v2, s[8:11], s29 offen offset:0 sc1
s_mov_b32 s30, 0x000f000f
s_mov_b32 s31, 0x000f000f
v_cndmask_b32 v10, v15, v2, s[30:31]
buffer_load_dwordx4 v[20:23], v10, s[8:11], s29 offen offset:1024 sc1
s_mov_b32 s30, 0x0000ffff
s_mov_b32 s31, 0x00000000
v_cndmask_b32 v11, v15, v2, s[30:31]
buffer_load_dwordx4 v[24:27], v11, s[8:11], s29 offen offset:2048 sc1
buffer_load_dwordx4 v[28:31], v2, s[8:11], s29 offen offset:3072 sc1
s_mov_b32 s30, 0x00ff0000
s_mov_b32 s31, 0x00ff00ff
v_cndmask_b32 v13, v15, v3, s[30:31]
buffer_load_dwordx4 v[32:35], v13, s[8:11], s29 offen offset:0 sc1
s_mov_b32 s30, 0xfff0fff0
s_mov_b32 s31, 0x00000000
v_cndmask_b32 v9, v15, v3, s[30:31]
buffer_load_dwordx4 v[36:39], v9, s[8:11], s29 offen offset:1024 sc1
buffer_load_dwordx4 v[40:43], v3, s[8:11], s29 offen offset:2048 sc1
s_mov_b32 s30, 0x00000000
s_mov_b32 s31, 0x0fff0fff
v_cndmask_b32 v11, v15, v3, s[30:31]
buffer_load_dwordx4 v[44:47], v11, s[8:11], s29 offen offset:3072 sc1
s_add_u32 s29, s27, 8192
s_mov_b32 s30, 0xff00ff00
s_mov_b32 s31, 0x0000ff00
v_cndmask_b32 v12, v15, v2, s[30:31]
buffer_load_dwordx4 v[48:51], v12, s[8:11], s29 offen offset:0 sc1
buffer_load_dwordx4 v[52:55], v2, s[8:11], s29 offen offset:1024 sc1
s_mov_b32 s30, 0x00000000
s_mov_b32 s31, 0xffff0000
v_cndmask_b32 v9, v15, v2, s[30:31]
buffer_load_dwordx4 v[56:59], v9, s[8:11], s29 offen offset:2048 sc1
s_mov_b32 s30, 0xf000f000
s_mov_b32 s31, 0xf000f000
v_cndmask_b32 v10, v15, v2, s[30:31]
buffer_load_dwordx4 v[60:63], v10, s[8:11], s29 offen offset:3072 sc1
buffer_load_dwordx4 v[64:67], v3, s[8:11], s29 offen offset:0 sc1
s_add_u32 s29, s24, 0
buffer_load_dwordx4 a[216:219], v4, s[8:11], s29 offen sc1
s_add_u32 s29, s24, 4096
buffer_load_dwordx4 a[220:223], v4, s[8:11], s29 offen sc1
s_add_u32 s29, s24, 8192
buffer_load_dwordx4 a[224:227], v4, s[8:11], s29 offen sc1
s_add_u32 s29, s24, 12288
buffer_load_dwordx4 a[228:231], v4, s[8:11], s29 offen sc1
s_add_u32 s29, s24, 16384
buffer_load_dwordx4 a[232:235], v4, s[8:11], s29 offen sc1
buffer_load_dwordx4 v[140:143], v157, s[8:11], s28 offen offset:320 sc1
buffer_load_dwordx4 v[144:147], v157, s[8:11], s28 offen offset:384 sc1
buffer_load_dwordx4 v[148:151], v157, s[8:11], s28 offen offset:448 sc1
buffer_load_dwordx4 v[152:155], v157, s[8:11], s28 offen offset:512 sc1
buffer_load_dwordx4 v[156:159], v157, s[8:11], s28 offen offset:576 sc1
s_add_u32 s29, s27, 8192
buffer_load_dwordx4 v[68:71], v3, s[8:11], s29 offen offset:1024 sc1
s_mov_b32 s30, 0x000f000f
s_mov_b32 s31, 0x000f000f
v_cndmask_b32 v13, v15, v3, s[30:31]
buffer_load_dwordx4 v[72:75], v13, s[8:11], s29 offen offset:2048 sc1
s_mov_b32 s30, 0x0000ffff
s_mov_b32 s31, 0x00000000
v_cndmask_b32 v9, v15, v3, s[30:31]
buffer_load_dwordx4 v[76:79], v9, s[8:11], s29 offen offset:3072 sc1
s_add_u32 s29, s27, 16384
buffer_load_dwordx4 v[80:83], v2, s[8:11], s29 offen offset:0 sc1
s_mov_b32 s30, 0x00ff0000
s_mov_b32 s31, 0x00ff00ff
v_cndmask_b32 v11, v15, v2, s[30:31]
s_waitcnt vmcnt(62)
buffer_load_dwordx4 v[84:87], v11, s[8:11], s29 offen offset:1024 sc1
s_mov_b32 s30, 0xfff0fff0
s_mov_b32 s31, 0x00000000
v_cndmask_b32 v12, v15, v2, s[30:31]
s_waitcnt vmcnt(62)
buffer_load_dwordx4 v[88:91], v12, s[8:11], s29 offen offset:2048 sc1
s_waitcnt vmcnt(62)
buffer_load_dwordx4 v[92:95], v2, s[8:11], s29 offen offset:3072 sc1
s_mov_b32 s30, 0x00000000
s_mov_b32 s31, 0x0fff0fff
v_cndmask_b32 v9, v15, v3, s[30:31]
s_waitcnt vmcnt(62)
buffer_load_dwordx4 v[96:99], v9, s[8:11], s29 offen offset:0 sc1
s_mov_b32 s30, 0xff00ff00
s_mov_b32 s31, 0x0000ff00
v_cndmask_b32 v10, v15, v3, s[30:31]
s_waitcnt vmcnt(62)
buffer_load_dwordx4 v[100:103], v10, s[8:11], s29 offen offset:1024 sc1
s_waitcnt vmcnt(62)
buffer_load_dwordx4 v[104:107], v3, s[8:11], s29 offen offset:2048 sc1
s_mov_b32 s30, 0x00000000
s_mov_b32 s31, 0xffff0000
v_cndmask_b32 v12, v15, v3, s[30:31]
s_waitcnt vmcnt(62)
buffer_load_dwordx4 v[108:111], v12, s[8:11], s29 offen offset:3072 sc1
s_add_u32 s29, s27, 24576
s_mov_b32 s30, 0xf000f000
s_mov_b32 s31, 0xf000f000
v_cndmask_b32 v13, v15, v2, s[30:31]
s_waitcnt vmcnt(62)
buffer_load_dwordx4 v[112:115], v13, s[8:11], s29 offen offset:0 sc1
s_waitcnt vmcnt(62)
buffer_load_dwordx4 v[116:119], v2, s[8:11], s29 offen offset:1024 sc1
s_add_u32 s29, s24, 0
s_waitcnt vmcnt(62)
buffer_load_dwordx4 a[236:239], v5, s[8:11], s29 offen sc1
s_add_u32 s29, s24, 4096
s_waitcnt vmcnt(62)
buffer_load_dwordx4 a[240:243], v5, s[8:11], s29 offen sc1
s_add_u32 s29, s24, 8192
s_waitcnt vmcnt(62)
buffer_load_dwordx4 a[244:247], v5, s[8:11], s29 offen sc1
s_add_u32 s29, s24, 12288
s_waitcnt vmcnt(62)
buffer_load_dwordx4 a[248:251], v5, s[8:11], s29 offen sc1
s_add_u32 s29, s24, 16384
s_waitcnt vmcnt(62)
buffer_load_dwordx4 a[252:255], v5, s[8:11], s29 offen sc1
s_mov_b32 s40, 0x11111111
s_mov_b32 s41, 0x11111111
s_mov_b32 s42, 0x22221111
s_mov_b32 s43, 0x22222222
s_mov_b32 s44, 0x22222222
s_mov_b32 s45, 0x44444444
s_mov_b32 s46, 0x44444444
s_mov_b32 s47, 0x88884444
s_mov_b32 s48, 0x88888888
s_mov_b32 s49, 0x88888888
s_mov_b32 s50, 0xffff0000
s_mov_b32 s51, 0xffffffff
s_mov_b32 s52, 0x00000000
s_mov_b32 s53, 0xffffffff
s_mov_b32 s54, 0x00000000
s_mov_b32 s55, 0xffff0000
s_mov_b32 s32, 0x358637bd
s_mov_b32 s33, 0x358637bd
s_waitcnt vmcnt(45)
v_cvt_pk_bf16_f32 v232, v120, v121
v_cvt_pk_bf16_f32 v233, v122, v123
v_cndmask_b32 v232, 0, v232, s[40:41]
s_add_u32 s29, s24, 0
s_add_u32 s68, s67, 0
s_mov_b32 m0, s68
v_cndmask_b32 v233, 0, v233, s[40:41]
s_waitcnt vmcnt(44)
v_cvt_pk_bf16_f32 v234, v124, v125
buffer_load_dwordx4 v6, s[8:11], s29 offen sc1 lds
v_cvt_pk_bf16_f32 v235, v126, v127
v_cndmask_b32 v234, 0, v234, s[42:43]
s_add_u32 s29, s24, 4096
s_add_u32 s68, s67, 1024
s_mov_b32 m0, s68
v_cndmask_b32 v235, 0, v235, s[42:43]
s_waitcnt vmcnt(44)
v_cvt_pk_bf16_f32 v236, v128, v129
buffer_load_dwordx4 v6, s[8:11], s29 offen sc1 lds
v_cvt_pk_bf16_f32 v237, v130, v131
v_cndmask_b32 v236, 0, v236, s[44:45]
s_add_u32 s29, s24, 8192
s_add_u32 s68, s67, 2048
s_mov_b32 m0, s68
v_cndmask_b32 v237, 0, v237, s[44:45]
s_waitcnt vmcnt(44)
v_cvt_pk_bf16_f32 v238, v132, v133
v_cvt_pk_bf16_f32 v239, v134, v135
buffer_load_dwordx4 v6, s[8:11], s29 offen sc1 lds
v_cndmask_b32 v238, 0, v238, s[46:47]
v_cndmask_b32 v239, 0, v239, s[46:47]
s_add_u32 s29, s24, 12288
s_add_u32 s68, s67, 3072
s_mov_b32 m0, s68
s_waitcnt vmcnt(44)
v_cvt_pk_bf16_f32 v240, v136, v137
v_cvt_pk_bf16_f32 v241, v138, v139
buffer_load_dwordx4 v6, s[8:11], s29 offen sc1 lds
v_cndmask_b32 v240, 0, v240, s[48:49]
v_cndmask_b32 v241, 0, v241, s[48:49]
s_add_u32 s29, s24, 16384
s_add_u32 s68, s67, 4096
s_mov_b32 m0, s68
v_mov_b32 v242, 0
v_mov_b32 v243, 0
buffer_load_dwordx4 v6, s[8:11], s29 offen sc1 lds
s_waitcnt vmcnt(45)
v_cvt_pk_bf16_f32 v160, v16, v17
v_cvt_pk_bf16_f32 v161, v18, v19
s_waitcnt vmcnt(43)
v_cvt_pk_bf16_f32 v162, v24, v25
s_add_u32 s29, s24, 0
s_add_u32 s68, s67, 5120
s_mov_b32 m0, s68
v_cvt_pk_bf16_f32 v163, v26, v27
v_cvt_pk_bf16_f32 v164, v20, v21
buffer_load_dwordx4 v7, s[8:11], s29 offen sc1 lds
v_cvt_pk_bf16_f32 v165, v22, v23
s_waitcnt vmcnt(43)
v_cvt_pk_bf16_f32 v166, v28, v29
s_add_u32 s29, s24, 4096
s_add_u32 s68, s67, 6144
s_mov_b32 m0, s68
v_cvt_pk_bf16_f32 v167, v30, v31
s_waitcnt vmcnt(41)
v_cvt_pk_bf16_f32 v168, v36, v37
buffer_load_dwordx4 v7, s[8:11], s29 offen sc1 lds
v_cvt_pk_bf16_f32 v169, v38, v39
v_mov_b32 v170, 0
s_add_u32 s29, s24, 8192
s_add_u32 s68, s67, 7168
s_mov_b32 m0, s68
v_mov_b32 v171, 0
v_mov_b32 v172, 0
v_mov_b32 v173, 0
buffer_load_dwordx4 v7, s[8:11], s29 offen sc1 lds
v_cvt_pk_bf16_f32 v174, v32, v33
v_cvt_pk_bf16_f32 v175, v34, v35
s_add_u32 s29, s24, 12288
s_add_u32 s68, s67, 8192
s_mov_b32 m0, s68
s_waitcnt vmcnt(42)
v_cvt_pk_bf16_f32 v176, v40, v41
v_cvt_pk_bf16_f32 v177, v42, v43
buffer_load_dwordx4 v7, s[8:11], s29 offen sc1 lds
s_waitcnt vmcnt(41)
v_cvt_pk_bf16_f32 v178, v48, v49
v_cvt_pk_bf16_f32 v179, v50, v51
s_add_u32 s29, s24, 16384
s_add_u32 s68, s67, 9216
s_mov_b32 m0, s68
v_cvt_pk_bf16_f32 v180, v44, v45
v_cvt_pk_bf16_f32 v181, v46, v47
buffer_load_dwordx4 v7, s[8:11], s29 offen sc1 lds
s_waitcnt vmcnt(41)
v_cvt_pk_bf16_f32 v182, v52, v53
v_cvt_pk_bf16_f32 v183, v54, v55
s_lshl_b32 s31, s17, 2
s_waitcnt vmcnt(39)
v_cvt_pk_bf16_f32 v184, v60, v61
v_cvt_pk_bf16_f32 v185, v62, v63
v_mov_b32 v186, 0
s_add_u32 s31, s31, s16
v_mov_b32 v187, 0
v_mov_b32 v188, 0
s_mul_i32 s76, s31, 20480
v_mov_b32 v189, 0
v_cvt_pk_bf16_f32 v190, v56, v57
s_mul_i32 s77, s18, 160
v_cvt_pk_bf16_f32 v191, v58, v59
s_waitcnt vmcnt(38)
v_cvt_pk_bf16_f32 v192, v64, v65
s_add_u32 s76, s76, s77
v_cvt_pk_bf16_f32 v193, v66, v67
v_mov_b32 v194, 0
s_lshl_b32 s77, s31, 6
v_mov_b32 v195, 0
v_mov_b32 v244, 0
v_mov_b32 v245, 0
s_add_u32 s77, s77, 21053440
s_waitcnt vmcnt(32)
v_cvt_pk_bf16_f32 v246, v140, v141
v_cvt_pk_bf16_f32 v247, v142, v143
s_mul_i32 s34, s16, 3072
v_cndmask_b32 v246, 0, v246, s[40:41]
v_cndmask_b32 v247, 0, v247, s[40:41]
s_add_u32 s34, s34, 146432
s_waitcnt vmcnt(31)
v_cvt_pk_bf16_f32 v248, v144, v145
v_cvt_pk_bf16_f32 v249, v146, v147
s_mov_b32 m0, s34
v_cndmask_b32 v248, 0, v248, s[42:43]
v_cndmask_b32 v249, 0, v249, s[42:43]
s_movk_i32 s20, 0x199a
s_waitcnt vmcnt(30)
v_cvt_pk_bf16_f32 v250, v148, v149
v_cvt_pk_bf16_f32 v251, v150, v151
v_cndmask_b32 v250, 0, v250, s[44:45]
v_and_b32 v14, 15, v1
v_cndmask_b32 v251, 0, v251, s[44:45]
s_waitcnt vmcnt(29)
v_cvt_pk_bf16_f32 v252, v152, v153
v_lshlrev_b32 v9, 2, v14
v_cvt_pk_bf16_f32 v253, v154, v155
v_cndmask_b32 v252, 0, v252, s[46:47]
v_add_u32 v15, 0, v1
v_cndmask_b32 v253, 0, v253, s[46:47]
s_waitcnt vmcnt(28)
v_cvt_pk_bf16_f32 v254, v156, v157
v_mul_u32_u24 v13, s20, v15
v_cvt_pk_bf16_f32 v255, v158, v159
v_cndmask_b32 v254, 0, v254, s[48:49]
v_lshrrev_b32 v13, 16, v13
v_cndmask_b32 v255, 0, v255, s[48:49]
v_mov_b32 v196, 0
v_mul_u32_u24 v13, 1120, v13
v_mov_b32 v197, 0
s_waitcnt vmcnt(27)
v_cvt_pk_bf16_f32 v198, v68, v69
v_cvt_pk_bf16_f32 v199, v70, v71
v_lshl_add_u32 v15, v15, 4, v13
s_waitcnt vmcnt(25)
v_cvt_pk_bf16_f32 v200, v76, v77
v_cvt_pk_bf16_f32 v201, v78, v79
buffer_load_dwordx4 v15, s[12:15], s76 offen offset:0 lds
v_mov_b32 v202, 0
v_mov_b32 v203, 0
v_add_u32 v15, 64, v1
v_mov_b32 v204, 0
v_mov_b32 v205, 0
v_mul_u32_u24 v13, s20, v15
v_cvt_pk_bf16_f32 v206, v72, v73
v_cvt_pk_bf16_f32 v207, v74, v75
v_lshrrev_b32 v13, 16, v13
s_waitcnt vmcnt(25)
v_cvt_pk_bf16_f32 v208, v80, v81
v_cvt_pk_bf16_f32 v209, v82, v83
s_waitcnt vmcnt(23)
v_cvt_pk_bf16_f32 v210, v88, v89
v_mul_u32_u24 v13, 1120, v13
v_cvt_pk_bf16_f32 v211, v90, v91
v_cvt_pk_bf16_f32 v212, v84, v85
v_lshl_add_u32 v15, v15, 4, v13
v_cvt_pk_bf16_f32 v213, v86, v87
s_waitcnt vmcnt(22)
v_cvt_pk_bf16_f32 v214, v92, v93
v_subrev_u32 v15, 1024, v15
v_cvt_pk_bf16_f32 v215, v94, v95
s_waitcnt vmcnt(20)
v_cvt_pk_bf16_f32 v216, v100, v101
buffer_load_dwordx4 v15, s[12:15], s76 offen offset:1024 lds
v_cvt_pk_bf16_f32 v217, v102, v103
v_mov_b32 v218, 0
v_add_u32 v15, 128, v1
v_mov_b32 v219, 0
v_mov_b32 v220, 0
v_mov_b32 v221, 0
v_mul_u32_u24 v13, s20, v15
v_cvt_pk_bf16_f32 v222, v96, v97
v_cvt_pk_bf16_f32 v223, v98, v99
v_lshrrev_b32 v13, 16, v13
s_waitcnt vmcnt(20)
v_cvt_pk_bf16_f32 v224, v104, v105
v_cvt_pk_bf16_f32 v225, v106, v107
v_mul_u32_u24 v13, 1120, v13
s_waitcnt vmcnt(18)
v_cvt_pk_bf16_f32 v226, v112, v113
v_cvt_pk_bf16_f32 v227, v114, v115
v_lshl_add_u32 v15, v15, 4, v13
v_cvt_pk_bf16_f32 v228, v108, v109
v_cvt_pk_bf16_f32 v229, v110, v111
v_subrev_u32 v15, 2048, v15
s_waitcnt vmcnt(17)
v_cvt_pk_bf16_f32 v230, v116, v117
v_cvt_pk_bf16_f32 v231, v118, v119
buffer_load_dwordx4 v15, s[12:15], s76 offen offset:2048 lds
s_add_u32 s20, s16, 1
s_and_b32 s20, s20, 3
s_mul_i32 s20, s20, 16128
s_add_u32 s20, s20, 81920
v_add_u32 v10, s20, v2
s_add_u32 s20, s16, 2
s_and_b32 s20, s20, 3
s_mul_i32 s20, s20, 16128
s_add_u32 s20, s20, 87296
v_add_u32 v11, s20, v2
s_add_u32 s20, s16, 3
s_and_b32 s20, s20, 3
s_mul_i32 s20, s20, 16128
s_add_u32 s20, s20, 92672
v_add_u32 v12, s20, v2
s_mul_i32 s20, s16, 16128
s_add_u32 s20, s20, 81920
v_add_u32 v13, s20, v2
s_mov_b32 s58, s20
v_add_u32 v159, s67, v2
v_mfma_f32_16x16x32_bf16 v[56:59], v[232:235], a[216:219], 0
v_mfma_f32_16x16x32_bf16 v[56:59], v[236:239], a[220:223], v[56:59]
v_mfma_f32_16x16x32_bf16 v[56:59], v[240:243], a[224:227], v[56:59]
v_mfma_f32_16x16x32_bf16 v[16:19], v[160:163], a[216:219], 0
v_mfma_f32_16x16x32_bf16 v[20:23], v[164:167], a[216:219], 0
v_mfma_f32_16x16x32_bf16 v[20:23], v[168:171], a[220:223], v[20:23]
v_mfma_f32_16x16x32_bf16 v[24:27], v[172:175], a[216:219], 0
v_mfma_f32_16x16x32_bf16 v[24:27], v[176:179], a[220:223], v[24:27]
v_mfma_f32_16x16x32_bf16 v[28:31], v[180:183], a[220:223], 0
v_mfma_f32_16x16x32_bf16 v[28:31], v[184:187], a[224:227], v[28:31]
v_mfma_f32_16x16x32_bf16 v[32:35], v[188:191], a[220:223], 0
v_mfma_f32_16x16x32_bf16 v[32:35], v[192:195], a[224:227], v[32:35]
v_mfma_f32_16x16x32_bf16 v[60:63], v[244:247], a[224:227], 0
v_mfma_f32_16x16x32_bf16 v[60:63], v[248:251], a[228:231], v[60:63]
v_mfma_f32_16x16x32_bf16 v[60:63], v[252:255], a[232:235], v[60:63]
v_mfma_f32_16x16x32_bf16 v[36:39], v[196:199], a[224:227], 0
v_mfma_f32_16x16x32_bf16 v[36:39], v[200:203], a[228:231], v[36:39]
v_mfma_f32_16x16x32_bf16 v[40:43], v[204:207], a[224:227], 0
v_mfma_f32_16x16x32_bf16 v[40:43], v[208:211], a[228:231], v[40:43]
v_mfma_f32_16x16x32_bf16 v[44:47], v[212:215], a[228:231], 0
v_mfma_f32_16x16x32_bf16 v[44:47], v[216:219], a[232:235], v[44:47]
v_mfma_f32_16x16x32_bf16 v[48:51], v[220:223], a[228:231], 0
v_mfma_f32_16x16x32_bf16 v[48:51], v[224:227], a[232:235], v[48:51]
v_mfma_f32_16x16x32_bf16 v[52:55], v[228:231], a[232:235], 0
buffer_load_dword v158, v9, s[8:11], s77 offen sc1
s_waitcnt vmcnt(18)
v_mfma_f32_16x16x32_bf16 v[104:107], v[232:235], a[236:239], 0
v_pk_add_f32 v[56:57], v[56:57], s[32:33]
v_pk_add_f32 v[58:59], v[58:59], s[32:33]
s_waitcnt vmcnt(17)
v_mfma_f32_16x16x32_bf16 v[104:107], v[236:239], a[240:243], v[104:107]
v_rcp_f32 v56, v56
v_rcp_f32 v57, v57
v_rcp_f32 v58, v58
s_waitcnt vmcnt(16)
v_mfma_f32_16x16x32_bf16 v[104:107], v[240:243], a[244:247], v[104:107]
v_rcp_f32 v59, v59
v_cndmask_b32 v152, v56, v57, s[50:51]
v_mfma_f32_16x16x32_bf16 v[64:67], v[160:163], a[236:239], 0
v_cndmask_b32 v153, v57, v58, s[52:53]
v_cndmask_b32 v154, v58, v59, s[54:55]
v_pk_mul_f32 v[16:17], v[16:17], v[56:57] op_sel_hi:[1,0]
v_mfma_f32_16x16x32_bf16 v[68:71], v[164:167], a[236:239], 0
v_pk_mul_f32 v[18:19], v[18:19], v[56:57] op_sel_hi:[1,0]
v_cvt_pk_bf16_f32 v112, v16, v17
v_cvt_pk_bf16_f32 v113, v18, v19
v_mfma_f32_16x16x32_bf16 v[68:71], v[168:171], a[240:243], v[68:71]
v_pk_mul_f32 v[20:21], v[20:21], v[152:153] op_sel_hi:[1,0]
v_pk_mul_f32 v[22:23], v[22:23], v[152:153] op_sel_hi:[1,0]
v_mfma_f32_16x16x32_bf16 v[72:75], v[172:175], a[236:239], 0
v_cvt_pk_bf16_f32 v114, v20, v21
v_cvt_pk_bf16_f32 v115, v22, v23
v_pk_mul_f32 v[24:25], v[24:25], v[152:153] op_sel:[0,1]
v_mfma_f32_16x16x32_bf16 v[72:75], v[176:179], a[240:243], v[72:75]
v_pk_mul_f32 v[26:27], v[26:27], v[152:153] op_sel:[0,1]
v_cvt_pk_bf16_f32 v116, v24, v25
v_cvt_pk_bf16_f32 v117, v26, v27
v_mfma_f32_16x16x32_bf16 v[76:79], v[180:183], a[240:243], 0
v_pk_mul_f32 v[28:29], v[28:29], v[154:155] op_sel_hi:[1,0]
v_pk_mul_f32 v[30:31], v[30:31], v[154:155] op_sel_hi:[1,0]
v_mfma_f32_16x16x32_bf16 v[76:79], v[184:187], a[244:247], v[76:79]
v_cvt_pk_bf16_f32 v118, v28, v29
v_cvt_pk_bf16_f32 v119, v30, v31
v_pk_mul_f32 v[32:33], v[32:33], v[58:59] op_sel:[0,1]
v_mfma_f32_16x16x32_bf16 v[80:83], v[188:191], a[240:243], 0
v_pk_mul_f32 v[34:35], v[34:35], v[58:59] op_sel:[0,1]
v_cvt_pk_bf16_f32 v120, v32, v33
v_mfma_f32_16x16x32_bf16 v[80:83], v[192:195], a[244:247], v[80:83]
v_cvt_pk_bf16_f32 v121, v34, v35
v_pk_add_f32 v[60:61], v[60:61], s[32:33]
v_pk_add_f32 v[62:63], v[62:63], s[32:33]
v_mfma_f32_16x16x32_bf16 v[108:111], v[244:247], a[244:247], 0
v_rcp_f32 v60, v60
v_rcp_f32 v61, v61
v_rcp_f32 v62, v62
s_waitcnt vmcnt(15)
v_mfma_f32_16x16x32_bf16 v[108:111], v[248:251], a[248:251], v[108:111]
v_rcp_f32 v63, v63
v_cndmask_b32 v155, v60, v61, s[50:51]
s_waitcnt vmcnt(14)
v_mfma_f32_16x16x32_bf16 v[108:111], v[252:255], a[252:255], v[108:111]
v_cndmask_b32 v156, v61, v62, s[52:53]
v_cndmask_b32 v157, v62, v63, s[54:55]
v_pk_mul_f32 v[36:37], v[36:37], v[60:61] op_sel_hi:[1,0]
v_mfma_f32_16x16x32_bf16 v[84:87], v[196:199], a[244:247], 0
v_pk_mul_f32 v[38:39], v[38:39], v[60:61] op_sel_hi:[1,0]
v_cvt_pk_bf16_f32 v122, v36, v37
v_cvt_pk_bf16_f32 v123, v38, v39
v_mfma_f32_16x16x32_bf16 v[84:87], v[200:203], a[248:251], v[84:87]
v_pk_mul_f32 v[40:41], v[40:41], v[154:155] op_sel:[0,1]
v_pk_mul_f32 v[42:43], v[42:43], v[154:155] op_sel:[0,1]
v_mfma_f32_16x16x32_bf16 v[88:91], v[204:207], a[244:247], 0
v_cvt_pk_bf16_f32 v124, v40, v41
v_cvt_pk_bf16_f32 v125, v42, v43
v_pk_mul_f32 v[44:45], v[44:45], v[156:157] op_sel_hi:[1,0]
v_mfma_f32_16x16x32_bf16 v[88:91], v[208:211], a[248:251], v[88:91]
v_pk_mul_f32 v[46:47], v[46:47], v[156:157] op_sel_hi:[1,0]
v_cvt_pk_bf16_f32 v126, v44, v45
v_mfma_f32_16x16x32_bf16 v[92:95], v[212:215], a[248:251], 0
v_cvt_pk_bf16_f32 v127, v46, v47
v_pk_mul_f32 v[48:49], v[48:49], v[156:157] op_sel:[0,1]
v_pk_mul_f32 v[50:51], v[50:51], v[156:157] op_sel:[0,1]
v_mfma_f32_16x16x32_bf16 v[92:95], v[216:219], a[252:255], v[92:95]
v_cvt_pk_bf16_f32 v128, v48, v49
v_cvt_pk_bf16_f32 v129, v50, v51
v_pk_mul_f32 v[52:53], v[52:53], v[62:63] op_sel:[0,1]
v_mfma_f32_16x16x32_bf16 v[96:99], v[220:223], a[248:251], 0
v_pk_mul_f32 v[54:55], v[54:55], v[62:63] op_sel:[0,1]
v_cvt_pk_bf16_f32 v130, v52, v53
v_mfma_f32_16x16x32_bf16 v[96:99], v[224:227], a[252:255], v[96:99]
v_cvt_pk_bf16_f32 v131, v54, v55
s_waitcnt vmcnt(9)
ds_read_b128 a[216:219], v159 offset:0
ds_read_b128 a[220:223], v159 offset:1024
v_mfma_f32_16x16x32_bf16 v[100:103], v[228:231], a[252:255], 0
ds_read_b128 a[224:227], v159 offset:2048
ds_read_b128 a[228:231], v159 offset:3072
ds_read_b128 a[232:235], v159 offset:4096
s_waitcnt lgkmcnt(4)
v_mfma_f32_16x16x32_bf16 v[56:59], v[232:235], a[216:219], 0
v_pk_add_f32 v[104:105], v[104:105], s[32:33]
v_pk_add_f32 v[106:107], v[106:107], s[32:33]
s_waitcnt lgkmcnt(3)
v_mfma_f32_16x16x32_bf16 v[56:59], v[236:239], a[220:223], v[56:59]
v_rcp_f32 v104, v104
v_rcp_f32 v105, v105
v_rcp_f32 v106, v106
s_waitcnt lgkmcnt(2)
v_mfma_f32_16x16x32_bf16 v[56:59], v[240:243], a[224:227], v[56:59]
v_rcp_f32 v107, v107
v_cndmask_b32 v152, v104, v105, s[50:51]
v_mfma_f32_16x16x32_bf16 v[16:19], v[160:163], a[216:219], 0
v_cndmask_b32 v153, v105, v106, s[52:53]
v_cndmask_b32 v154, v106, v107, s[54:55]
v_pk_mul_f32 v[64:65], v[64:65], v[104:105] op_sel_hi:[1,0]
v_mfma_f32_16x16x32_bf16 v[20:23], v[164:167], a[216:219], 0
v_pk_mul_f32 v[66:67], v[66:67], v[104:105] op_sel_hi:[1,0]
v_cvt_pk_bf16_f32 v132, v64, v65
v_cvt_pk_bf16_f32 v133, v66, v67
v_mfma_f32_16x16x32_bf16 v[20:23], v[168:171], a[220:223], v[20:23]
v_pk_mul_f32 v[68:69], v[68:69], v[152:153] op_sel_hi:[1,0]
v_pk_mul_f32 v[70:71], v[70:71], v[152:153] op_sel_hi:[1,0]
v_mfma_f32_16x16x32_bf16 v[24:27], v[172:175], a[216:219], 0
v_cvt_pk_bf16_f32 v134, v68, v69
v_cvt_pk_bf16_f32 v135, v70, v71
v_pk_mul_f32 v[72:73], v[72:73], v[152:153] op_sel:[0,1]
v_mfma_f32_16x16x32_bf16 v[24:27], v[176:179], a[220:223], v[24:27]
v_pk_mul_f32 v[74:75], v[74:75], v[152:153] op_sel:[0,1]
v_cvt_pk_bf16_f32 v136, v72, v73
v_cvt_pk_bf16_f32 v137, v74, v75
v_mfma_f32_16x16x32_bf16 v[28:31], v[180:183], a[220:223], 0
v_pk_mul_f32 v[76:77], v[76:77], v[154:155] op_sel_hi:[1,0]
v_pk_mul_f32 v[78:79], v[78:79], v[154:155] op_sel_hi:[1,0]
v_mfma_f32_16x16x32_bf16 v[28:31], v[184:187], a[224:227], v[28:31]
v_cvt_pk_bf16_f32 v138, v76, v77
v_cvt_pk_bf16_f32 v139, v78, v79
v_pk_mul_f32 v[80:81], v[80:81], v[106:107] op_sel:[0,1]
v_mfma_f32_16x16x32_bf16 v[32:35], v[188:191], a[220:223], 0
v_pk_mul_f32 v[82:83], v[82:83], v[106:107] op_sel:[0,1]
v_cvt_pk_bf16_f32 v140, v80, v81
v_mfma_f32_16x16x32_bf16 v[32:35], v[192:195], a[224:227], v[32:35]
v_cvt_pk_bf16_f32 v141, v82, v83
v_pk_add_f32 v[108:109], v[108:109], s[32:33]
v_pk_add_f32 v[110:111], v[110:111], s[32:33]
v_mfma_f32_16x16x32_bf16 v[60:63], v[244:247], a[224:227], 0
v_rcp_f32 v108, v108
v_rcp_f32 v109, v109
v_rcp_f32 v110, v110
s_waitcnt lgkmcnt(1)
v_mfma_f32_16x16x32_bf16 v[60:63], v[248:251], a[228:231], v[60:63]
v_rcp_f32 v111, v111
v_cndmask_b32 v155, v108, v109, s[50:51]
s_waitcnt lgkmcnt(0)
v_mfma_f32_16x16x32_bf16 v[60:63], v[252:255], a[232:235], v[60:63]
v_cndmask_b32 v156, v109, v110, s[52:53]
v_cndmask_b32 v157, v110, v111, s[54:55]
v_pk_mul_f32 v[84:85], v[84:85], v[108:109] op_sel_hi:[1,0]
v_mfma_f32_16x16x32_bf16 v[36:39], v[196:199], a[224:227], 0
v_pk_mul_f32 v[86:87], v[86:87], v[108:109] op_sel_hi:[1,0]
v_cvt_pk_bf16_f32 v142, v84, v85
v_cvt_pk_bf16_f32 v143, v86, v87
v_mfma_f32_16x16x32_bf16 v[36:39], v[200:203], a[228:231], v[36:39]
v_pk_mul_f32 v[88:89], v[88:89], v[154:155] op_sel:[0,1]
v_pk_mul_f32 v[90:91], v[90:91], v[154:155] op_sel:[0,1]
v_mfma_f32_16x16x32_bf16 v[40:43], v[204:207], a[224:227], 0
v_cvt_pk_bf16_f32 v144, v88, v89
v_cvt_pk_bf16_f32 v145, v90, v91
v_pk_mul_f32 v[92:93], v[92:93], v[156:157] op_sel_hi:[1,0]
v_mfma_f32_16x16x32_bf16 v[40:43], v[208:211], a[228:231], v[40:43]
v_pk_mul_f32 v[94:95], v[94:95], v[156:157] op_sel_hi:[1,0]
v_cvt_pk_bf16_f32 v146, v92, v93
v_mfma_f32_16x16x32_bf16 v[44:47], v[212:215], a[228:231], 0
v_cvt_pk_bf16_f32 v147, v94, v95
v_pk_mul_f32 v[96:97], v[96:97], v[156:157] op_sel:[0,1]
v_pk_mul_f32 v[98:99], v[98:99], v[156:157] op_sel:[0,1]
v_mfma_f32_16x16x32_bf16 v[44:47], v[216:219], a[232:235], v[44:47]
v_cvt_pk_bf16_f32 v148, v96, v97
v_cvt_pk_bf16_f32 v149, v98, v99
v_pk_mul_f32 v[100:101], v[100:101], v[110:111] op_sel:[0,1]
v_mfma_f32_16x16x32_bf16 v[48:51], v[220:223], a[228:231], 0
v_pk_mul_f32 v[102:103], v[102:103], v[110:111] op_sel:[0,1]
v_cvt_pk_bf16_f32 v150, v100, v101
v_mfma_f32_16x16x32_bf16 v[48:51], v[224:227], a[232:235], v[48:51]
v_cvt_pk_bf16_f32 v151, v102, v103
s_waitcnt vmcnt(4)
ds_read_b128 a[236:239], v159 offset:5120
ds_read_b128 a[240:243], v159 offset:6144
v_mfma_f32_16x16x32_bf16 v[52:55], v[228:231], a[232:235], 0
ds_read_b128 a[244:247], v159 offset:7168
ds_read_b128 a[248:251], v159 offset:8192
ds_read_b128 a[252:255], v159 offset:9216
buffer_load_dwordx4 v[4:7], v2, s[8:11], s75 offen sc1
s_waitcnt lgkmcnt(4)
v_mfma_f32_16x16x32_bf16 v[104:107], v[232:235], a[236:239], 0
v_pk_add_f32 v[56:57], v[56:57], s[32:33]
v_pk_add_f32 v[58:59], v[58:59], s[32:33]
s_waitcnt lgkmcnt(3)
v_mfma_f32_16x16x32_bf16 v[104:107], v[236:239], a[240:243], v[104:107]
v_rcp_f32 v56, v56
v_rcp_f32 v57, v57
s_waitcnt lgkmcnt(2)
v_mfma_f32_16x16x32_bf16 v[104:107], v[240:243], a[244:247], v[104:107]
v_rcp_f32 v58, v58
v_rcp_f32 v59, v59
v_cndmask_b32 v152, v56, v57, s[50:51]
v_mfma_f32_16x16x32_bf16 v[64:67], v[160:163], a[236:239], 0
v_cndmask_b32 v153, v57, v58, s[52:53]
v_cndmask_b32 v154, v58, v59, s[54:55]
v_mfma_f32_16x16x32_bf16 v[68:71], v[164:167], a[236:239], 0
v_pk_mul_f32 v[16:17], v[16:17], v[56:57] op_sel_hi:[1,0]
v_pk_mul_f32 v[18:19], v[18:19], v[56:57] op_sel_hi:[1,0]
v_cvt_pk_bf16_f32 v16, v16, v17
v_mfma_f32_16x16x32_bf16 v[68:71], v[168:171], a[240:243], v[68:71]
v_cvt_pk_bf16_f32 v17, v18, v19
v_pk_mul_f32 v[20:21], v[20:21], v[152:153] op_sel_hi:[1,0]
v_mfma_f32_16x16x32_bf16 v[72:75], v[172:175], a[236:239], 0
v_pk_mul_f32 v[22:23], v[22:23], v[152:153] op_sel_hi:[1,0]
v_cvt_pk_bf16_f32 v18, v20, v21
v_mfma_f32_16x16x32_bf16 v[72:75], v[176:179], a[240:243], v[72:75]
v_cvt_pk_bf16_f32 v19, v22, v23
v_pk_mul_f32 v[24:25], v[24:25], v[152:153] op_sel:[0,1]
v_pk_mul_f32 v[26:27], v[26:27], v[152:153] op_sel:[0,1]
v_mfma_f32_16x16x32_bf16 v[76:79], v[180:183], a[240:243], 0
v_cvt_pk_bf16_f32 v20, v24, v25
v_cvt_pk_bf16_f32 v21, v26, v27
v_mfma_f32_16x16x32_bf16 v[76:79], v[184:187], a[244:247], v[76:79]
v_pk_mul_f32 v[28:29], v[28:29], v[154:155] op_sel_hi:[1,0]
v_pk_mul_f32 v[30:31], v[30:31], v[154:155] op_sel_hi:[1,0]
v_cvt_pk_bf16_f32 v22, v28, v29
v_mfma_f32_16x16x32_bf16 v[80:83], v[188:191], a[240:243], 0
v_cvt_pk_bf16_f32 v23, v30, v31
v_pk_mul_f32 v[32:33], v[32:33], v[58:59] op_sel:[0,1]
v_mfma_f32_16x16x32_bf16 v[80:83], v[192:195], a[244:247], v[80:83]
v_pk_mul_f32 v[34:35], v[34:35], v[58:59] op_sel:[0,1]
v_cvt_pk_bf16_f32 v24, v32, v33
v_cvt_pk_bf16_f32 v25, v34, v35
v_mfma_f32_16x16x32_bf16 v[108:111], v[244:247], a[244:247], 0
v_pk_add_f32 v[60:61], v[60:61], s[32:33]
v_pk_add_f32 v[62:63], v[62:63], s[32:33]
s_waitcnt lgkmcnt(1)
v_mfma_f32_16x16x32_bf16 v[108:111], v[248:251], a[248:251], v[108:111]
v_rcp_f32 v60, v60
v_rcp_f32 v61, v61
s_waitcnt lgkmcnt(0)
v_mfma_f32_16x16x32_bf16 v[108:111], v[252:255], a[252:255], v[108:111]
v_rcp_f32 v62, v62
v_rcp_f32 v63, v63
v_cndmask_b32 v155, v60, v61, s[50:51]
v_mfma_f32_16x16x32_bf16 v[84:87], v[196:199], a[244:247], 0
v_cndmask_b32 v156, v61, v62, s[52:53]
v_cndmask_b32 v157, v62, v63, s[54:55]
v_mfma_f32_16x16x32_bf16 v[84:87], v[200:203], a[248:251], v[84:87]
v_pk_mul_f32 v[36:37], v[36:37], v[60:61] op_sel_hi:[1,0]
v_pk_mul_f32 v[38:39], v[38:39], v[60:61] op_sel_hi:[1,0]
v_cvt_pk_bf16_f32 v26, v36, v37
v_mfma_f32_16x16x32_bf16 v[88:91], v[204:207], a[244:247], 0
v_cvt_pk_bf16_f32 v27, v38, v39
v_pk_mul_f32 v[40:41], v[40:41], v[154:155] op_sel:[0,1]
v_mfma_f32_16x16x32_bf16 v[88:91], v[208:211], a[248:251], v[88:91]
v_pk_mul_f32 v[42:43], v[42:43], v[154:155] op_sel:[0,1]
v_cvt_pk_bf16_f32 v28, v40, v41
v_mfma_f32_16x16x32_bf16 v[92:95], v[212:215], a[248:251], 0
v_cvt_pk_bf16_f32 v29, v42, v43
v_pk_mul_f32 v[44:45], v[44:45], v[156:157] op_sel_hi:[1,0]
v_pk_mul_f32 v[46:47], v[46:47], v[156:157] op_sel_hi:[1,0]
v_mfma_f32_16x16x32_bf16 v[92:95], v[216:219], a[252:255], v[92:95]
v_cvt_pk_bf16_f32 v30, v44, v45
v_cvt_pk_bf16_f32 v31, v46, v47
v_mfma_f32_16x16x32_bf16 v[96:99], v[220:223], a[248:251], 0
v_pk_mul_f32 v[48:49], v[48:49], v[156:157] op_sel:[0,1]
v_pk_mul_f32 v[50:51], v[50:51], v[156:157] op_sel:[0,1]
v_cvt_pk_bf16_f32 v32, v48, v49
v_mfma_f32_16x16x32_bf16 v[96:99], v[224:227], a[252:255], v[96:99]
v_cvt_pk_bf16_f32 v33, v50, v51
v_pk_mul_f32 v[52:53], v[52:53], v[62:63] op_sel:[0,1]
v_mfma_f32_16x16x32_bf16 v[100:103], v[228:231], a[252:255], 0
v_pk_mul_f32 v[54:55], v[54:55], v[62:63] op_sel:[0,1]
v_cvt_pk_bf16_f32 v34, v52, v53
v_cvt_pk_bf16_f32 v35, v54, v55
s_waitcnt vmcnt(0)
v_and_b32 v4, v4, v5
v_and_b32 v4, v4, v6
v_and_b32 v4, v4, v7
v_cmp_ne_u32 vcc, 1, v4
s_nop 1
s_cbranch_vccz L_fa_ok
s_mov_b32 s21, 0
L_fa_lp:
s_sleep 8
buffer_load_dwordx4 v[4:7], v2, s[8:11], s75 offen sc1
s_waitcnt vmcnt(0)
v_and_b32 v4, v4, v5
v_and_b32 v4, v4, v6
v_and_b32 v4, v4, v7
v_cmp_ne_u32 vcc, 1, v4
s_add_u32 s21, s21, 1
s_cmp_ge_u32 s21, 0x40000
s_cbranch_scc1 L_fa_ok
s_nop 1
s_cbranch_vccnz L_fa_lp
L_fa_ok:
s_nop 1
v_mfma_f32_16x16x32_bf16 a[24:27], a[96:99], v[112:115], 0
v_pk_add_f32 v[104:105], v[104:105], s[32:33]
v_mfma_f32_16x16x32_bf16 a[28:31], a[100:103], v[112:115], 0
v_pk_add_f32 v[106:107], v[106:107], s[32:33]
v_rcp_f32 v104, v104
v_mfma_f32_16x16x32_bf16 a[24:27], a[120:123], v[116:119], a[24:27]
v_rcp_f32 v105, v105
v_mfma_f32_16x16x32_bf16 a[28:31], a[124:127], v[116:119], a[28:31]
v_rcp_f32 v106, v106
s_add_u32 s68, s67, 0
s_mov_b32 m0, s68
s_add_u32 s69, s66, 0
v_mfma_f32_16x16x32_bf16 a[24:27], a[144:147], v[120:123], a[24:27]
v_rcp_f32 v107, v107
v_cndmask_b32 v152, v104, v105, s[50:51]
v_mfma_f32_16x16x32_bf16 a[28:31], a[148:151], v[120:123], a[28:31]
v_cndmask_b32 v153, v105, v106, s[52:53]
v_mfma_f32_16x16x32_bf16 a[24:27], a[168:171], v[124:127], a[24:27]
v_cndmask_b32 v154, v106, v107, s[54:55]
buffer_load_dwordx4 v2, s[36:39], s69 offen offset:0 sc1 lds
v_mfma_f32_16x16x32_bf16 a[28:31], a[172:175], v[124:127], a[28:31]
v_pk_mul_f32 v[64:65], v[64:65], v[104:105] op_sel_hi:[1,0]
v_pk_mul_f32 v[66:67], v[66:67], v[104:105] op_sel_hi:[1,0]
v_mfma_f32_16x16x32_bf16 a[24:27], a[192:195], v[128:131], a[24:27]
v_cvt_pk_bf16_f32 v64, v64, v65
v_mfma_f32_16x16x32_bf16 a[28:31], a[196:199], v[128:131], a[28:31]
v_cvt_pk_bf16_f32 v65, v66, v67
v_pk_mul_f32 v[68:69], v[68:69], v[152:153] op_sel_hi:[1,0]
v_mfma_f32_16x16x32_bf16 a[48:51], a[96:99], v[132:135], 0
buffer_load_dwordx4 v2, s[36:39], s69 offen offset:1024 sc1 lds
v_mfma_f32_16x16x32_bf16 a[52:55], a[100:103], v[132:135], 0
v_pk_mul_f32 v[70:71], v[70:71], v[152:153] op_sel_hi:[1,0]
v_cvt_pk_bf16_f32 v66, v68, v69
v_mfma_f32_16x16x32_bf16 a[48:51], a[120:123], v[136:139], a[48:51]
v_cvt_pk_bf16_f32 v67, v70, v71
v_pk_mul_f32 v[72:73], v[72:73], v[152:153] op_sel:[0,1]
v_mfma_f32_16x16x32_bf16 a[52:55], a[124:127], v[136:139], a[52:55]
buffer_load_dwordx4 v2, s[36:39], s69 offen offset:2048 sc1 lds
v_mfma_f32_16x16x32_bf16 a[48:51], a[144:147], v[140:143], a[48:51]
v_pk_mul_f32 v[74:75], v[74:75], v[152:153] op_sel:[0,1]
v_cvt_pk_bf16_f32 v68, v72, v73
v_mfma_f32_16x16x32_bf16 a[52:55], a[148:151], v[140:143], a[52:55]
v_cvt_pk_bf16_f32 v69, v74, v75
v_pk_mul_f32 v[76:77], v[76:77], v[154:155] op_sel_hi:[1,0]
v_mfma_f32_16x16x32_bf16 a[48:51], a[168:171], v[144:147], a[48:51]
v_pk_mul_f32 v[78:79], v[78:79], v[154:155] op_sel_hi:[1,0]
v_mfma_f32_16x16x32_bf16 a[52:55], a[172:175], v[144:147], a[52:55]
buffer_load_dwordx4 v2, s[36:39], s69 offen offset:3072 sc1 lds
v_cvt_pk_bf16_f32 v70, v76, v77
v_mfma_f32_16x16x32_bf16 a[48:51], a[192:195], v[148:151], a[48:51]
v_cvt_pk_bf16_f32 v71, v78, v79
v_pk_mul_f32 v[80:81], v[80:81], v[106:107] op_sel:[0,1]
v_mfma_f32_16x16x32_bf16 a[52:55], a[196:199], v[148:151], a[52:55]
v_pk_mul_f32 v[82:83], v[82:83], v[106:107] op_sel:[0,1]
v_mfma_f32_16x16x32_bf16 a[72:75], a[96:99], v[16:19], 0
s_add_u32 s68, s67, 4096
s_mov_b32 m0, s68
s_add_u32 s69, s66, 4096
v_cvt_pk_bf16_f32 v72, v80, v81
v_mfma_f32_16x16x32_bf16 a[76:79], a[100:103], v[16:19], 0
v_cvt_pk_bf16_f32 v73, v82, v83
v_mfma_f32_16x16x32_bf16 a[72:75], a[120:123], v[20:23], a[72:75]
v_pk_add_f32 v[108:109], v[108:109], s[32:33]
v_pk_add_f32 v[110:111], v[110:111], s[32:33]
v_mfma_f32_16x16x32_bf16 a[76:79], a[124:127], v[20:23], a[76:79]
v_rcp_f32 v108, v108
buffer_load_dwordx4 v2, s[36:39], s69 offen offset:0 sc1 lds
v_mfma_f32_16x16x32_bf16 a[72:75], a[144:147], v[24:27], a[72:75]
v_rcp_f32 v109, v109
v_mfma_f32_16x16x32_bf16 a[76:79], a[148:151], v[24:27], a[76:79]
v_rcp_f32 v110, v110
v_rcp_f32 v111, v111
v_mfma_f32_16x16x32_bf16 a[72:75], a[168:171], v[28:31], a[72:75]
v_cndmask_b32 v155, v108, v109, s[50:51]
s_add_u32 s68, s67, 5120
s_mov_b32 m0, s68
s_add_u32 s69, s66, 40960
v_mfma_f32_16x16x32_bf16 a[76:79], a[172:175], v[28:31], a[76:79]
v_cndmask_b32 v156, v109, v110, s[52:53]
v_mfma_f32_16x16x32_bf16 a[72:75], a[192:195], v[32:35], a[72:75]
v_cndmask_b32 v157, v110, v111, s[54:55]
v_pk_mul_f32 v[84:85], v[84:85], v[108:109] op_sel_hi:[1,0]
v_mfma_f32_16x16x32_bf16 a[76:79], a[196:199], v[32:35], a[76:79]
v_pk_mul_f32 v[86:87], v[86:87], v[108:109] op_sel_hi:[1,0]
buffer_load_dwordx4 v2, s[36:39], s69 offen offset:0 sc1 lds
v_mfma_f32_16x16x32_bf16 a[32:35], a[104:107], v[112:115], 0
v_cvt_pk_bf16_f32 v74, v84, v85
v_mfma_f32_16x16x32_bf16 a[36:39], a[108:111], v[112:115], 0
v_cvt_pk_bf16_f32 v75, v86, v87
v_mfma_f32_16x16x32_bf16 a[32:35], a[128:131], v[116:119], a[32:35]
v_pk_mul_f32 v[88:89], v[88:89], v[154:155] op_sel:[0,1]
v_pk_mul_f32 v[90:91], v[90:91], v[154:155] op_sel:[0,1]
v_mfma_f32_16x16x32_bf16 a[36:39], a[132:135], v[116:119], a[36:39]
buffer_load_dwordx4 v2, s[36:39], s69 offen offset:1024 sc1 lds
v_mfma_f32_16x16x32_bf16 a[32:35], a[152:155], v[120:123], a[32:35]
v_cvt_pk_bf16_f32 v76, v88, v89
v_cvt_pk_bf16_f32 v77, v90, v91
v_mfma_f32_16x16x32_bf16 a[36:39], a[156:159], v[120:123], a[36:39]
v_pk_mul_f32 v[92:93], v[92:93], v[156:157] op_sel_hi:[1,0]
v_mfma_f32_16x16x32_bf16 a[32:35], a[176:179], v[124:127], a[32:35]
v_pk_mul_f32 v[94:95], v[94:95], v[156:157] op_sel_hi:[1,0]
v_mfma_f32_16x16x32_bf16 a[36:39], a[180:183], v[124:127], a[36:39]
buffer_load_dwordx4 v2, s[36:39], s69 offen offset:2048 sc1 lds
v_cvt_pk_bf16_f32 v78, v92, v93
v_mfma_f32_16x16x32_bf16 a[32:35], a[200:203], v[128:131], a[32:35]
v_cvt_pk_bf16_f32 v79, v94, v95
v_mfma_f32_16x16x32_bf16 a[36:39], a[204:207], v[128:131], a[36:39]
v_pk_mul_f32 v[96:97], v[96:97], v[156:157] op_sel:[0,1]
buffer_load_dwordx4 v2, s[36:39], s69 offen offset:3072 sc1 lds
v_mfma_f32_16x16x32_bf16 a[56:59], a[104:107], v[132:135], 0
v_pk_mul_f32 v[98:99], v[98:99], v[156:157] op_sel:[0,1]
v_mfma_f32_16x16x32_bf16 a[60:63], a[108:111], v[132:135], 0
v_cvt_pk_bf16_f32 v80, v96, v97
v_mfma_f32_16x16x32_bf16 a[56:59], a[128:131], v[136:139], a[56:59]
v_cvt_pk_bf16_f32 v81, v98, v99
v_pk_mul_f32 v[100:101], v[100:101], v[110:111] op_sel:[0,1]
v_mfma_f32_16x16x32_bf16 a[60:63], a[132:135], v[136:139], a[60:63]
s_add_u32 s68, s67, 9216
s_mov_b32 m0, s68
s_add_u32 s69, s66, 45056
v_mfma_f32_16x16x32_bf16 a[56:59], a[152:155], v[140:143], a[56:59]
v_pk_mul_f32 v[102:103], v[102:103], v[110:111] op_sel:[0,1]
v_cvt_pk_bf16_f32 v82, v100, v101
v_mfma_f32_16x16x32_bf16 a[60:63], a[156:159], v[140:143], a[60:63]
v_cvt_pk_bf16_f32 v83, v102, v103
v_mfma_f32_16x16x32_bf16 a[56:59], a[176:179], v[144:147], a[56:59]
v_mul_u32_u24 v15, 160, v14
v_mfma_f32_16x16x32_bf16 a[60:63], a[180:183], v[144:147], a[60:63]
buffer_load_dwordx4 v2, s[36:39], s69 offen offset:0 sc1 lds
v_lshl_add_u32 v15, v8, 3, v15
v_mfma_f32_16x16x32_bf16 a[56:59], a[200:203], v[148:151], a[56:59]
v_add_u32 v15, s34, v15
v_mfma_f32_16x16x32_bf16 a[60:63], a[204:207], v[148:151], a[60:63]
ds_read_b64 v[160:161], v15 offset:0
s_add_u32 s68, s67, 40960
s_mov_b32 m0, s68
s_add_u32 s69, s66, 20480
v_mfma_f32_16x16x32_bf16 a[80:83], a[104:107], v[16:19], 0
ds_read_b64 v[162:163], v15 offset:32
v_mfma_f32_16x16x32_bf16 a[84:87], a[108:111], v[16:19], 0
ds_read_b64 v[164:165], v15 offset:64
v_mfma_f32_16x16x32_bf16 a[80:83], a[128:131], v[20:23], a[80:83]
ds_read_b64 v[166:167], v15 offset:96
ds_read_b64 v[168:169], v15 offset:128
v_mfma_f32_16x16x32_bf16 a[84:87], a[132:135], v[20:23], a[84:87]
buffer_load_dwordx4 v2, s[36:39], s69 offen offset:0 sc1 lds
v_mfma_f32_16x16x32_bf16 a[80:83], a[152:155], v[24:27], a[80:83]
v_mov_b32 v170, v158
ds_write_b128 v10, a[24:27] offset:0
v_mfma_f32_16x16x32_bf16 a[84:87], a[156:159], v[24:27], a[84:87]
ds_write_b128 v10, a[28:31] offset:1024
v_mfma_f32_16x16x32_bf16 a[80:83], a[176:179], v[28:31], a[80:83]
ds_write_b128 v11, a[48:51] offset:0
v_mfma_f32_16x16x32_bf16 a[84:87], a[180:183], v[28:31], a[84:87]
buffer_load_dwordx4 v2, s[36:39], s69 offen offset:1024 sc1 lds
ds_write_b128 v11, a[52:55] offset:1024
v_mfma_f32_16x16x32_bf16 a[80:83], a[200:203], v[32:35], a[80:83]
ds_write_b128 v12, a[72:75] offset:0
v_mfma_f32_16x16x32_bf16 a[84:87], a[204:207], v[32:35], a[84:87]
ds_write_b128 v12, a[76:79] offset:1024
buffer_load_dwordx4 v2, s[36:39], s69 offen offset:2048 sc1 lds
v_mfma_f32_16x16x32_bf16 a[40:43], a[112:115], v[112:115], 0
v_mfma_f32_16x16x32_bf16 a[44:47], a[116:119], v[112:115], 0
ds_write_b128 v10, a[32:35] offset:2048
v_mfma_f32_16x16x32_bf16 a[40:43], a[136:139], v[116:119], a[40:43]
buffer_load_dwordx4 v2, s[36:39], s69 offen offset:3072 sc1 lds
v_mfma_f32_16x16x32_bf16 a[44:47], a[140:143], v[116:119], a[44:47]
v_mfma_f32_16x16x32_bf16 a[40:43], a[160:163], v[120:123], a[40:43]
ds_write_b128 v10, a[36:39] offset:3072
v_mfma_f32_16x16x32_bf16 a[44:47], a[164:167], v[120:123], a[44:47]
s_add_u32 s68, s67, 45056
s_mov_b32 m0, s68
s_add_u32 s69, s66, 24576
v_mfma_f32_16x16x32_bf16 a[40:43], a[184:187], v[124:127], a[40:43]
v_mfma_f32_16x16x32_bf16 a[44:47], a[188:191], v[124:127], a[44:47]
ds_write_b128 v11, a[56:59] offset:2048
v_mfma_f32_16x16x32_bf16 a[40:43], a[208:211], v[128:131], a[40:43]
buffer_load_dwordx4 v2, s[36:39], s69 offen offset:0 sc1 lds
v_mfma_f32_16x16x32_bf16 a[44:47], a[212:215], v[128:131], a[44:47]
v_mfma_f32_16x16x32_bf16 a[64:67], a[112:115], v[132:135], 0
ds_write_b128 v11, a[60:63] offset:3072
v_mfma_f32_16x16x32_bf16 a[68:71], a[116:119], v[132:135], 0
s_add_u32 s68, s67, 46080
s_mov_b32 m0, s68
s_add_u32 s69, s66, 61440
v_mfma_f32_16x16x32_bf16 a[64:67], a[136:139], v[136:139], a[64:67]
v_mfma_f32_16x16x32_bf16 a[68:71], a[140:143], v[136:139], a[68:71]
buffer_load_dwordx4 v2, s[36:39], s69 offen offset:0 sc1 lds
v_mfma_f32_16x16x32_bf16 a[64:67], a[160:163], v[140:143], a[64:67]
s_waitcnt lgkmcnt(14)
ds_write_b128 v12, a[80:83] offset:2048
v_mfma_f32_16x16x32_bf16 a[68:71], a[164:167], v[140:143], a[68:71]
v_mfma_f32_16x16x32_bf16 a[64:67], a[184:187], v[144:147], a[64:67]
buffer_load_dwordx4 v2, s[36:39], s69 offen offset:1024 sc1 lds
v_mfma_f32_16x16x32_bf16 a[68:71], a[188:191], v[144:147], a[68:71]
s_waitcnt lgkmcnt(14)
ds_write_b128 v12, a[84:87] offset:3072
v_mfma_f32_16x16x32_bf16 a[64:67], a[208:211], v[148:151], a[64:67]
v_mfma_f32_16x16x32_bf16 a[68:71], a[212:215], v[148:151], a[68:71]
buffer_load_dwordx4 v2, s[36:39], s69 offen offset:2048 sc1 lds
v_mfma_f32_16x16x32_bf16 a[88:91], a[112:115], v[16:19], 0
s_waitcnt lgkmcnt(14)
ds_write_b128 v10, a[40:43] offset:4096
v_mfma_f32_16x16x32_bf16 a[92:95], a[116:119], v[16:19], 0
v_mfma_f32_16x16x32_bf16 a[88:91], a[136:139], v[20:23], a[88:91]
buffer_load_dwordx4 v2, s[36:39], s69 offen offset:3072 sc1 lds
v_mfma_f32_16x16x32_bf16 a[92:95], a[140:143], v[20:23], a[92:95]
s_mov_b64 exec, 0xffff
s_waitcnt lgkmcnt(14)
ds_write_b128 v10, a[44:47] offset:5120
s_mov_b64 exec, -1
v_mfma_f32_16x16x32_bf16 a[88:91], a[160:163], v[24:27], a[88:91]
v_mfma_f32_16x16x32_bf16 a[92:95], a[164:167], v[24:27], a[92:95]
s_add_u32 s68, s67, 50176
s_mov_b32 m0, s68
s_add_u32 s69, s66, 65536
v_mfma_f32_16x16x32_bf16 a[88:91], a[184:187], v[28:31], a[88:91]
buffer_load_dwordx4 v2, s[36:39], s69 offen offset:0 sc1 lds
v_mfma_f32_16x16x32_bf16 a[92:95], a[188:191], v[28:31], a[92:95]
v_mfma_f32_16x16x32_bf16 a[88:91], a[208:211], v[32:35], a[88:91]
s_waitcnt lgkmcnt(14)
ds_write_b128 v11, a[64:67] offset:4096
v_mfma_f32_16x16x32_bf16 a[92:95], a[212:215], v[32:35], a[92:95]
s_mov_b64 exec, 0xffff
s_waitcnt lgkmcnt(14)
ds_write_b128 v11, a[68:71] offset:5120
s_mov_b64 exec, -1
v_mfma_f32_16x16x32_bf16 a[0:3], a[96:99], v[64:67], 0
v_mfma_f32_16x16x32_bf16 a[4:7], a[100:103], v[64:67], 0
v_mfma_f32_16x16x32_bf16 a[0:3], a[120:123], v[68:71], a[0:3]
v_mfma_f32_16x16x32_bf16 a[4:7], a[124:127], v[68:71], a[4:7]
v_mfma_f32_16x16x32_bf16 a[0:3], a[144:147], v[72:75], a[0:3]
v_mfma_f32_16x16x32_bf16 a[4:7], a[148:151], v[72:75], a[4:7]
v_mfma_f32_16x16x32_bf16 a[0:3], a[168:171], v[76:79], a[0:3]
s_waitcnt lgkmcnt(14)
ds_write_b128 v12, a[88:91] offset:4096
v_mfma_f32_16x16x32_bf16 a[4:7], a[172:175], v[76:79], a[4:7]
v_mfma_f32_16x16x32_bf16 a[0:3], a[192:195], v[80:83], a[0:3]
v_mfma_f32_16x16x32_bf16 a[4:7], a[196:199], v[80:83], a[4:7]
s_mov_b64 exec, 0xffff
s_waitcnt lgkmcnt(14)
ds_write_b128 v12, a[92:95] offset:5120
s_mov_b64 exec, -1
s_waitcnt lgkmcnt(0)
s_barrier
v_mfma_f32_16x16x32_bf16 a[8:11], a[104:107], v[64:67], 0
v_lshlrev_b32 v7, 4, v14
v_add_u32 v7, s58, v7
ds_read_b32 v96, v7 offset:5120
ds_read_b32 v100, v7 offset:10496
ds_read_b32 v104, v7 offset:15872
ds_read_b128 v[16:19], v13 offset:0
v_mfma_f32_16x16x32_bf16 a[12:15], a[108:111], v[64:67], 0
ds_read_b128 v[20:23], v13 offset:5376
ds_read_b128 v[24:27], v13 offset:10752
ds_read_b128 v[28:31], v13 offset:1024
ds_read_b128 v[32:35], v13 offset:6400
ds_read_b128 v[36:39], v13 offset:11776
ds_read_b128 v[40:43], v13 offset:2048
v_mfma_f32_16x16x32_bf16 a[8:11], a[128:131], v[68:71], a[8:11]
ds_read_b128 v[44:47], v13 offset:7424
ds_read_b128 v[48:51], v13 offset:12800
ds_read_b128 v[52:55], v13 offset:3072
ds_read_b128 v[56:59], v13 offset:8448
ds_read_b128 v[60:63], v13 offset:13824
s_waitcnt lgkmcnt(14)
ds_read_b128 v[84:87], v13 offset:4096
s_waitcnt lgkmcnt(14)
ds_read_b128 v[88:91], v13 offset:9472
v_mfma_f32_16x16x32_bf16 a[12:15], a[132:135], v[68:71], a[12:15]
s_waitcnt lgkmcnt(14)
ds_read_b128 v[92:95], v13 offset:14848
v_add_f32 v196, v96, v100
v_add_f32 v196, v196, v104
v_add_f32 v170, v170, v196
s_waitcnt lgkmcnt(13)
v_add_f32 v176, v16, v20
s_waitcnt lgkmcnt(12)
v_add_f32 v176, v176, v24
v_mfma_f32_16x16x32_bf16 a[8:11], a[152:155], v[72:75], a[8:11]
v_add_f32 v177, v17, v21
v_add_f32 v177, v177, v25
v_add_f32 v178, v18, v22
v_add_f32 v178, v178, v26
v_add_f32 v179, v19, v23
v_add_f32 v179, v179, v27
s_waitcnt lgkmcnt(10)
v_add_f32 v180, v28, v32
v_mfma_f32_16x16x32_bf16 a[12:15], a[156:159], v[72:75], a[12:15]
s_waitcnt lgkmcnt(9)
v_add_f32 v180, v180, v36
v_add_f32 v181, v29, v33
v_add_f32 v181, v181, v37
v_add_f32 v182, v30, v34
v_add_f32 v182, v182, v38
v_add_f32 v183, v31, v35
v_mfma_f32_16x16x32_bf16 a[8:11], a[176:179], v[76:79], a[8:11]
v_add_f32 v183, v183, v39
s_waitcnt lgkmcnt(7)
v_add_f32 v184, v40, v44
s_waitcnt lgkmcnt(6)
v_add_f32 v184, v184, v48
v_add_f32 v185, v41, v45
v_add_f32 v185, v185, v49
v_add_f32 v186, v42, v46
v_mfma_f32_16x16x32_bf16 a[12:15], a[180:183], v[76:79], a[12:15]
v_add_f32 v186, v186, v50
v_add_f32 v187, v43, v47
v_add_f32 v187, v187, v51
s_waitcnt lgkmcnt(4)
v_add_f32 v188, v52, v56
s_waitcnt lgkmcnt(3)
v_add_f32 v188, v188, v60
v_add_f32 v189, v53, v57
v_add_f32 v189, v189, v61
v_mfma_f32_16x16x32_bf16 a[8:11], a[200:203], v[80:83], a[8:11]
v_add_f32 v190, v54, v58
v_add_f32 v190, v190, v62
v_add_f32 v191, v55, v59
v_add_f32 v191, v191, v63
s_waitcnt lgkmcnt(1)
v_add_f32 v192, v84, v88
s_waitcnt lgkmcnt(0)
v_add_f32 v192, v192, v92
v_mfma_f32_16x16x32_bf16 a[12:15], a[204:207], v[80:83], a[12:15]
v_add_f32 v193, v85, v89
v_add_f32 v193, v193, v93
v_add_f32 v194, v86, v90
v_add_f32 v194, v194, v94
v_add_f32 v195, v87, v91
v_add_f32 v195, v195, v95
v_lshlrev_b32 v4, 16, v160
v_mfma_f32_16x16x32_bf16 a[16:19], a[112:115], v[64:67], 0
v_and_b32 v5, 0xffff0000, v160
v_add_f32 v176, v176, v4
v_add_f32 v177, v177, v5
v_lshlrev_b32 v4, 16, v161
v_and_b32 v5, 0xffff0000, v161
v_add_f32 v178, v178, v4
v_mfma_f32_16x16x32_bf16 a[20:23], a[116:119], v[64:67], 0
v_add_f32 v179, v179, v5
v_lshlrev_b32 v4, 16, v162
v_and_b32 v5, 0xffff0000, v162
v_add_f32 v180, v180, v4
v_add_f32 v181, v181, v5
v_lshlrev_b32 v4, 16, v163
v_mfma_f32_16x16x32_bf16 a[16:19], a[136:139], v[68:71], a[16:19]
v_and_b32 v5, 0xffff0000, v163
v_add_f32 v182, v182, v4
v_add_f32 v183, v183, v5
v_lshlrev_b32 v4, 16, v164
v_and_b32 v5, 0xffff0000, v164
v_add_f32 v184, v184, v4
v_add_f32 v185, v185, v5
v_mfma_f32_16x16x32_bf16 a[20:23], a[140:143], v[68:71], a[20:23]
v_lshlrev_b32 v4, 16, v165
v_and_b32 v5, 0xffff0000, v165
v_add_f32 v186, v186, v4
v_add_f32 v187, v187, v5
v_lshlrev_b32 v4, 16, v166
v_and_b32 v5, 0xffff0000, v166
v_mfma_f32_16x16x32_bf16 a[16:19], a[160:163], v[72:75], a[16:19]
v_add_f32 v188, v188, v4
v_add_f32 v189, v189, v5
v_lshlrev_b32 v4, 16, v167
v_and_b32 v5, 0xffff0000, v167
v_add_f32 v190, v190, v4
v_add_f32 v191, v191, v5
v_lshlrev_b32 v4, 16, v168
v_mfma_f32_16x16x32_bf16 a[20:23], a[164:167], v[72:75], a[20:23]
v_and_b32 v5, 0xffff0000, v168
v_add_f32 v192, v192, v4
v_add_f32 v193, v193, v5
v_lshlrev_b32 v4, 16, v169
v_and_b32 v5, 0xffff0000, v169
v_add_f32 v194, v194, v4
v_mfma_f32_16x16x32_bf16 a[16:19], a[184:187], v[76:79], a[16:19]
v_add_f32 v195, v195, v5
v_bfe_u32 v4, v1, 4, 1
v_lshlrev_b32 v4, 9, v4
v_lshl_add_u32 v4, v14, 4, v4
v_lshrrev_b32 v6, 5, v1
v_lshl_add_u32 v5, v6, 3, v4
v_mfma_f32_16x16x32_bf16 a[20:23], a[188:191], v[76:79], a[20:23]
v_lshl_add_u32 v4, v6, 10, v4
s_lshl_b32 s26, s17, 1
s_lshr_b32 s27, s16, 1
s_add_u32 s26, s26, s27
s_mul_i32 s26, s26, 40
s_mul_i32 s27, s18, 5
s_add_u32 s26, s26, s27
v_mfma_f32_16x16x32_bf16 a[16:19], a[208:211], v[80:83], a[16:19]
s_lshl_b32 s26, s26, 10
s_and_b32 s27, s16, 1
s_lshl_b32 s27, s27, 8
s_add_u32 s27, s27, s26
s_add_u32 s27, s27, 2621440
s_add_u32 s26, s27, 4096
v_mfma_f32_16x16x32_bf16 a[20:23], a[212:215], v[80:83], a[20:23]
v_lshlrev_b32 v6, 5, v14
s_lshl_b32 s28, s31, 9
s_lshl_b32 s29, s18, 2
s_add_u32 s28, s28, s29
s_add_u32 s28, s28, 21078016
s_lshl_b32 s29, s31, 6
s_add_u32 s29, s29, 21069824
s_nop 0
v_accvgpr_read_b32 v7, a20
v_accvgpr_read_b32 v16, a0
v_accvgpr_read_b32 v17, a1
v_accvgpr_read_b32 v18, a2
v_accvgpr_read_b32 v19, a3
v_accvgpr_read_b32 v20, a4
v_accvgpr_read_b32 v21, a5
v_accvgpr_read_b32 v22, a6
v_accvgpr_read_b32 v23, a7
v_accvgpr_read_b32 v24, a8
v_accvgpr_read_b32 v25, a9
v_accvgpr_read_b32 v26, a10
v_accvgpr_read_b32 v27, a11
v_accvgpr_read_b32 v28, a12
v_accvgpr_read_b32 v29, a13
v_accvgpr_read_b32 v30, a14
v_accvgpr_read_b32 v31, a15
v_accvgpr_read_b32 v32, a16
v_accvgpr_read_b32 v33, a17
v_accvgpr_read_b32 v34, a18
v_accvgpr_read_b32 v35, a19
v_add_f32 v170, v170, v7
v_add_f32 v16, v16, v176
v_add_f32 v17, v17, v177
v_add_f32 v18, v18, v178
v_add_f32 v19, v19, v179
v_add_f32 v20, v20, v180
v_add_f32 v21, v21, v181
v_add_f32 v22, v22, v182
v_add_f32 v23, v23, v183
v_add_f32 v24, v24, v184
v_add_f32 v25, v25, v185
v_add_f32 v26, v26, v186
v_add_f32 v27, v27, v187
v_add_f32 v28, v28, v188
v_add_f32 v29, v29, v189
v_add_f32 v30, v30, v190
v_add_f32 v31, v31, v191
v_add_f32 v32, v32, v192
v_add_f32 v33, v33, v193
v_add_f32 v34, v34, v194
v_add_f32 v35, v35, v195
v_sub_f32 v16, v16, v170
v_sub_f32 v17, v17, v170
v_sub_f32 v18, v18, v170
v_sub_f32 v19, v19, v170
v_sub_f32 v20, v20, v170
v_sub_f32 v21, v21, v170
v_sub_f32 v22, v22, v170
v_sub_f32 v23, v23, v170
v_sub_f32 v24, v24, v170
v_sub_f32 v25, v25, v170
v_sub_f32 v26, v26, v170
v_sub_f32 v27, v27, v170
v_sub_f32 v28, v28, v170
v_sub_f32 v29, v29, v170
v_sub_f32 v30, v30, v170
v_sub_f32 v31, v31, v170
v_sub_f32 v32, v32, v170
v_sub_f32 v33, v33, v170
v_sub_f32 v34, v34, v170
v_sub_f32 v35, v35, v170
v_cvt_pk_bf16_f32 v200, v16, v17
v_cvt_pk_bf16_f32 v201, v18, v19
v_cvt_pk_bf16_f32 v202, v20, v21
v_cvt_pk_bf16_f32 v203, v22, v23
v_cvt_pk_bf16_f32 v204, v24, v25
v_cvt_pk_bf16_f32 v205, v26, v27
v_cvt_pk_bf16_f32 v206, v28, v29
v_cvt_pk_bf16_f32 v207, v30, v31
v_cvt_pk_bf16_f32 v208, v32, v33
v_cvt_pk_bf16_f32 v209, v34, v35
v_permlane32_swap_b32 v200, v202
v_permlane32_swap_b32 v201, v203
buffer_store_dwordx4 v[200:203], v4, s[8:11], s27 offen offset:0 sc1
v_permlane32_swap_b32 v204, v206
v_permlane32_swap_b32 v205, v207
buffer_store_dwordx4 v[204:207], v4, s[8:11], s27 offen offset:2048 sc1
buffer_store_dwordx2 v[208:209], v5, s[8:11], s26 offen sc1
v_mul_f32 v14, v16, v16
v_mul_f32 v15, v17, v17
v_fmac_f32 v14, v18, v18
v_fmac_f32 v15, v19, v19
v_fmac_f32 v14, v20, v20
v_fmac_f32 v15, v21, v21
v_fmac_f32 v14, v22, v22
v_fmac_f32 v15, v23, v23
v_fmac_f32 v14, v24, v24
v_fmac_f32 v15, v25, v25
v_fmac_f32 v14, v26, v26
v_fmac_f32 v15, v27, v27
v_fmac_f32 v14, v28, v28
v_fmac_f32 v15, v29, v29
v_fmac_f32 v14, v30, v30
v_fmac_f32 v15, v31, v31
v_fmac_f32 v14, v32, v32
v_fmac_f32 v15, v33, v33
v_fmac_f32 v14, v34, v34
v_fmac_f32 v15, v35, v35
v_add_f32 v14, v14, v15
v_mov_b32 v15, v14
s_nop 1
v_permlane16_swap_b32 v14, v15
v_add_f32 v14, v14, v15
v_mov_b32 v15, v14
s_nop 1
v_permlane32_swap_b32 v14, v15
v_add_f32 v14, v14, v15
s_mov_b64 exec, 0xffff
buffer_store_dword v14, v6, s[8:11], s28 offen sc1
buffer_store_dword v170, v9, s[8:11], s29 offen sc1
s_mov_b64 exec, -1
s_waitcnt vmcnt(0)
s_barrier
s_cmp_eq_u32 s16, 0
s_cselect_b32 s20, 19910656, s56
v_mov_b32 v10, s63
v_mov_b32 v11, 1
s_mov_b64 exec, 1
buffer_store_dword v11, v10, s[8:11], s20 offen sc1
s_mov_b64 exec, -1
s_add_u32 s68, s67, 81920
s_mov_b32 m0, s68
s_add_u32 s69, s66, 81920
buffer_load_dwordx4 v2, s[36:39], s69 offen offset:0 sc1 lds
buffer_load_dwordx4 v2, s[36:39], s69 offen offset:1024 sc1 lds
buffer_load_dwordx4 v2, s[36:39], s69 offen offset:2048 sc1 lds
buffer_load_dwordx4 v2, s[36:39], s69 offen offset:3072 sc1 lds
s_add_u32 s68, s67, 86016
s_mov_b32 m0, s68
s_add_u32 s69, s66, 86016
buffer_load_dwordx4 v2, s[36:39], s69 offen offset:0 sc1 lds
s_add_u32 s68, s67, 87040
s_mov_b32 m0, s68
s_add_u32 s69, s66, 122880
buffer_load_dwordx4 v2, s[36:39], s69 offen offset:0 sc1 lds
buffer_load_dwordx4 v2, s[36:39], s69 offen offset:1024 sc1 lds
buffer_load_dwordx4 v2, s[36:39], s69 offen offset:2048 sc1 lds
buffer_load_dwordx4 v2, s[36:39], s69 offen offset:3072 sc1 lds
s_add_u32 s68, s67, 91136
s_mov_b32 m0, s68
s_add_u32 s69, s66, 126976
buffer_load_dwordx4 v2, s[36:39], s69 offen offset:0 sc1 lds
s_add_u32 s68, s67, 122880
s_mov_b32 m0, s68
s_add_u32 s69, s66, 102400
buffer_load_dwordx4 v2, s[36:39], s69 offen offset:0 sc1 lds
buffer_load_dwordx4 v2, s[36:39], s69 offen offset:1024 sc1 lds
buffer_load_dwordx4 v2, s[36:39], s69 offen offset:2048 sc1 lds
buffer_load_dwordx4 v2, s[36:39], s69 offen offset:3072 sc1 lds
s_add_u32 s68, s67, 126976
s_mov_b32 m0, s68
s_add_u32 s69, s66, 106496
buffer_load_dwordx4 v2, s[36:39], s69 offen offset:0 sc1 lds
v_and_b32 v15, 15, v1
v_lshlrev_b32 v15, 2, v15
v_add_u32 v15, s64, v15
s_mov_b32 s79, 19910656
buffer_load_dword v12, v15, s[8:11], s79 offen sc1
s_add_u32 s68, s67, 128000
s_mov_b32 m0, s68
s_add_u32 s69, s66, 143360
buffer_load_dwordx4 v2, s[36:39], s69 offen offset:0 sc1 lds
buffer_load_dwordx4 v2, s[36:39], s69 offen offset:1024 sc1 lds
buffer_load_dwordx4 v2, s[36:39], s69 offen offset:2048 sc1 lds
buffer_load_dwordx4 v2, s[36:39], s69 offen offset:3072 sc1 lds
s_add_u32 s68, s67, 132096
s_mov_b32 m0, s68
s_add_u32 s69, s66, 147456
buffer_load_dwordx4 v2, s[36:39], s69 offen offset:0 sc1 lds
s_waitcnt vmcnt(5)
v_cmp_ne_u32 vcc, 1, v12
s_nop 1
s_cbranch_vccz L_sy0_sequential_preLN__linear_attn_block__swiglu_ffn__prompt_kernel_ok
s_mov_b32 s21, 0
L_sy0_sequential_preLN__linear_attn_block__swiglu_ffn__prompt_kernel_lp:
s_sleep 2
buffer_load_dword v12, v15, s[8:11], s79 offen sc1
s_waitcnt vmcnt(0)
v_cmp_ne_u32 vcc, 1, v12
s_add_u32 s21, s21, 1
s_cmp_ge_u32 s21, 0x40000
s_cbranch_scc1 L_sy0_sequential_preLN__linear_attn_block__swiglu_ffn__prompt_kernel_ok
s_nop 1
s_cbranch_vccnz L_sy0_sequential_preLN__linear_attn_block__swiglu_ffn__prompt_kernel_lp
L_sy0_sequential_preLN__linear_attn_block__swiglu_ffn__prompt_kernel_ok:
s_nop 1
v_lshlrev_b32 v2, 4, v1
v_add_u32 v3, 0x1000, v2
v_and_b32 v4, 31, v1
s_lshl_b32 s26, s60, 2
s_add_u32 s26, s26, s16
s_mul_i32 s27, s26, 40960
s_add_u32 s27, s27, 2621440
v_lshlrev_b32 v5, 5, v4
s_lshl_b32 s28, s26, 10
s_add_u32 s28, s28, 21078016
s_add_u32 s34, s27, 0
buffer_load_dwordx4 a[0:3], v2, s[8:11], s34 offen offset:0 sc1
buffer_load_dwordx4 a[4:7], v2, s[8:11], s34 offen offset:1024 sc1
buffer_load_dwordx4 a[8:11], v2, s[8:11], s34 offen offset:2048 sc1
buffer_load_dwordx4 a[12:15], v2, s[8:11], s34 offen offset:3072 sc1
s_add_u32 s34, s27, 4096
buffer_load_dwordx4 a[16:19], v2, s[8:11], s34 offen offset:0 sc1
buffer_load_dwordx4 a[20:23], v2, s[8:11], s34 offen offset:1024 sc1
buffer_load_dwordx4 a[24:27], v2, s[8:11], s34 offen offset:2048 sc1
buffer_load_dwordx4 a[28:31], v2, s[8:11], s34 offen offset:3072 sc1
s_add_u32 s34, s27, 8192
buffer_load_dwordx4 a[32:35], v2, s[8:11], s34 offen offset:0 sc1
buffer_load_dwordx4 a[36:39], v2, s[8:11], s34 offen offset:1024 sc1
buffer_load_dwordx4 a[40:43], v2, s[8:11], s34 offen offset:2048 sc1
buffer_load_dwordx4 a[44:47], v2, s[8:11], s34 offen offset:3072 sc1
s_lshl_b32 s30, s60, 1
s_lshr_b32 s31, s16, 1
s_add_u32 s30, s30, s31
s_mul_i32 s30, s30, 108
s_mul_i32 s31, s61, 7
s_add_u32 s30, s30, s31
s_lshl_b32 s30, s30, 1
s_and_b32 s31, s16, 1
s_add_u32 s30, s30, s31
s_lshl_b32 s30, s30, 10
s_add_u32 s30, s30, 5242880
s_xor_b32 s32, s57, 1
s_mul_i32 s32, s32, 12288
s_add_u32 s32, s32, s30
s_lshl_b32 s31, s57, 11
s_add_u32 s30, s30, s31
s_cmp_eq_u32 s61, 15
s_cselect_b32 s31, 0x7f000000, s30
v_add_u32 v13, 0x10000, v2
v_add_u32 v14, 0x20000, v2
s_barrier
ds_read_b128 a[160:163], v2 offset:0
ds_read_b128 a[164:167], v2 offset:5120
ds_read_b128 a[168:171], v2 offset:1024
ds_read_b128 a[172:175], v2 offset:6144
ds_read_b128 a[176:179], v2 offset:2048
ds_read_b128 a[180:183], v2 offset:7168
ds_read_b128 a[184:187], v2 offset:3072
s_waitcnt lgkmcnt(3)
s_waitcnt vmcnt(11)
v_mfma_f32_32x32x16_bf16 v[16:31], a[160:163], a[0:3], 0
s_add_u32 s34, s27, 12288
buffer_load_dwordx4 a[48:51], v2, s[8:11], s34 offen offset:0 sc1
ds_read_b128 a[188:191], v2 offset:8192
v_mfma_f32_32x32x16_bf16 v[32:47], a[164:167], a[0:3], 0
buffer_load_dwordx4 a[52:55], v2, s[8:11], s34 offen offset:1024 sc1
ds_read_b128 a[160:163], v2 offset:4096
s_waitcnt vmcnt(12)
v_mfma_f32_32x32x16_bf16 v[16:31], a[168:171], a[4:7], v[16:31]
buffer_load_dwordx4 a[56:59], v2, s[8:11], s34 offen offset:2048 sc1
ds_read_b128 a[164:167], v2 offset:9216
v_mfma_f32_32x32x16_bf16 v[32:47], a[172:175], a[4:7], v[32:47]
buffer_load_dwordx4 a[60:63], v2, s[8:11], s34 offen offset:3072 sc1
ds_read_b128 a[168:171], v2 offset:10240
s_waitcnt lgkmcnt(3)
s_waitcnt vmcnt(13)
v_mfma_f32_32x32x16_bf16 v[16:31], a[176:179], a[8:11], v[16:31]
s_add_u32 s34, s27, 16384
buffer_load_dwordx4 a[64:67], v2, s[8:11], s34 offen offset:0 sc1
ds_read_b128 a[172:175], v2 offset:15360
v_mfma_f32_32x32x16_bf16 v[32:47], a[180:183], a[8:11], v[32:47]
buffer_load_dwordx4 a[68:71], v2, s[8:11], s34 offen offset:1024 sc1
ds_read_b128 a[176:179], v2 offset:11264
s_waitcnt vmcnt(14)
v_mfma_f32_32x32x16_bf16 v[16:31], a[184:187], a[12:15], v[16:31]
buffer_load_dwordx4 a[72:75], v2, s[8:11], s34 offen offset:2048 sc1
ds_read_b128 a[180:183], v2 offset:16384
v_mfma_f32_32x32x16_bf16 v[32:47], a[188:191], a[12:15], v[32:47]
buffer_load_dwordx4 a[76:79], v2, s[8:11], s34 offen offset:3072 sc1
ds_read_b128 a[184:187], v2 offset:12288
s_waitcnt lgkmcnt(3)
s_waitcnt vmcnt(15)
v_mfma_f32_32x32x16_bf16 v[16:31], a[160:163], a[16:19], v[16:31]
s_add_u32 s34, s27, 20480
buffer_load_dwordx4 a[80:83], v2, s[8:11], s34 offen offset:0 sc1
ds_read_b128 a[188:191], v2 offset:17408
v_mfma_f32_32x32x16_bf16 v[32:47], a[164:167], a[16:19], v[32:47]
buffer_load_dwordx4 a[84:87], v2, s[8:11], s34 offen offset:1024 sc1
ds_read_b128 a[160:163], v2 offset:13312
s_waitcnt vmcnt(16)
v_mfma_f32_32x32x16_bf16 v[16:31], a[168:171], a[20:23], v[16:31]
buffer_load_dwordx4 a[88:91], v2, s[8:11], s34 offen offset:2048 sc1
ds_read_b128 a[164:167], v2 offset:18432
v_mfma_f32_32x32x16_bf16 v[32:47], a[172:175], a[20:23], v[32:47]
buffer_load_dwordx4 a[92:95], v2, s[8:11], s34 offen offset:3072 sc1
ds_read_b128 a[168:171], v2 offset:14336
s_waitcnt lgkmcnt(3)
s_waitcnt vmcnt(17)
v_mfma_f32_32x32x16_bf16 v[16:31], a[176:179], a[24:27], v[16:31]
s_add_u32 s34, s27, 24576
buffer_load_dwordx4 a[96:99], v2, s[8:11], s34 offen offset:0 sc1
ds_read_b128 a[172:175], v2 offset:19456
v_mfma_f32_32x32x16_bf16 v[32:47], a[180:183], a[24:27], v[32:47]
buffer_load_dwordx4 a[100:103], v2, s[8:11], s34 offen offset:1024 sc1
ds_read_b128 a[176:179], v2 offset:20480
s_waitcnt vmcnt(18)
v_mfma_f32_32x32x16_bf16 v[16:31], a[184:187], a[28:31], v[16:31]
buffer_load_dwordx4 a[104:107], v2, s[8:11], s34 offen offset:2048 sc1
ds_read_b128 a[180:183], v2 offset:25600
v_mfma_f32_32x32x16_bf16 v[32:47], a[188:191], a[28:31], v[32:47]
buffer_load_dwordx4 a[108:111], v2, s[8:11], s34 offen offset:3072 sc1
ds_read_b128 a[184:187], v2 offset:21504
s_waitcnt lgkmcnt(3)
s_waitcnt vmcnt(19)
v_mfma_f32_32x32x16_bf16 v[16:31], a[160:163], a[32:35], v[16:31]
s_add_u32 s34, s27, 28672
buffer_load_dwordx4 a[112:115], v2, s[8:11], s34 offen offset:0 sc1
ds_read_b128 a[188:191], v2 offset:26624
v_mfma_f32_32x32x16_bf16 v[32:47], a[164:167], a[32:35], v[32:47]
buffer_load_dwordx4 a[116:119], v2, s[8:11], s34 offen offset:1024 sc1
ds_read_b128 a[160:163], v2 offset:22528
s_waitcnt vmcnt(20)
v_mfma_f32_32x32x16_bf16 v[16:31], a[168:171], a[36:39], v[16:31]
buffer_load_dwordx4 a[120:123], v2, s[8:11], s34 offen offset:2048 sc1
ds_read_b128 a[164:167], v2 offset:27648
v_mfma_f32_32x32x16_bf16 v[32:47], a[172:175], a[36:39], v[32:47]
buffer_load_dwordx4 a[124:127], v2, s[8:11], s34 offen offset:3072 sc1
ds_read_b128 a[168:171], v2 offset:23552
s_waitcnt lgkmcnt(3)
s_waitcnt vmcnt(21)
v_mfma_f32_32x32x16_bf16 v[16:31], a[176:179], a[40:43], v[16:31]
s_add_u32 s34, s27, 32768
buffer_load_dwordx4 a[128:131], v2, s[8:11], s34 offen offset:0 sc1
ds_read_b128 a[172:175], v2 offset:28672
v_mfma_f32_32x32x16_bf16 v[32:47], a[180:183], a[40:43], v[32:47]
buffer_load_dwordx4 a[132:135], v2, s[8:11], s34 offen offset:1024 sc1
ds_read_b128 a[176:179], v2 offset:24576
s_waitcnt vmcnt(22)
v_mfma_f32_32x32x16_bf16 v[16:31], a[184:187], a[44:47], v[16:31]
buffer_load_dwordx4 a[136:139], v2, s[8:11], s34 offen offset:2048 sc1
ds_read_b128 a[180:183], v2 offset:29696
v_mfma_f32_32x32x16_bf16 v[32:47], a[188:191], a[44:47], v[32:47]
buffer_load_dwordx4 a[140:143], v2, s[8:11], s34 offen offset:3072 sc1
ds_read_b128 a[184:187], v2 offset:30720
s_waitcnt lgkmcnt(3)
s_waitcnt vmcnt(23)
v_mfma_f32_32x32x16_bf16 v[16:31], a[160:163], a[48:51], v[16:31]
s_add_u32 s34, s27, 36864
buffer_load_dwordx4 a[144:147], v2, s[8:11], s34 offen offset:0 sc1
ds_read_b128 a[188:191], v2 offset:35840
v_mfma_f32_32x32x16_bf16 v[32:47], a[164:167], a[48:51], v[32:47]
buffer_load_dwordx4 a[148:151], v2, s[8:11], s34 offen offset:1024 sc1
ds_read_b128 a[160:163], v2 offset:31744
s_waitcnt vmcnt(24)
v_mfma_f32_32x32x16_bf16 v[16:31], a[168:171], a[52:55], v[16:31]
buffer_load_dwordx4 a[152:155], v2, s[8:11], s34 offen offset:2048 sc1
ds_read_b128 a[164:167], v2 offset:36864
v_mfma_f32_32x32x16_bf16 v[32:47], a[172:175], a[52:55], v[32:47]
buffer_load_dwordx4 a[156:159], v2, s[8:11], s34 offen offset:3072 sc1
ds_read_b128 a[168:171], v2 offset:32768
s_waitcnt lgkmcnt(3)
s_waitcnt vmcnt(25)
v_mfma_f32_32x32x16_bf16 v[16:31], a[176:179], a[56:59], v[16:31]
buffer_load_dwordx4 v[80:83], v5, s[8:11], s28 offen offset:0 sc1
ds_read_b128 a[172:175], v2 offset:37888
v_mfma_f32_32x32x16_bf16 v[32:47], a[180:183], a[56:59], v[32:47]
buffer_load_dwordx4 v[84:87], v5, s[8:11], s28 offen offset:16 sc1
ds_read_b128 a[176:179], v2 offset:33792
s_waitcnt vmcnt(26)
v_mfma_f32_32x32x16_bf16 v[16:31], a[184:187], a[60:63], v[16:31]
ds_read_b128 a[180:183], v2 offset:38912
v_mfma_f32_32x32x16_bf16 v[32:47], a[188:191], a[60:63], v[32:47]
ds_read_b128 a[184:187], v2 offset:34816
s_waitcnt lgkmcnt(3)
s_waitcnt vmcnt(25)
v_mfma_f32_32x32x16_bf16 v[16:31], a[160:163], a[64:67], v[16:31]
ds_read_b128 a[188:191], v2 offset:39936
v_mfma_f32_32x32x16_bf16 v[32:47], a[164:167], a[64:67], v[32:47]
ds_read_b128 a[160:163], v2 offset:40960
s_waitcnt vmcnt(24)
v_mfma_f32_32x32x16_bf16 v[16:31], a[168:171], a[68:71], v[16:31]
ds_read_b128 a[164:167], v2 offset:46080
v_mfma_f32_32x32x16_bf16 v[32:47], a[172:175], a[68:71], v[32:47]
ds_read_b128 a[168:171], v2 offset:41984
s_waitcnt lgkmcnt(3)
s_waitcnt vmcnt(23)
v_mfma_f32_32x32x16_bf16 v[16:31], a[176:179], a[72:75], v[16:31]
s_add_u32 s73, s71, 0
buffer_load_dwordx4 v[212:215], v2, s[8:11], s73 offen sc1
ds_read_b128 a[172:175], v2 offset:47104
v_mfma_f32_32x32x16_bf16 v[32:47], a[180:183], a[72:75], v[32:47]
ds_read_b128 a[176:179], v2 offset:43008
s_waitcnt vmcnt(23)
v_mfma_f32_32x32x16_bf16 v[16:31], a[184:187], a[76:79], v[16:31]
ds_read_b128 a[180:183], v2 offset:48128
v_mfma_f32_32x32x16_bf16 v[32:47], a[188:191], a[76:79], v[32:47]
s_add_u32 s73, s71, 55296
buffer_load_dwordx4 v[216:219], v2, s[8:11], s73 offen sc1
ds_read_b128 a[184:187], v2 offset:44032
s_waitcnt lgkmcnt(3)
s_waitcnt vmcnt(23)
v_mfma_f32_32x32x16_bf16 v[16:31], a[160:163], a[80:83], v[16:31]
ds_read_b128 a[188:191], v2 offset:49152
v_mfma_f32_32x32x16_bf16 v[32:47], a[164:167], a[80:83], v[32:47]
ds_read_b128 a[160:163], v2 offset:45056
s_waitcnt vmcnt(22)
v_mfma_f32_32x32x16_bf16 v[16:31], a[168:171], a[84:87], v[16:31]
ds_read_b128 a[164:167], v2 offset:50176
v_mfma_f32_32x32x16_bf16 v[32:47], a[172:175], a[84:87], v[32:47]
s_add_u32 s73, s71, 110592
buffer_load_dwordx4 v[220:223], v2, s[8:11], s73 offen sc1
ds_read_b128 a[168:171], v2 offset:51200
s_waitcnt lgkmcnt(3)
s_waitcnt vmcnt(22)
v_mfma_f32_32x32x16_bf16 v[16:31], a[176:179], a[88:91], v[16:31]
ds_read_b128 a[172:175], v2 offset:56320
v_mfma_f32_32x32x16_bf16 v[32:47], a[180:183], a[88:91], v[32:47]
ds_read_b128 a[176:179], v2 offset:52224
s_waitcnt vmcnt(21)
v_mfma_f32_32x32x16_bf16 v[16:31], a[184:187], a[92:95], v[16:31]
ds_read_b128 a[180:183], v2 offset:57344
v_mfma_f32_32x32x16_bf16 v[32:47], a[188:191], a[92:95], v[32:47]
s_add_u32 s73, s71, 165888
buffer_load_dwordx4 v[224:227], v2, s[8:11], s73 offen sc1
ds_read_b128 a[184:187], v2 offset:53248
s_waitcnt lgkmcnt(3)
s_waitcnt vmcnt(21)
v_mfma_f32_32x32x16_bf16 v[16:31], a[160:163], a[96:99], v[16:31]
ds_read_b128 a[188:191], v2 offset:58368
v_mfma_f32_32x32x16_bf16 v[32:47], a[164:167], a[96:99], v[32:47]
ds_read_b128 a[160:163], v2 offset:54272
s_waitcnt vmcnt(20)
v_mfma_f32_32x32x16_bf16 v[16:31], a[168:171], a[100:103], v[16:31]
ds_read_b128 a[164:167], v2 offset:59392
v_mfma_f32_32x32x16_bf16 v[32:47], a[172:175], a[100:103], v[32:47]
s_add_u32 s73, s71, 221184
buffer_load_dwordx4 v[228:231], v2, s[8:11], s73 offen sc1
ds_read_b128 a[168:171], v2 offset:55296
s_waitcnt lgkmcnt(3)
s_waitcnt vmcnt(20)
v_mfma_f32_32x32x16_bf16 v[16:31], a[176:179], a[104:107], v[16:31]
ds_read_b128 a[172:175], v2 offset:60416
v_mfma_f32_32x32x16_bf16 v[32:47], a[180:183], a[104:107], v[32:47]
ds_read_b128 a[176:179], v2 offset:61440
s_waitcnt vmcnt(19)
v_mfma_f32_32x32x16_bf16 v[16:31], a[184:187], a[108:111], v[16:31]
ds_read_b128 a[180:183], v13 offset:1024
v_mfma_f32_32x32x16_bf16 v[32:47], a[188:191], a[108:111], v[32:47]
s_add_u32 s73, s71, 1024
buffer_load_dwordx4 v[232:235], v2, s[8:11], s73 offen sc1
ds_read_b128 a[184:187], v2 offset:62464
s_waitcnt lgkmcnt(3)
s_waitcnt vmcnt(19)
v_mfma_f32_32x32x16_bf16 v[16:31], a[160:163], a[112:115], v[16:31]
ds_read_b128 a[188:191], v13 offset:2048
v_mfma_f32_32x32x16_bf16 v[32:47], a[164:167], a[112:115], v[32:47]
ds_read_b128 a[160:163], v2 offset:63488
s_waitcnt vmcnt(18)
v_mfma_f32_32x32x16_bf16 v[16:31], a[168:171], a[116:119], v[16:31]
s_add_u32 s73, s71, 56320
buffer_load_dwordx4 v[236:239], v2, s[8:11], s73 offen sc1
ds_read_b128 a[164:167], v13 offset:3072
v_mfma_f32_32x32x16_bf16 v[32:47], a[172:175], a[116:119], v[32:47]
ds_read_b128 a[168:171], v2 offset:64512
s_waitcnt lgkmcnt(3)
s_waitcnt vmcnt(18)
v_mfma_f32_32x32x16_bf16 v[16:31], a[176:179], a[120:123], v[16:31]
s_waitcnt vmcnt(8)
v_add_f32 v80, v80, v81
v_add_f32 v80, v80, v82
ds_read_b128 a[172:175], v13 offset:4096
v_mfma_f32_32x32x16_bf16 v[32:47], a[180:183], a[120:123], v[32:47]
v_add_f32 v80, v80, v83
s_waitcnt vmcnt(7)
v_add_f32 v80, v80, v84
ds_read_b128 a[176:179], v13 offset:0
v_mfma_f32_32x32x16_bf16 v[16:31], a[184:187], a[124:127], v[16:31]
s_add_u32 s73, s71, 111616
buffer_load_dwordx4 v[240:243], v2, s[8:11], s73 offen sc1
v_add_f32 v80, v80, v85
v_add_f32 v80, v80, v86
ds_read_b128 a[180:183], v13 offset:5120
v_mfma_f32_32x32x16_bf16 v[32:47], a[188:191], a[124:127], v[32:47]
v_add_f32 v80, v80, v87
v_mov_b32 v81, 0x3727c5ac
ds_read_b128 a[184:187], v13 offset:6144
s_waitcnt lgkmcnt(3)
v_mfma_f32_32x32x16_bf16 v[16:31], a[160:163], a[128:131], v[16:31]
v_fmac_f32 v81, 0x3acccccd, v80
v_rsq_f32 v8, v81
ds_read_b128 a[188:191], v13 offset:11264
v_mfma_f32_32x32x16_bf16 v[32:47], a[164:167], a[128:131], v[32:47]
v_rcp_f32 v9, v81
v_mul_f32 v8, 0xbfb8aa3b, v8
ds_read_b128 a[160:163], v13 offset:7168
v_mfma_f32_32x32x16_bf16 v[16:31], a[168:171], a[132:135], v[16:31]
s_add_u32 s73, s71, 166912
buffer_load_dwordx4 v[244:247], v2, s[8:11], s73 offen sc1
ds_read_b128 a[164:167], v13 offset:12288
v_mfma_f32_32x32x16_bf16 v[32:47], a[172:175], a[132:135], v[32:47]
s_barrier
ds_read_b128 a[168:171], v13 offset:8192
s_waitcnt lgkmcnt(3)
v_mfma_f32_32x32x16_bf16 v[16:31], a[176:179], a[136:139], v[16:31]
s_add_u32 s68, s67, 0
s_mov_b32 m0, s68
s_add_u32 s69, s66, 163840
buffer_load_dwordx4 v2, s[36:39], s69 offen offset:0 sc1 lds
ds_read_b128 a[172:175], v13 offset:13312
v_mfma_f32_32x32x16_bf16 v[32:47], a[180:183], a[136:139], v[32:47]
ds_read_b128 a[176:179], v13 offset:9216
v_mfma_f32_32x32x16_bf16 v[16:31], a[184:187], a[140:143], v[16:31]
buffer_load_dwordx4 v2, s[36:39], s69 offen offset:1024 sc1 lds
ds_read_b128 a[180:183], v13 offset:14336
v_mfma_f32_32x32x16_bf16 v[32:47], a[188:191], a[140:143], v[32:47]
ds_read_b128 a[184:187], v13 offset:10240
s_waitcnt lgkmcnt(3)
v_mfma_f32_32x32x16_bf16 v[16:31], a[160:163], a[144:147], v[16:31]
buffer_load_dwordx4 v2, s[36:39], s69 offen offset:2048 sc1 lds
ds_read_b128 a[188:191], v13 offset:15360
v_mfma_f32_32x32x16_bf16 v[32:47], a[164:167], a[144:147], v[32:47]
ds_read_b128 a[160:163], v13 offset:16384
v_mfma_f32_32x32x16_bf16 v[16:31], a[168:171], a[148:151], v[16:31]
buffer_load_dwordx4 v2, s[36:39], s69 offen offset:3072 sc1 lds
ds_read_b128 a[164:167], v13 offset:21504
v_mfma_f32_32x32x16_bf16 v[32:47], a[172:175], a[148:151], v[32:47]
ds_read_b128 a[168:171], v13 offset:17408
s_waitcnt lgkmcnt(3)
v_mfma_f32_32x32x16_bf16 v[16:31], a[176:179], a[152:155], v[16:31]
s_add_u32 s68, s67, 4096
s_mov_b32 m0, s68
s_add_u32 s69, s66, 167936
buffer_load_dwordx4 v2, s[36:39], s69 offen offset:0 sc1 lds
ds_read_b128 a[172:175], v13 offset:22528
v_mfma_f32_32x32x16_bf16 v[32:47], a[180:183], a[152:155], v[32:47]
ds_read_b128 a[176:179], v13 offset:18432
v_mfma_f32_32x32x16_bf16 v[16:31], a[184:187], a[156:159], v[16:31]
s_add_u32 s68, s67, 5120
s_mov_b32 m0, s68
s_add_u32 s69, s66, 204800
buffer_load_dwordx4 v2, s[36:39], s69 offen offset:0 sc1 lds
ds_read_b128 a[180:183], v13 offset:23552
v_mfma_f32_32x32x16_bf16 v[32:47], a[188:191], a[156:159], v[32:47]
ds_read_b128 a[184:187], v13 offset:19456
s_waitcnt lgkmcnt(3)
v_mfma_f32_32x32x16_bf16 v[48:63], a[160:163], a[0:3], 0
buffer_load_dwordx4 v2, s[36:39], s69 offen offset:1024 sc1 lds
ds_read_b128 a[188:191], v13 offset:24576
v_mfma_f32_32x32x16_bf16 v[64:79], a[164:167], a[0:3], 0
v_mul_f32 v96, v8, v16
v_mul_f32 v97, v8, v17
ds_read_b128 a[160:163], v13 offset:20480
v_mfma_f32_32x32x16_bf16 v[48:63], a[168:171], a[4:7], v[48:63]
buffer_load_dwordx4 v2, s[36:39], s69 offen offset:2048 sc1 lds
v_mul_f32 v98, v8, v18
v_mul_f32 v99, v8, v19
ds_read_b128 a[164:167], v13 offset:25600
v_mfma_f32_32x32x16_bf16 v[64:79], a[172:175], a[4:7], v[64:79]
v_exp_f32 v96, v96
v_mul_f32 v104, v16, v24
ds_read_b128 a[168:171], v13 offset:26624
s_waitcnt lgkmcnt(3)
v_mfma_f32_32x32x16_bf16 v[48:63], a[176:179], a[8:11], v[48:63]
buffer_load_dwordx4 v2, s[36:39], s69 offen offset:3072 sc1 lds
v_exp_f32 v97, v97
v_mul_f32 v105, v17, v25
ds_read_b128 a[172:175], v13 offset:31744
v_mfma_f32_32x32x16_bf16 v[64:79], a[180:183], a[8:11], v[64:79]
v_exp_f32 v98, v98
v_mul_f32 v106, v18, v26
ds_read_b128 a[176:179], v13 offset:27648
v_mfma_f32_32x32x16_bf16 v[48:63], a[184:187], a[12:15], v[48:63]
s_add_u32 s68, s67, 9216
s_mov_b32 m0, s68
s_add_u32 s69, s66, 208896
buffer_load_dwordx4 v2, s[36:39], s69 offen offset:0 sc1 lds
v_exp_f32 v99, v99
v_mul_f32 v107, v19, v27
ds_read_b128 a[180:183], v13 offset:32768
v_mfma_f32_32x32x16_bf16 v[64:79], a[188:191], a[12:15], v[64:79]
v_add_f32 v96, 1.0, v96
v_add_f32 v97, 1.0, v97
ds_read_b128 a[184:187], v13 offset:28672
s_waitcnt lgkmcnt(3)
v_mfma_f32_32x32x16_bf16 v[48:63], a[160:163], a[16:19], v[48:63]
s_add_u32 s73, s71, 222208
buffer_load_dwordx4 v[248:251], v2, s[8:11], s73 offen sc1
v_add_f32 v98, 1.0, v98
v_add_f32 v99, 1.0, v99
ds_read_b128 a[188:191], v13 offset:33792
v_mfma_f32_32x32x16_bf16 v[64:79], a[164:167], a[16:19], v[64:79]
v_rcp_f32 v96, v96
v_mul_f32 v104, v9, v104
ds_read_b128 a[160:163], v13 offset:29696
v_mfma_f32_32x32x16_bf16 v[48:63], a[168:171], a[20:23], v[48:63]
s_add_u32 s73, s71, 4096
buffer_load_dwordx4 v[252:255], v2, s[8:11], s73 offen sc1
v_rcp_f32 v97, v97
v_mul_f32 v105, v9, v105
ds_read_b128 a[164:167], v13 offset:34816
v_mfma_f32_32x32x16_bf16 v[64:79], a[172:175], a[20:23], v[64:79]
v_rcp_f32 v98, v98
v_mul_f32 v106, v9, v106
ds_read_b128 a[168:171], v13 offset:30720
s_waitcnt lgkmcnt(3)
v_mfma_f32_32x32x16_bf16 v[48:63], a[176:179], a[24:27], v[48:63]
s_add_u32 s73, s71, 59392
buffer_load_dwordx4 a[216:219], v2, s[8:11], s73 offen sc1
v_rcp_f32 v99, v99
v_mul_f32 v107, v9, v107
ds_read_b128 a[172:175], v13 offset:35840
v_mfma_f32_32x32x16_bf16 v[64:79], a[180:183], a[24:27], v[64:79]
v_mul_f32 v104, v104, v96
v_mul_f32 v105, v105, v97
ds_read_b128 a[176:179], v13 offset:36864
v_mfma_f32_32x32x16_bf16 v[48:63], a[184:187], a[28:31], v[48:63]
s_add_u32 s73, s71, 114688
buffer_load_dwordx4 a[220:223], v2, s[8:11], s73 offen sc1
v_mul_f32 v106, v106, v98
v_mul_f32 v107, v107, v99
ds_read_b128 a[180:183], v13 offset:41984
v_mfma_f32_32x32x16_bf16 v[64:79], a[188:191], a[28:31], v[64:79]
v_cvt_pk_bf16_f32 v88, v104, v105
v_cvt_pk_bf16_f32 v89, v106, v107
ds_read_b128 a[184:187], v13 offset:37888
s_waitcnt lgkmcnt(3)
v_mfma_f32_32x32x16_bf16 v[48:63], a[160:163], a[32:35], v[48:63]
s_add_u32 s73, s71, 169984
buffer_load_dwordx4 a[224:227], v2, s[8:11], s73 offen sc1
v_mul_f32 v100, v8, v20
v_mul_f32 v101, v8, v21
ds_read_b128 a[188:191], v13 offset:43008
v_mfma_f32_32x32x16_bf16 v[64:79], a[164:167], a[32:35], v[64:79]
v_mul_f32 v102, v8, v22
v_mul_f32 v103, v8, v23
ds_read_b128 a[160:163], v13 offset:38912
v_mfma_f32_32x32x16_bf16 v[48:63], a[168:171], a[36:39], v[48:63]
s_add_u32 s73, s71, 225280
buffer_load_dwordx4 a[228:231], v2, s[8:11], s73 offen sc1
v_exp_f32 v100, v100
v_mul_f32 v108, v20, v28
ds_read_b128 a[164:167], v13 offset:44032
v_mfma_f32_32x32x16_bf16 v[64:79], a[172:175], a[36:39], v[64:79]
v_exp_f32 v101, v101
v_mul_f32 v109, v21, v29
ds_read_b128 a[168:171], v13 offset:39936
s_waitcnt lgkmcnt(3)
v_mfma_f32_32x32x16_bf16 v[48:63], a[176:179], a[40:43], v[48:63]
s_add_u32 s73, s71, 5120
buffer_load_dwordx4 a[232:235], v2, s[8:11], s73 offen sc1
v_exp_f32 v102, v102
v_mul_f32 v110, v22, v30
ds_read_b128 a[172:175], v13 offset:45056
v_mfma_f32_32x32x16_bf16 v[64:79], a[180:183], a[40:43], v[64:79]
v_exp_f32 v103, v103
v_mul_f32 v111, v23, v31
ds_read_b128 a[176:179], v13 offset:40960
v_mfma_f32_32x32x16_bf16 v[48:63], a[184:187], a[44:47], v[48:63]
s_add_u32 s73, s71, 60416
buffer_load_dwordx4 a[236:239], v2, s[8:11], s73 offen sc1
v_add_f32 v100, 1.0, v100
v_add_f32 v101, 1.0, v101
ds_read_b128 a[180:183], v13 offset:46080
v_mfma_f32_32x32x16_bf16 v[64:79], a[188:191], a[44:47], v[64:79]
v_add_f32 v102, 1.0, v102
v_add_f32 v103, 1.0, v103
ds_read_b128 a[184:187], v13 offset:47104
s_waitcnt lgkmcnt(3)
v_mfma_f32_32x32x16_bf16 v[48:63], a[160:163], a[48:51], v[48:63]
s_add_u32 s73, s71, 115712
buffer_load_dwordx4 a[240:243], v2, s[8:11], s73 offen sc1
v_rcp_f32 v100, v100
v_mul_f32 v108, v9, v108
ds_read_b128 a[188:191], v13 offset:52224
v_mfma_f32_32x32x16_bf16 v[64:79], a[164:167], a[48:51], v[64:79]
v_rcp_f32 v101, v101
v_mul_f32 v109, v9, v109
ds_read_b128 a[160:163], v13 offset:48128
v_mfma_f32_32x32x16_bf16 v[48:63], a[168:171], a[52:55], v[48:63]
s_add_u32 s73, s71, 171008
buffer_load_dwordx4 a[244:247], v2, s[8:11], s73 offen sc1
v_rcp_f32 v102, v102
v_mul_f32 v110, v9, v110
ds_read_b128 a[164:167], v13 offset:53248
v_mfma_f32_32x32x16_bf16 v[64:79], a[172:175], a[52:55], v[64:79]
v_rcp_f32 v103, v103
v_mul_f32 v111, v9, v111
s_barrier
ds_read_b128 a[168:171], v13 offset:49152
s_waitcnt lgkmcnt(3)
v_mfma_f32_32x32x16_bf16 v[48:63], a[176:179], a[56:59], v[48:63]
s_add_u32 s68, s67, 40960
s_mov_b32 m0, s68
s_add_u32 s69, s66, 184320
buffer_load_dwordx4 v2, s[36:39], s69 offen offset:0 sc1 lds
v_mul_f32 v108, v108, v100
v_mul_f32 v109, v109, v101
ds_read_b128 a[172:175], v13 offset:54272
v_mfma_f32_32x32x16_bf16 v[64:79], a[180:183], a[56:59], v[64:79]
v_mul_f32 v110, v110, v102
v_mul_f32 v111, v111, v103
ds_read_b128 a[176:179], v13 offset:50176
v_mfma_f32_32x32x16_bf16 v[48:63], a[184:187], a[60:63], v[48:63]
buffer_load_dwordx4 v2, s[36:39], s69 offen offset:1024 sc1 lds
v_cvt_pk_bf16_f32 v90, v108, v109
v_cvt_pk_bf16_f32 v91, v110, v111
ds_read_b128 a[180:183], v13 offset:55296
v_mfma_f32_32x32x16_bf16 v[64:79], a[188:191], a[60:63], v[64:79]
s_add_u32 s35, s30, 0
buffer_store_dwordx4 v[88:91], v2, s[8:11], s35 offen sc1
ds_read_b128 a[184:187], v13 offset:51200
s_waitcnt lgkmcnt(3)
v_mfma_f32_32x32x16_bf16 v[48:63], a[160:163], a[64:67], v[48:63]
buffer_load_dwordx4 v2, s[36:39], s69 offen offset:2048 sc1 lds
v_mul_f32 v96, v8, v32
v_mul_f32 v97, v8, v33
ds_read_b128 a[188:191], v13 offset:56320
v_mfma_f32_32x32x16_bf16 v[64:79], a[164:167], a[64:67], v[64:79]
v_mul_f32 v98, v8, v34
v_mul_f32 v99, v8, v35
ds_read_b128 a[160:163], v13 offset:57344
v_mfma_f32_32x32x16_bf16 v[48:63], a[168:171], a[68:71], v[48:63]
buffer_load_dwordx4 v2, s[36:39], s69 offen offset:3072 sc1 lds
v_exp_f32 v96, v96
v_mul_f32 v104, v32, v40
ds_read_b128 a[164:167], v13 offset:62464
v_mfma_f32_32x32x16_bf16 v[64:79], a[172:175], a[68:71], v[64:79]
v_exp_f32 v97, v97
v_mul_f32 v105, v33, v41
ds_read_b128 a[168:171], v13 offset:58368
s_waitcnt lgkmcnt(3)
v_mfma_f32_32x32x16_bf16 v[48:63], a[176:179], a[72:75], v[48:63]
s_add_u32 s68, s67, 45056
s_mov_b32 m0, s68
s_add_u32 s69, s66, 188416
buffer_load_dwordx4 v2, s[36:39], s69 offen offset:0 sc1 lds
v_exp_f32 v98, v98
v_mul_f32 v106, v34, v42
ds_read_b128 a[172:175], v13 offset:63488
v_mfma_f32_32x32x16_bf16 v[64:79], a[180:183], a[72:75], v[64:79]
v_exp_f32 v99, v99
v_mul_f32 v107, v35, v43
ds_read_b128 a[176:179], v13 offset:59392
v_mfma_f32_32x32x16_bf16 v[48:63], a[184:187], a[76:79], v[48:63]
s_add_u32 s68, s67, 46080
s_mov_b32 m0, s68
s_add_u32 s69, s66, 225280
buffer_load_dwordx4 v2, s[36:39], s69 offen offset:0 sc1 lds
v_add_f32 v96, 1.0, v96
v_add_f32 v97, 1.0, v97
ds_read_b128 a[180:183], v13 offset:64512
v_mfma_f32_32x32x16_bf16 v[64:79], a[188:191], a[76:79], v[64:79]
v_add_f32 v98, 1.0, v98
v_add_f32 v99, 1.0, v99
ds_read_b128 a[184:187], v13 offset:60416
s_waitcnt lgkmcnt(3)
v_mfma_f32_32x32x16_bf16 v[48:63], a[160:163], a[80:83], v[48:63]
buffer_load_dwordx4 v2, s[36:39], s69 offen offset:1024 sc1 lds
v_rcp_f32 v96, v96
v_mul_f32 v104, v9, v104
ds_read_b128 a[188:191], v14 offset:0
v_mfma_f32_32x32x16_bf16 v[64:79], a[164:167], a[80:83], v[64:79]
v_rcp_f32 v97, v97
v_mul_f32 v105, v9, v105
ds_read_b128 a[160:163], v13 offset:61440
v_mfma_f32_32x32x16_bf16 v[48:63], a[168:171], a[84:87], v[48:63]
buffer_load_dwordx4 v2, s[36:39], s69 offen offset:2048 sc1 lds
v_rcp_f32 v98, v98
v_mul_f32 v106, v9, v106
ds_read_b128 a[164:167], v14 offset:1024
v_mfma_f32_32x32x16_bf16 v[64:79], a[172:175], a[84:87], v[64:79]
v_rcp_f32 v99, v99
v_mul_f32 v107, v9, v107
ds_read_b128 a[168:171], v14 offset:2048
s_waitcnt lgkmcnt(3)
v_mfma_f32_32x32x16_bf16 v[48:63], a[176:179], a[88:91], v[48:63]
buffer_load_dwordx4 v2, s[36:39], s69 offen offset:3072 sc1 lds
v_mul_f32 v104, v104, v96
v_mul_f32 v105, v105, v97
ds_read_b128 a[172:175], v14 offset:7168
v_mfma_f32_32x32x16_bf16 v[64:79], a[180:183], a[88:91], v[64:79]
v_mul_f32 v106, v106, v98
v_mul_f32 v107, v107, v99
ds_read_b128 a[176:179], v14 offset:3072
v_mfma_f32_32x32x16_bf16 v[48:63], a[184:187], a[92:95], v[48:63]
s_add_u32 s68, s67, 50176
s_mov_b32 m0, s68
s_add_u32 s69, s66, 229376
buffer_load_dwordx4 v2, s[36:39], s69 offen offset:0 sc1 lds
v_cvt_pk_bf16_f32 v92, v104, v105
v_cvt_pk_bf16_f32 v93, v106, v107
ds_read_b128 a[180:183], v14 offset:8192
v_mfma_f32_32x32x16_bf16 v[64:79], a[188:191], a[92:95], v[64:79]
v_mul_f32 v100, v8, v36
v_mul_f32 v101, v8, v37
ds_read_b128 a[184:187], v14 offset:4096
s_waitcnt lgkmcnt(3)
v_mfma_f32_32x32x16_bf16 v[48:63], a[160:163], a[96:99], v[48:63]
s_add_u32 s73, s71, 226304
buffer_load_dwordx4 a[248:251], v2, s[8:11], s73 offen sc1
v_mul_f32 v102, v8, v38
v_mul_f32 v103, v8, v39
ds_read_b128 a[188:191], v14 offset:9216
v_mfma_f32_32x32x16_bf16 v[64:79], a[164:167], a[96:99], v[64:79]
v_exp_f32 v100, v100
v_mul_f32 v108, v36, v44
ds_read_b128 a[160:163], v14 offset:5120
v_mfma_f32_32x32x16_bf16 v[48:63], a[168:171], a[100:103], v[48:63]
s_add_u32 s73, s71, 7168
buffer_load_dwordx4 a[252:255], v2, s[8:11], s73 offen sc1
v_exp_f32 v101, v101
v_mul_f32 v109, v37, v45
ds_read_b128 a[164:167], v14 offset:10240
v_mfma_f32_32x32x16_bf16 v[64:79], a[172:175], a[100:103], v[64:79]
v_exp_f32 v102, v102
v_mul_f32 v110, v38, v46
ds_read_b128 a[168:171], v14 offset:6144
s_waitcnt lgkmcnt(3)
v_mfma_f32_32x32x16_bf16 v[48:63], a[176:179], a[104:107], v[48:63]
s_add_u32 s73, s71, 62464
buffer_load_dwordx4 v[120:123], v2, s[8:11], s73 offen sc1
v_exp_f32 v103, v103
v_mul_f32 v111, v39, v47
ds_read_b128 a[172:175], v14 offset:11264
v_mfma_f32_32x32x16_bf16 v[64:79], a[180:183], a[104:107], v[64:79]
v_add_f32 v100, 1.0, v100
v_add_f32 v101, 1.0, v101
ds_read_b128 a[176:179], v14 offset:12288
v_mfma_f32_32x32x16_bf16 v[48:63], a[184:187], a[108:111], v[48:63]
s_add_u32 s73, s71, 117760
buffer_load_dwordx4 v[124:127], v2, s[8:11], s73 offen sc1
v_add_f32 v102, 1.0, v102
v_add_f32 v103, 1.0, v103
ds_read_b128 a[180:183], v14 offset:17408
v_mfma_f32_32x32x16_bf16 v[64:79], a[188:191], a[108:111], v[64:79]
v_rcp_f32 v100, v100
v_mul_f32 v108, v9, v108
ds_read_b128 a[184:187], v14 offset:13312
s_waitcnt lgkmcnt(3)
v_mfma_f32_32x32x16_bf16 v[48:63], a[160:163], a[112:115], v[48:63]
s_add_u32 s73, s71, 173056
buffer_load_dwordx4 v[128:131], v2, s[8:11], s73 offen sc1
v_rcp_f32 v101, v101
v_mul_f32 v109, v9, v109
ds_read_b128 a[188:191], v14 offset:18432
v_mfma_f32_32x32x16_bf16 v[64:79], a[164:167], a[112:115], v[64:79]
v_rcp_f32 v102, v102
v_mul_f32 v110, v9, v110
ds_read_b128 a[160:163], v14 offset:14336
v_mfma_f32_32x32x16_bf16 v[48:63], a[168:171], a[116:119], v[48:63]
s_add_u32 s73, s71, 228352
buffer_load_dwordx4 v[132:135], v2, s[8:11], s73 offen sc1
v_rcp_f32 v103, v103
v_mul_f32 v111, v9, v111
ds_read_b128 a[164:167], v14 offset:19456
v_mfma_f32_32x32x16_bf16 v[64:79], a[172:175], a[116:119], v[64:79]
v_mul_f32 v108, v108, v100
v_mul_f32 v109, v109, v101
ds_read_b128 a[168:171], v14 offset:15360
s_waitcnt lgkmcnt(3)
v_mfma_f32_32x32x16_bf16 v[48:63], a[176:179], a[120:123], v[48:63]
s_add_u32 s73, s71, 8192
buffer_load_dwordx4 v[136:139], v2, s[8:11], s73 offen sc1
v_mul_f32 v110, v110, v102
v_mul_f32 v111, v111, v103
ds_read_b128 a[172:175], v14 offset:20480
v_mfma_f32_32x32x16_bf16 v[64:79], a[180:183], a[120:123], v[64:79]
v_cvt_pk_bf16_f32 v94, v108, v109
v_cvt_pk_bf16_f32 v95, v110, v111
ds_read_b128 a[176:179], v14 offset:16384
v_mfma_f32_32x32x16_bf16 v[48:63], a[184:187], a[124:127], v[48:63]
s_add_u32 s73, s71, 63488
buffer_load_dwordx4 v[140:143], v2, s[8:11], s73 offen sc1
s_add_u32 s35, s30, 2048
buffer_store_dwordx4 v[92:95], v2, s[8:11], s35 offen sc1
ds_read_b128 a[180:183], v14 offset:21504
v_mfma_f32_32x32x16_bf16 v[64:79], a[188:191], a[124:127], v[64:79]
ds_read_b128 a[184:187], v14 offset:22528
s_waitcnt lgkmcnt(3)
v_mfma_f32_32x32x16_bf16 v[48:63], a[160:163], a[128:131], v[48:63]
s_add_u32 s73, s71, 118784
buffer_load_dwordx4 v[144:147], v2, s[8:11], s73 offen sc1
ds_read_b128 a[188:191], v14 offset:27648
v_mfma_f32_32x32x16_bf16 v[64:79], a[164:167], a[128:131], v[64:79]
ds_read_b128 a[160:163], v14 offset:23552
v_mfma_f32_32x32x16_bf16 v[48:63], a[168:171], a[132:135], v[48:63]
s_add_u32 s73, s71, 174080
buffer_load_dwordx4 v[148:151], v2, s[8:11], s73 offen sc1
ds_read_b128 a[164:167], v14 offset:28672
v_mfma_f32_32x32x16_bf16 v[64:79], a[172:175], a[132:135], v[64:79]
s_waitcnt vmcnt(32)
s_barrier
ds_read_b128 a[168:171], v14 offset:24576
s_waitcnt lgkmcnt(3)
v_mfma_f32_32x32x16_bf16 v[48:63], a[176:179], a[136:139], v[48:63]
s_add_u32 s68, s67, 81920
s_mov_b32 m0, s68
s_add_u32 s69, s59, 0
buffer_load_dwordx4 v2, s[36:39], s69 offen offset:0 sc1 lds
ds_read_b128 a[172:175], v14 offset:29696
v_mfma_f32_32x32x16_bf16 v[64:79], a[180:183], a[136:139], v[64:79]
ds_read_b128 a[176:179], v14 offset:25600
v_mfma_f32_32x32x16_bf16 v[48:63], a[184:187], a[140:143], v[48:63]
buffer_load_dwordx4 v2, s[36:39], s69 offen offset:1024 sc1 lds
ds_read_b128 a[180:183], v14 offset:30720
v_mfma_f32_32x32x16_bf16 v[64:79], a[188:191], a[140:143], v[64:79]
ds_read_b128 a[184:187], v14 offset:26624
s_waitcnt lgkmcnt(3)
v_mfma_f32_32x32x16_bf16 v[48:63], a[160:163], a[144:147], v[48:63]
buffer_load_dwordx4 v2, s[36:39], s69 offen offset:2048 sc1 lds
ds_read_b128 a[188:191], v14 offset:31744
v_mfma_f32_32x32x16_bf16 v[64:79], a[164:167], a[144:147], v[64:79]
ds_read_b128 a[160:163], v2 offset:0
v_mfma_f32_32x32x16_bf16 v[48:63], a[168:171], a[148:151], v[48:63]
buffer_load_dwordx4 v2, s[36:39], s69 offen offset:3072 sc1 lds
ds_read_b128 a[164:167], v2 offset:5120
v_mfma_f32_32x32x16_bf16 v[64:79], a[172:175], a[148:151], v[64:79]
ds_read_b128 a[168:171], v2 offset:1024
s_waitcnt lgkmcnt(3)
v_mfma_f32_32x32x16_bf16 v[48:63], a[176:179], a[152:155], v[48:63]
s_add_u32 s68, s67, 86016
s_mov_b32 m0, s68
s_add_u32 s69, s59, 4096
buffer_load_dwordx4 v2, s[36:39], s69 offen offset:0 sc1 lds
ds_read_b128 a[172:175], v2 offset:6144
v_mfma_f32_32x32x16_bf16 v[64:79], a[180:183], a[152:155], v[64:79]
ds_read_b128 a[176:179], v2 offset:2048
v_mfma_f32_32x32x16_bf16 v[48:63], a[184:187], a[156:159], v[48:63]
buffer_load_dwordx4 v2, s[36:39], s69 offen offset:1024 sc1 lds
ds_read_b128 a[180:183], v2 offset:7168
v_mfma_f32_32x32x16_bf16 v[64:79], a[188:191], a[156:159], v[64:79]
ds_read_b128 a[184:187], v2 offset:3072
s_waitcnt lgkmcnt(3)
v_mfma_f32_32x32x16_bf16 v[16:31], a[160:163], a[0:3], 0
buffer_load_dwordx4 v2, s[36:39], s69 offen offset:2048 sc1 lds
ds_read_b128 a[188:191], v2 offset:8192
v_mfma_f32_32x32x16_bf16 v[32:47], a[164:167], a[0:3], 0
s_nop 2
v_mul_f32 v96, v8, v48
v_mul_f32 v97, v8, v49
ds_read_b128 a[160:163], v2 offset:4096
v_mfma_f32_32x32x16_bf16 v[16:31], a[168:171], a[4:7], v[16:31]
buffer_load_dwordx4 v2, s[36:39], s69 offen offset:3072 sc1 lds
v_mul_f32 v98, v8, v50
v_mul_f32 v99, v8, v51
ds_read_b128 a[164:167], v2 offset:9216
v_mfma_f32_32x32x16_bf16 v[32:47], a[172:175], a[4:7], v[32:47]
v_exp_f32 v96, v96
v_mul_f32 v104, v48, v56
ds_read_b128 a[168:171], v2 offset:10240
s_waitcnt lgkmcnt(3)
v_mfma_f32_32x32x16_bf16 v[16:31], a[176:179], a[8:11], v[16:31]
s_add_u32 s68, s67, 90112
s_mov_b32 m0, s68
s_add_u32 s69, s59, 8192
buffer_load_dwordx4 v2, s[36:39], s69 offen offset:0 sc1 lds
v_exp_f32 v97, v97
v_mul_f32 v105, v49, v57
ds_read_b128 a[172:175], v2 offset:15360
v_mfma_f32_32x32x16_bf16 v[32:47], a[180:183], a[8:11], v[32:47]
v_exp_f32 v98, v98
v_mul_f32 v106, v50, v58
ds_read_b128 a[176:179], v2 offset:11264
v_mfma_f32_32x32x16_bf16 v[16:31], a[184:187], a[12:15], v[16:31]
buffer_load_dwordx4 v2, s[36:39], s69 offen offset:1024 sc1 lds
v_exp_f32 v99, v99
v_mul_f32 v107, v51, v59
ds_read_b128 a[180:183], v2 offset:16384
v_mfma_f32_32x32x16_bf16 v[32:47], a[188:191], a[12:15], v[32:47]
v_add_f32 v96, 1.0, v96
v_add_f32 v97, 1.0, v97
ds_read_b128 a[184:187], v2 offset:12288
s_waitcnt lgkmcnt(3)
v_mfma_f32_32x32x16_bf16 v[16:31], a[160:163], a[16:19], v[16:31]
s_add_u32 s73, s71, 229376
buffer_load_dwordx4 v[152:155], v2, s[8:11], s73 offen sc1
v_add_f32 v98, 1.0, v98
v_add_f32 v99, 1.0, v99
ds_read_b128 a[188:191], v2 offset:17408
v_mfma_f32_32x32x16_bf16 v[32:47], a[164:167], a[16:19], v[32:47]
v_rcp_f32 v96, v96
v_mul_f32 v104, v9, v104
ds_read_b128 a[160:163], v2 offset:13312
v_mfma_f32_32x32x16_bf16 v[16:31], a[168:171], a[20:23], v[16:31]
s_add_u32 s73, s71, 11264
buffer_load_dwordx4 v[156:159], v2, s[8:11], s73 offen sc1
v_rcp_f32 v97, v97
v_mul_f32 v105, v9, v105
ds_read_b128 a[164:167], v2 offset:18432
v_mfma_f32_32x32x16_bf16 v[32:47], a[172:175], a[20:23], v[32:47]
v_rcp_f32 v98, v98
v_mul_f32 v106, v9, v106
ds_read_b128 a[168:171], v2 offset:14336
s_waitcnt lgkmcnt(3)
v_mfma_f32_32x32x16_bf16 v[16:31], a[176:179], a[24:27], v[16:31]
s_add_u32 s73, s71, 66560
buffer_load_dwordx4 v[160:163], v2, s[8:11], s73 offen sc1
v_rcp_f32 v99, v99
v_mul_f32 v107, v9, v107
ds_read_b128 a[172:175], v2 offset:19456
v_mfma_f32_32x32x16_bf16 v[32:47], a[180:183], a[24:27], v[32:47]
v_mul_f32 v104, v104, v96
v_mul_f32 v105, v105, v97
ds_read_b128 a[176:179], v2 offset:20480
v_mfma_f32_32x32x16_bf16 v[16:31], a[184:187], a[28:31], v[16:31]
s_add_u32 s73, s71, 121856
buffer_load_dwordx4 v[164:167], v2, s[8:11], s73 offen sc1
v_mul_f32 v106, v106, v98
v_mul_f32 v107, v107, v99
ds_read_b128 a[180:183], v2 offset:25600
v_mfma_f32_32x32x16_bf16 v[32:47], a[188:191], a[28:31], v[32:47]
v_cvt_pk_bf16_f32 v88, v104, v105
v_cvt_pk_bf16_f32 v89, v106, v107
ds_read_b128 a[184:187], v2 offset:21504
s_waitcnt lgkmcnt(3)
v_mfma_f32_32x32x16_bf16 v[16:31], a[160:163], a[32:35], v[16:31]
s_add_u32 s73, s71, 177152
buffer_load_dwordx4 v[168:171], v2, s[8:11], s73 offen sc1
v_mul_f32 v100, v8, v52
v_mul_f32 v101, v8, v53
ds_read_b128 a[188:191], v2 offset:26624
v_mfma_f32_32x32x16_bf16 v[32:47], a[164:167], a[32:35], v[32:47]
v_mul_f32 v102, v8, v54
v_mul_f32 v103, v8, v55
ds_read_b128 a[160:163], v2 offset:22528
v_mfma_f32_32x32x16_bf16 v[16:31], a[168:171], a[36:39], v[16:31]
s_add_u32 s73, s71, 232448
buffer_load_dwordx4 v[172:175], v2, s[8:11], s73 offen sc1
v_exp_f32 v100, v100
v_mul_f32 v108, v52, v60
ds_read_b128 a[164:167], v2 offset:27648
v_mfma_f32_32x32x16_bf16 v[32:47], a[172:175], a[36:39], v[32:47]
v_exp_f32 v101, v101
v_mul_f32 v109, v53, v61
ds_read_b128 a[168:171], v2 offset:23552
s_waitcnt lgkmcnt(3)
v_mfma_f32_32x32x16_bf16 v[16:31], a[176:179], a[40:43], v[16:31]
s_add_u32 s73, s72, 12288
buffer_load_dwordx4 v[176:179], v2, s[8:11], s73 offen sc1
v_exp_f32 v102, v102
v_mul_f32 v110, v54, v62
ds_read_b128 a[172:175], v2 offset:28672
v_mfma_f32_32x32x16_bf16 v[32:47], a[180:183], a[40:43], v[32:47]
v_exp_f32 v103, v103
v_mul_f32 v111, v55, v63
ds_read_b128 a[176:179], v2 offset:24576
v_mfma_f32_32x32x16_bf16 v[16:31], a[184:187], a[44:47], v[16:31]
s_add_u32 s73, s72, 67584
buffer_load_dwordx4 v[180:183], v2, s[8:11], s73 offen sc1
v_add_f32 v100, 1.0, v100
v_add_f32 v101, 1.0, v101
ds_read_b128 a[180:183], v2 offset:29696
v_mfma_f32_32x32x16_bf16 v[32:47], a[188:191], a[44:47], v[32:47]
v_add_f32 v102, 1.0, v102
v_add_f32 v103, 1.0, v103
ds_read_b128 a[184:187], v2 offset:30720
s_waitcnt lgkmcnt(3)
v_mfma_f32_32x32x16_bf16 v[16:31], a[160:163], a[48:51], v[16:31]
s_add_u32 s73, s72, 122880
buffer_load_dwordx4 v[184:187], v2, s[8:11], s73 offen sc1
v_rcp_f32 v100, v100
v_mul_f32 v108, v9, v108
ds_read_b128 a[188:191], v2 offset:35840
v_mfma_f32_32x32x16_bf16 v[32:47], a[164:167], a[48:51], v[32:47]
v_rcp_f32 v101, v101
v_mul_f32 v109, v9, v109
ds_read_b128 a[160:163], v2 offset:31744
v_mfma_f32_32x32x16_bf16 v[16:31], a[168:171], a[52:55], v[16:31]
s_add_u32 s73, s72, 178176
buffer_load_dwordx4 v[188:191], v2, s[8:11], s73 offen sc1
v_rcp_f32 v102, v102
v_mul_f32 v110, v9, v110
ds_read_b128 a[164:167], v2 offset:36864
v_mfma_f32_32x32x16_bf16 v[32:47], a[172:175], a[52:55], v[32:47]
v_rcp_f32 v103, v103
v_mul_f32 v111, v9, v111
s_waitcnt vmcnt(31)
s_barrier
ds_read_b128 a[168:171], v2 offset:32768
s_waitcnt lgkmcnt(3)
v_mfma_f32_32x32x16_bf16 v[16:31], a[176:179], a[56:59], v[16:31]
s_add_u32 s73, s72, 233472
buffer_load_dwordx4 v[192:195], v2, s[8:11], s73 offen sc1
v_mul_f32 v108, v108, v100
v_mul_f32 v109, v109, v101
ds_read_b128 a[172:175], v2 offset:37888
v_mfma_f32_32x32x16_bf16 v[32:47], a[180:183], a[56:59], v[32:47]
v_mul_f32 v110, v110, v102
v_mul_f32 v111, v111, v103
ds_read_b128 a[176:179], v2 offset:33792
v_mfma_f32_32x32x16_bf16 v[16:31], a[184:187], a[60:63], v[16:31]
s_add_u32 s73, s71, 2048
buffer_load_dwordx4 v[196:199], v2, s[8:11], s73 offen sc1
v_cvt_pk_bf16_f32 v90, v108, v109
v_cvt_pk_bf16_f32 v91, v110, v111
ds_read_b128 a[180:183], v2 offset:38912
v_mfma_f32_32x32x16_bf16 v[32:47], a[188:191], a[60:63], v[32:47]
s_add_u32 s35, s31, 4096
buffer_store_dwordx4 v[88:91], v2, s[8:11], s35 offen sc1
ds_read_b128 a[184:187], v2 offset:34816
s_waitcnt lgkmcnt(3)
v_mfma_f32_32x32x16_bf16 v[16:31], a[160:163], a[64:67], v[16:31]
s_add_u32 s73, s71, 57344
buffer_load_dwordx4 v[200:203], v2, s[8:11], s73 offen sc1
v_mul_f32 v96, v8, v64
v_mul_f32 v97, v8, v65
ds_read_b128 a[188:191], v2 offset:39936
v_mfma_f32_32x32x16_bf16 v[32:47], a[164:167], a[64:67], v[32:47]
v_mul_f32 v98, v8, v66
v_mul_f32 v99, v8, v67
ds_read_b128 a[160:163], v2 offset:40960
v_mfma_f32_32x32x16_bf16 v[16:31], a[168:171], a[68:71], v[16:31]
v_exp_f32 v96, v96
v_mul_f32 v104, v64, v72
ds_read_b128 a[164:167], v2 offset:46080
v_mfma_f32_32x32x16_bf16 v[32:47], a[172:175], a[68:71], v[32:47]
s_add_u32 s73, s71, 112640
buffer_load_dwordx4 v[204:207], v2, s[8:11], s73 offen sc1
v_exp_f32 v97, v97
v_mul_f32 v105, v65, v73
ds_read_b128 a[168:171], v2 offset:41984
s_waitcnt lgkmcnt(3)
v_mfma_f32_32x32x16_bf16 v[16:31], a[176:179], a[72:75], v[16:31]
v_exp_f32 v98, v98
v_mul_f32 v106, v66, v74
ds_read_b128 a[172:175], v2 offset:47104
v_mfma_f32_32x32x16_bf16 v[32:47], a[180:183], a[72:75], v[32:47]
v_exp_f32 v99, v99
v_mul_f32 v107, v67, v75
ds_read_b128 a[176:179], v2 offset:43008
v_mfma_f32_32x32x16_bf16 v[16:31], a[184:187], a[76:79], v[16:31]
v_add_f32 v96, 1.0, v96
v_add_f32 v97, 1.0, v97
ds_read_b128 a[180:183], v2 offset:48128
v_mfma_f32_32x32x16_bf16 v[32:47], a[188:191], a[76:79], v[32:47]
s_add_u32 s73, s71, 167936
buffer_load_dwordx4 v[208:211], v2, s[8:11], s73 offen sc1
v_add_f32 v98, 1.0, v98
v_add_f32 v99, 1.0, v99
ds_read_b128 a[184:187], v2 offset:44032
s_waitcnt lgkmcnt(3)
v_mfma_f32_32x32x16_bf16 v[16:31], a[160:163], a[80:83], v[16:31]
v_rcp_f32 v96, v96
v_mul_f32 v104, v9, v104
ds_read_b128 a[188:191], v2 offset:49152
v_mfma_f32_32x32x16_bf16 v[32:47], a[164:167], a[80:83], v[32:47]
v_rcp_f32 v97, v97
v_mul_f32 v105, v9, v105
ds_read_b128 a[160:163], v2 offset:45056
v_mfma_f32_32x32x16_bf16 v[16:31], a[168:171], a[84:87], v[16:31]
v_rcp_f32 v98, v98
v_mul_f32 v106, v9, v106
ds_read_b128 a[164:167], v2 offset:50176
v_mfma_f32_32x32x16_bf16 v[32:47], a[172:175], a[84:87], v[32:47]
s_add_u32 s73, s71, 223232
buffer_load_dwordx4 a[192:195], v2, s[8:11], s73 offen sc1
v_rcp_f32 v99, v99
v_mul_f32 v107, v9, v107
ds_read_b128 a[168:171], v2 offset:51200
s_waitcnt lgkmcnt(3)
v_mfma_f32_32x32x16_bf16 v[16:31], a[176:179], a[88:91], v[16:31]
v_mul_f32 v104, v104, v96
v_mul_f32 v105, v105, v97
ds_read_b128 a[172:175], v2 offset:56320
v_mfma_f32_32x32x16_bf16 v[32:47], a[180:183], a[88:91], v[32:47]
v_mul_f32 v106, v106, v98
v_mul_f32 v107, v107, v99
ds_read_b128 a[176:179], v2 offset:52224
v_mfma_f32_32x32x16_bf16 v[16:31], a[184:187], a[92:95], v[16:31]
v_cvt_pk_bf16_f32 v92, v104, v105
v_cvt_pk_bf16_f32 v93, v106, v107
ds_read_b128 a[180:183], v2 offset:57344
v_mfma_f32_32x32x16_bf16 v[32:47], a[188:191], a[92:95], v[32:47]
s_add_u32 s73, s71, 3072
buffer_load_dwordx4 a[196:199], v2, s[8:11], s73 offen sc1
v_mul_f32 v100, v8, v68
v_mul_f32 v101, v8, v69
ds_read_b128 a[184:187], v2 offset:53248
s_waitcnt lgkmcnt(3)
v_mfma_f32_32x32x16_bf16 v[16:31], a[160:163], a[96:99], v[16:31]
v_mul_f32 v102, v8, v70
v_mul_f32 v103, v8, v71
ds_read_b128 a[188:191], v2 offset:58368
v_mfma_f32_32x32x16_bf16 v[32:47], a[164:167], a[96:99], v[32:47]
v_exp_f32 v100, v100
v_mul_f32 v108, v68, v76
ds_read_b128 a[160:163], v2 offset:54272
v_mfma_f32_32x32x16_bf16 v[16:31], a[168:171], a[100:103], v[16:31]
s_add_u32 s73, s71, 58368
buffer_load_dwordx4 a[200:203], v2, s[8:11], s73 offen sc1
v_exp_f32 v101, v101
v_mul_f32 v109, v69, v77
ds_read_b128 a[164:167], v2 offset:59392
v_mfma_f32_32x32x16_bf16 v[32:47], a[172:175], a[100:103], v[32:47]
v_exp_f32 v102, v102
v_mul_f32 v110, v70, v78
ds_read_b128 a[168:171], v2 offset:55296
s_waitcnt lgkmcnt(3)
v_mfma_f32_32x32x16_bf16 v[16:31], a[176:179], a[104:107], v[16:31]
v_exp_f32 v103, v103
v_mul_f32 v111, v71, v79
ds_read_b128 a[172:175], v2 offset:60416
v_mfma_f32_32x32x16_bf16 v[32:47], a[180:183], a[104:107], v[32:47]
v_add_f32 v100, 1.0, v100
v_add_f32 v101, 1.0, v101
ds_read_b128 a[176:179], v2 offset:61440
v_mfma_f32_32x32x16_bf16 v[16:31], a[184:187], a[108:111], v[16:31]
s_add_u32 s73, s71, 113664
buffer_load_dwordx4 a[204:207], v2, s[8:11], s73 offen sc1
v_add_f32 v102, 1.0, v102
v_add_f32 v103, 1.0, v103
ds_read_b128 a[180:183], v13 offset:1024
v_mfma_f32_32x32x16_bf16 v[32:47], a[188:191], a[108:111], v[32:47]
v_rcp_f32 v100, v100
v_mul_f32 v108, v9, v108
ds_read_b128 a[184:187], v2 offset:62464
s_waitcnt lgkmcnt(3)
v_mfma_f32_32x32x16_bf16 v[16:31], a[160:163], a[112:115], v[16:31]
v_rcp_f32 v101, v101
v_mul_f32 v109, v9, v109
ds_read_b128 a[188:191], v13 offset:2048
v_mfma_f32_32x32x16_bf16 v[32:47], a[164:167], a[112:115], v[32:47]
v_rcp_f32 v102, v102
v_mul_f32 v110, v9, v110
ds_read_b128 a[160:163], v2 offset:63488
v_mfma_f32_32x32x16_bf16 v[16:31], a[168:171], a[116:119], v[16:31]
s_add_u32 s73, s71, 168960
buffer_load_dwordx4 a[208:211], v2, s[8:11], s73 offen sc1
v_rcp_f32 v103, v103
v_mul_f32 v111, v9, v111
ds_read_b128 a[164:167], v13 offset:3072
v_mfma_f32_32x32x16_bf16 v[32:47], a[172:175], a[116:119], v[32:47]
v_mul_f32 v108, v108, v100
v_mul_f32 v109, v109, v101
ds_read_b128 a[168:171], v2 offset:64512
s_waitcnt lgkmcnt(3)
v_mfma_f32_32x32x16_bf16 v[16:31], a[176:179], a[120:123], v[16:31]
v_mul_f32 v110, v110, v102
v_mul_f32 v111, v111, v103
ds_read_b128 a[172:175], v13 offset:4096
v_mfma_f32_32x32x16_bf16 v[32:47], a[180:183], a[120:123], v[32:47]
v_cvt_pk_bf16_f32 v94, v108, v109
v_cvt_pk_bf16_f32 v95, v110, v111
ds_read_b128 a[176:179], v13 offset:0
v_mfma_f32_32x32x16_bf16 v[16:31], a[184:187], a[124:127], v[16:31]
s_add_u32 s73, s71, 224256
buffer_load_dwordx4 a[212:215], v2, s[8:11], s73 offen sc1
s_add_u32 s35, s31, 6144
buffer_store_dwordx4 v[92:95], v2, s[8:11], s35 offen sc1
ds_read_b128 a[180:183], v13 offset:5120
v_mfma_f32_32x32x16_bf16 v[32:47], a[188:191], a[124:127], v[32:47]
ds_read_b128 a[184:187], v13 offset:6144
s_waitcnt lgkmcnt(3)
v_mfma_f32_32x32x16_bf16 v[16:31], a[160:163], a[128:131], v[16:31]
ds_read_b128 a[188:191], v13 offset:11264
v_mfma_f32_32x32x16_bf16 v[32:47], a[164:167], a[128:131], v[32:47]
ds_read_b128 a[160:163], v13 offset:7168
v_mfma_f32_32x32x16_bf16 v[16:31], a[168:171], a[132:135], v[16:31]
ds_read_b128 a[164:167], v13 offset:12288
v_mfma_f32_32x32x16_bf16 v[32:47], a[172:175], a[132:135], v[32:47]
s_waitcnt vmcnt(23)
s_waitcnt vmcnt(0)
s_barrier
s_cmp_eq_u32 s16, 0
s_cselect_b32 s20, 19912704, s56
v_mov_b32 v10, s63
v_mov_b32 v11, 1
s_mov_b64 exec, 1
buffer_store_dword v11, v10, s[8:11], s20 offen sc1
s_mov_b64 exec, -1
ds_read_b128 a[168:171], v13 offset:8192
s_waitcnt lgkmcnt(3)
v_mfma_f32_32x32x16_bf16 v[16:31], a[176:179], a[136:139], v[16:31]
s_add_u32 s68, s67, 122880
s_mov_b32 m0, s68
s_add_u32 s73, s71, 6144
buffer_load_dwordx4 v2, s[8:11], s73 offen sc1 lds
ds_read_b128 a[172:175], v13 offset:13312
v_mfma_f32_32x32x16_bf16 v[32:47], a[180:183], a[136:139], v[32:47]
ds_read_b128 a[176:179], v13 offset:9216
v_mfma_f32_32x32x16_bf16 v[16:31], a[184:187], a[140:143], v[16:31]
s_add_u32 s68, s67, 123904
s_mov_b32 m0, s68
s_add_u32 s73, s71, 61440
buffer_load_dwordx4 v2, s[8:11], s73 offen sc1 lds
ds_read_b128 a[180:183], v13 offset:14336
v_mfma_f32_32x32x16_bf16 v[32:47], a[188:191], a[140:143], v[32:47]
ds_read_b128 a[184:187], v13 offset:10240
s_waitcnt lgkmcnt(3)
v_mfma_f32_32x32x16_bf16 v[16:31], a[160:163], a[144:147], v[16:31]
s_add_u32 s68, s67, 124928
s_mov_b32 m0, s68
s_add_u32 s73, s71, 116736
buffer_load_dwordx4 v2, s[8:11], s73 offen sc1 lds
ds_read_b128 a[188:191], v13 offset:15360
v_mfma_f32_32x32x16_bf16 v[32:47], a[164:167], a[144:147], v[32:47]
ds_read_b128 a[160:163], v13 offset:16384
v_mfma_f32_32x32x16_bf16 v[16:31], a[168:171], a[148:151], v[16:31]
s_add_u32 s68, s67, 125952
s_mov_b32 m0, s68
s_add_u32 s73, s71, 172032
buffer_load_dwordx4 v2, s[8:11], s73 offen sc1 lds
ds_read_b128 a[164:167], v13 offset:17408
v_mfma_f32_32x32x16_bf16 v[32:47], a[172:175], a[148:151], v[32:47]
ds_read_b128 a[168:171], v13 offset:18432
s_waitcnt lgkmcnt(3)
v_mfma_f32_32x32x16_bf16 v[16:31], a[176:179], a[152:155], v[16:31]
s_add_u32 s68, s67, 126976
s_mov_b32 m0, s68
s_add_u32 s73, s71, 227328
buffer_load_dwordx4 v2, s[8:11], s73 offen sc1 lds
ds_read_b128 a[172:175], v13 offset:19456
v_mfma_f32_32x32x16_bf16 v[32:47], a[180:183], a[152:155], v[32:47]
ds_read_b128 a[176:179], v13 offset:20480
v_mfma_f32_32x32x16_bf16 v[16:31], a[184:187], a[156:159], v[16:31]
s_add_u32 s68, s67, 128000
s_mov_b32 m0, s68
s_add_u32 s73, s71, 9216
buffer_load_dwordx4 v2, s[8:11], s73 offen sc1 lds
ds_read_b128 a[180:183], v13 offset:21504
v_mfma_f32_32x32x16_bf16 v[32:47], a[188:191], a[156:159], v[32:47]
ds_read_b128 a[184:187], v13 offset:22528
s_waitcnt lgkmcnt(3)
v_mfma_f32_32x32x16_bf16 v[48:63], a[160:163], a[0:3], 0
s_add_u32 s68, s67, 129024
s_mov_b32 m0, s68
s_add_u32 s73, s71, 64512
buffer_load_dwordx4 v2, s[8:11], s73 offen sc1 lds
ds_read_b128 a[188:191], v13 offset:23552
v_mfma_f32_32x32x16_bf16 v[64:79], a[164:167], a[4:7], 0
v_mul_f32 v96, v8, v16
v_mul_f32 v97, v8, v17
ds_read_b128 a[160:163], v13 offset:24576
v_mfma_f32_32x32x16_bf16 v[48:63], a[168:171], a[8:11], v[48:63]
s_add_u32 s68, s67, 130048
s_mov_b32 m0, s68
s_add_u32 s73, s71, 119808
buffer_load_dwordx4 v2, s[8:11], s73 offen sc1 lds
v_mul_f32 v98, v8, v18
v_mul_f32 v99, v8, v19
ds_read_b128 a[164:167], v13 offset:25600
v_mfma_f32_32x32x16_bf16 v[64:79], a[172:175], a[12:15], v[64:79]
v_exp_f32 v96, v96
v_mul_f32 v104, v16, v24
ds_read_b128 a[168:171], v13 offset:26624
s_waitcnt lgkmcnt(3)
v_mfma_f32_32x32x16_bf16 v[48:63], a[176:179], a[16:19], v[48:63]
s_add_u32 s68, s67, 131072
s_mov_b32 m0, s68
s_add_u32 s73, s71, 175104
buffer_load_dwordx4 v2, s[8:11], s73 offen sc1 lds
v_exp_f32 v97, v97
v_mul_f32 v105, v17, v25
ds_read_b128 a[172:175], v13 offset:27648
v_mfma_f32_32x32x16_bf16 v[64:79], a[180:183], a[20:23], v[64:79]
v_exp_f32 v98, v98
v_mul_f32 v106, v18, v26
ds_read_b128 a[176:179], v13 offset:28672
v_mfma_f32_32x32x16_bf16 v[48:63], a[184:187], a[24:27], v[48:63]
s_add_u32 s68, s67, 132096
s_mov_b32 m0, s68
s_add_u32 s73, s71, 230400
buffer_load_dwordx4 v2, s[8:11], s73 offen sc1 lds
v_exp_f32 v99, v99
v_mul_f32 v107, v19, v27
ds_read_b128 a[180:183], v13 offset:29696
v_mfma_f32_32x32x16_bf16 v[64:79], a[188:191], a[28:31], v[64:79]
v_add_f32 v96, 1.0, v96
v_add_f32 v97, 1.0, v97
ds_read_b128 a[184:187], v13 offset:30720
s_waitcnt lgkmcnt(3)
v_mfma_f32_32x32x16_bf16 v[48:63], a[160:163], a[32:35], v[48:63]
s_add_u32 s68, s67, 0
s_mov_b32 m0, s68
s_add_u32 s73, s71, 10240
buffer_load_dwordx4 v2, s[8:11], s73 offen sc1 lds
v_add_f32 v98, 1.0, v98
v_add_f32 v99, 1.0, v99
ds_read_b128 a[188:191], v13 offset:31744
v_mfma_f32_32x32x16_bf16 v[64:79], a[164:167], a[36:39], v[64:79]
v_rcp_f32 v96, v96
v_mul_f32 v104, v9, v104
ds_read_b128 a[160:163], v13 offset:32768
v_mfma_f32_32x32x16_bf16 v[48:63], a[168:171], a[40:43], v[48:63]
s_add_u32 s68, s67, 1024
s_mov_b32 m0, s68
s_add_u32 s73, s71, 65536
buffer_load_dwordx4 v2, s[8:11], s73 offen sc1 lds
v_rcp_f32 v97, v97
v_mul_f32 v105, v9, v105
ds_read_b128 a[164:167], v13 offset:33792
v_mfma_f32_32x32x16_bf16 v[64:79], a[172:175], a[44:47], v[64:79]
v_rcp_f32 v98, v98
v_mul_f32 v106, v9, v106
ds_read_b128 a[168:171], v13 offset:34816
s_waitcnt lgkmcnt(3)
v_mfma_f32_32x32x16_bf16 v[48:63], a[176:179], a[48:51], v[48:63]
s_add_u32 s68, s67, 2048
s_mov_b32 m0, s68
s_add_u32 s73, s71, 120832
buffer_load_dwordx4 v2, s[8:11], s73 offen sc1 lds
v_rcp_f32 v99, v99
v_mul_f32 v107, v9, v107
ds_read_b128 a[172:175], v13 offset:35840
v_mfma_f32_32x32x16_bf16 v[64:79], a[180:183], a[52:55], v[64:79]
v_mul_f32 v104, v104, v96
v_mul_f32 v105, v105, v97
ds_read_b128 a[176:179], v13 offset:36864
v_mfma_f32_32x32x16_bf16 v[48:63], a[184:187], a[56:59], v[48:63]
s_add_u32 s68, s67, 3072
s_mov_b32 m0, s68
s_add_u32 s73, s71, 176128
buffer_load_dwordx4 v2, s[8:11], s73 offen sc1 lds
v_mul_f32 v106, v106, v98
v_mul_f32 v107, v107, v99
ds_read_b128 a[180:183], v13 offset:37888
v_mfma_f32_32x32x16_bf16 v[64:79], a[188:191], a[60:63], v[64:79]
v_cvt_pk_bf16_f32 v88, v104, v105
v_cvt_pk_bf16_f32 v89, v106, v107
ds_read_b128 a[184:187], v13 offset:38912
s_waitcnt lgkmcnt(3)
v_mfma_f32_32x32x16_bf16 v[48:63], a[160:163], a[64:67], v[48:63]
s_add_u32 s68, s67, 4096
s_mov_b32 m0, s68
s_add_u32 s73, s71, 231424
buffer_load_dwordx4 v2, s[8:11], s73 offen sc1 lds
v_mul_f32 v100, v8, v20
v_mul_f32 v101, v8, v21
ds_read_b128 a[188:191], v13 offset:39936
v_mfma_f32_32x32x16_bf16 v[64:79], a[164:167], a[68:71], v[64:79]
v_mul_f32 v102, v8, v22
v_mul_f32 v103, v8, v23
ds_read_b128 a[160:163], v13 offset:40960
v_mfma_f32_32x32x16_bf16 v[48:63], a[168:171], a[72:75], v[48:63]
s_add_u32 s68, s67, 5120
s_mov_b32 m0, s68
s_add_u32 s73, s72, 13312
buffer_load_dwordx4 v2, s[8:11], s73 offen sc1 lds
v_exp_f32 v100, v100
v_mul_f32 v108, v20, v28
ds_read_b128 a[164:167], v13 offset:41984
v_mfma_f32_32x32x16_bf16 v[64:79], a[172:175], a[76:79], v[64:79]
v_exp_f32 v101, v101
v_mul_f32 v109, v21, v29
ds_read_b128 a[168:171], v13 offset:43008
s_waitcnt lgkmcnt(3)
v_mfma_f32_32x32x16_bf16 v[48:63], a[176:179], a[80:83], v[48:63]
s_add_u32 s68, s67, 6144
s_mov_b32 m0, s68
s_add_u32 s73, s72, 68608
buffer_load_dwordx4 v2, s[8:11], s73 offen sc1 lds
v_exp_f32 v102, v102
v_mul_f32 v110, v22, v30
ds_read_b128 a[172:175], v13 offset:44032
v_mfma_f32_32x32x16_bf16 v[64:79], a[180:183], a[84:87], v[64:79]
v_exp_f32 v103, v103
v_mul_f32 v111, v23, v31
ds_read_b128 a[176:179], v13 offset:45056
v_mfma_f32_32x32x16_bf16 v[48:63], a[184:187], a[88:91], v[48:63]
s_add_u32 s68, s67, 7168
s_mov_b32 m0, s68
s_add_u32 s73, s72, 123904
buffer_load_dwordx4 v2, s[8:11], s73 offen sc1 lds
v_add_f32 v100, 1.0, v100
v_add_f32 v101, 1.0, v101
ds_read_b128 a[180:183], v13 offset:46080
v_mfma_f32_32x32x16_bf16 v[64:79], a[188:191], a[92:95], v[64:79]
v_add_f32 v102, 1.0, v102
v_add_f32 v103, 1.0, v103
ds_read_b128 a[184:187], v13 offset:47104
s_waitcnt lgkmcnt(3)
v_mfma_f32_32x32x16_bf16 v[48:63], a[160:163], a[96:99], v[48:63]
s_add_u32 s68, s67, 8192
s_mov_b32 m0, s68
s_add_u32 s73, s72, 179200
buffer_load_dwordx4 v2, s[8:11], s73 offen sc1 lds
v_rcp_f32 v100, v100
v_mul_f32 v108, v9, v108
ds_read_b128 a[188:191], v13 offset:48128
v_mfma_f32_32x32x16_bf16 v[64:79], a[164:167], a[100:103], v[64:79]
v_rcp_f32 v101, v101
v_mul_f32 v109, v9, v109
ds_read_b128 a[160:163], v13 offset:49152
v_mfma_f32_32x32x16_bf16 v[48:63], a[168:171], a[104:107], v[48:63]
s_add_u32 s68, s67, 9216
s_mov_b32 m0, s68
s_add_u32 s73, s72, 234496
buffer_load_dwordx4 v2, s[8:11], s73 offen sc1 lds
v_rcp_f32 v102, v102
v_mul_f32 v110, v9, v110
ds_read_b128 a[164:167], v13 offset:50176
v_mfma_f32_32x32x16_bf16 v[64:79], a[172:175], a[108:111], v[64:79]
v_rcp_f32 v103, v103
v_mul_f32 v111, v9, v111
ds_read_b128 a[168:171], v13 offset:51200
s_waitcnt lgkmcnt(3)
v_mfma_f32_32x32x16_bf16 v[48:63], a[176:179], a[112:115], v[48:63]
v_mul_f32 v108, v108, v100
v_mul_f32 v109, v109, v101
v_and_b32 v15, 15, v1
v_lshlrev_b32 v15, 2, v15
v_add_u32 v15, s64, v15
s_mov_b32 s79, 19912704
buffer_load_dword v12, v15, s[8:11], s79 offen sc1
ds_read_b128 a[172:175], v13 offset:52224
v_mfma_f32_32x32x16_bf16 v[64:79], a[180:183], a[116:119], v[64:79]
v_mul_f32 v110, v110, v102
v_mul_f32 v111, v111, v103
ds_read_b128 a[176:179], v13 offset:53248
v_mfma_f32_32x32x16_bf16 v[48:63], a[184:187], a[120:123], v[48:63]
v_cvt_pk_bf16_f32 v90, v108, v109
v_cvt_pk_bf16_f32 v91, v110, v111
ds_read_b128 a[180:183], v13 offset:54272
v_mfma_f32_32x32x16_bf16 v[64:79], a[188:191], a[124:127], v[64:79]
s_add_u32 s35, s31, 8192
buffer_store_dwordx4 v[88:91], v2, s[8:11], s35 offen sc1
ds_read_b128 a[184:187], v13 offset:55296
s_waitcnt lgkmcnt(3)
v_mfma_f32_32x32x16_bf16 v[48:63], a[160:163], a[128:131], v[48:63]
v_mul_f32 v96, v8, v32
v_mul_f32 v97, v8, v33
ds_read_b128 a[188:191], v13 offset:56320
v_mfma_f32_32x32x16_bf16 v[64:79], a[164:167], a[132:135], v[64:79]
v_mul_f32 v98, v8, v34
v_mul_f32 v99, v8, v35
v_mfma_f32_32x32x16_bf16 v[48:63], a[168:171], a[136:139], v[48:63]
v_exp_f32 v96, v96
v_mul_f32 v104, v32, v40
v_mfma_f32_32x32x16_bf16 v[64:79], a[172:175], a[140:143], v[64:79]
v_exp_f32 v97, v97
v_mul_f32 v105, v33, v41
s_waitcnt lgkmcnt(0)
v_mfma_f32_32x32x16_bf16 v[48:63], a[176:179], a[144:147], v[48:63]
v_exp_f32 v98, v98
v_mul_f32 v106, v34, v42
v_mfma_f32_32x32x16_bf16 v[64:79], a[180:183], a[148:151], v[64:79]
v_exp_f32 v99, v99
v_mul_f32 v107, v35, v43
v_mfma_f32_32x32x16_bf16 v[48:63], a[184:187], a[152:155], v[48:63]
v_add_f32 v96, 1.0, v96
v_add_f32 v97, 1.0, v97
v_mfma_f32_32x32x16_bf16 v[64:79], a[188:191], a[156:159], v[64:79]
v_add_f32 v98, 1.0, v98
v_add_f32 v99, 1.0, v99
v_rcp_f32 v96, v96
v_mul_f32 v104, v9, v104
v_rcp_f32 v97, v97
v_mul_f32 v105, v9, v105
v_rcp_f32 v98, v98
v_mul_f32 v106, v9, v106
v_rcp_f32 v99, v99
v_mul_f32 v107, v9, v107
v_mul_f32 v104, v104, v96
v_mul_f32 v105, v105, v97
v_mul_f32 v106, v106, v98
v_mul_f32 v107, v107, v99
v_cvt_pk_bf16_f32 v92, v104, v105
v_cvt_pk_bf16_f32 v93, v106, v107
v_mul_f32 v100, v8, v36
v_mul_f32 v101, v8, v37
v_mul_f32 v102, v8, v38
v_mul_f32 v103, v8, v39
v_exp_f32 v100, v100
v_mul_f32 v108, v36, v44
v_exp_f32 v101, v101
v_mul_f32 v109, v37, v45
v_exp_f32 v102, v102
v_mul_f32 v110, v38, v46
v_exp_f32 v103, v103
v_mul_f32 v111, v39, v47
v_add_f32 v100, 1.0, v100
v_add_f32 v101, 1.0, v101
v_add_f32 v102, 1.0, v102
v_add_f32 v103, 1.0, v103
v_rcp_f32 v100, v100
v_mul_f32 v108, v9, v108
v_rcp_f32 v101, v101
v_mul_f32 v109, v9, v109
v_rcp_f32 v102, v102
v_mul_f32 v110, v9, v110
v_rcp_f32 v103, v103
v_mul_f32 v111, v9, v111
v_mul_f32 v108, v108, v100
v_mul_f32 v109, v109, v101
v_mul_f32 v110, v110, v102
v_mul_f32 v111, v111, v103
v_cvt_pk_bf16_f32 v94, v108, v109
v_cvt_pk_bf16_f32 v95, v110, v111
s_add_u32 s35, s31, 10240
buffer_store_dwordx4 v[92:95], v2, s[8:11], s35 offen sc1
v_add_f32 v48, v48, v64
v_add_f32 v49, v49, v65
v_add_f32 v50, v50, v66
v_add_f32 v51, v51, v67
v_add_f32 v52, v52, v68
v_add_f32 v53, v53, v69
v_add_f32 v54, v54, v70
v_add_f32 v55, v55, v71
v_add_f32 v56, v56, v72
v_add_f32 v57, v57, v73
v_add_f32 v58, v58, v74
v_add_f32 v59, v59, v75
v_add_f32 v60, v60, v76
v_add_f32 v61, v61, v77
v_add_f32 v62, v62, v78
v_add_f32 v63, v63, v79
v_mul_f32 v96, v8, v48
v_mul_f32 v97, v8, v49
v_mul_f32 v98, v8, v50
v_mul_f32 v99, v8, v51
v_exp_f32 v96, v96
v_mul_f32 v104, v48, v56
v_exp_f32 v97, v97
v_mul_f32 v105, v49, v57
v_exp_f32 v98, v98
v_mul_f32 v106, v50, v58
v_exp_f32 v99, v99
v_mul_f32 v107, v51, v59
v_add_f32 v96, 1.0, v96
v_add_f32 v97, 1.0, v97
v_add_f32 v98, 1.0, v98
v_add_f32 v99, 1.0, v99
v_rcp_f32 v96, v96
v_mul_f32 v104, v9, v104
v_rcp_f32 v97, v97
v_mul_f32 v105, v9, v105
v_rcp_f32 v98, v98
v_mul_f32 v106, v9, v106
v_rcp_f32 v99, v99
v_mul_f32 v107, v9, v107
v_mul_f32 v104, v104, v96
v_mul_f32 v105, v105, v97
v_mul_f32 v106, v106, v98
v_mul_f32 v107, v107, v99
v_cvt_pk_bf16_f32 v88, v104, v105
v_cvt_pk_bf16_f32 v89, v106, v107
v_mul_f32 v100, v8, v52
v_mul_f32 v101, v8, v53
v_mul_f32 v102, v8, v54
v_mul_f32 v103, v8, v55
v_exp_f32 v100, v100
v_mul_f32 v108, v52, v60
v_exp_f32 v101, v101
v_mul_f32 v109, v53, v61
v_exp_f32 v102, v102
v_mul_f32 v110, v54, v62
v_exp_f32 v103, v103
v_mul_f32 v111, v55, v63
v_add_f32 v100, 1.0, v100
v_add_f32 v101, 1.0, v101
v_add_f32 v102, 1.0, v102
v_add_f32 v103, 1.0, v103
v_rcp_f32 v100, v100
v_mul_f32 v108, v9, v108
v_rcp_f32 v101, v101
v_mul_f32 v109, v9, v109
v_rcp_f32 v102, v102
v_mul_f32 v110, v9, v110
v_rcp_f32 v103, v103
v_mul_f32 v111, v9, v111
v_mul_f32 v108, v108, v100
v_mul_f32 v109, v109, v101
v_mul_f32 v110, v110, v102
v_mul_f32 v111, v111, v103
v_cvt_pk_bf16_f32 v90, v108, v109
v_cvt_pk_bf16_f32 v91, v110, v111
s_add_u32 s35, s32, 0
buffer_store_dwordx4 v[88:91], v2, s[8:11], s35 offen sc1
v_lshrrev_b32 v8, 5, v1
v_lshlrev_b32 v8, 11, v8
v_bfe_u32 v9, v1, 4, 1
v_lshl_add_u32 v8, v9, 9, v8
v_and_b32 v9, 15, v1
v_lshl_add_u32 v8, v9, 4, v8
s_add_u32 s22, s16, 1
s_and_b32 s23, s22, 1
s_lshl_b32 s23, s23, 8
s_and_b32 s22, s22, 2
s_lshl_b32 s22, s22, 9
s_add_u32 s22, s22, s23
v_add_u32 v4, s22, v8
s_add_u32 s22, s16, 2
s_and_b32 s23, s22, 1
s_lshl_b32 s23, s23, 8
s_and_b32 s22, s22, 2
s_lshl_b32 s22, s22, 9
s_add_u32 s22, s22, s23
v_add_u32 v5, s22, v8
s_add_u32 s22, s16, 3
s_and_b32 s23, s22, 1
s_lshl_b32 s23, s23, 8
s_and_b32 s22, s22, 2
s_lshl_b32 s22, s22, 9
s_add_u32 s22, s22, s23
v_add_u32 v6, s22, v8
s_add_u32 s22, s16, 0
s_and_b32 s23, s22, 1
s_lshl_b32 s23, s23, 8
s_and_b32 s22, s22, 2
s_lshl_b32 s22, s22, 9
s_add_u32 s22, s22, s23
v_add_u32 v7, s22, v8
s_waitcnt vmcnt(3)
v_cmp_ne_u32 vcc, 1, v12
s_nop 1
s_cbranch_vccz L_pa_sequential_preLN__linear_attn_block__swiglu_ffn__prompt_kernel_ok
s_mov_b32 s21, 0
L_pa_sequential_preLN__linear_attn_block__swiglu_ffn__prompt_kernel_lp:
s_sleep 2
buffer_load_dword v12, v15, s[8:11], s79 offen sc1
s_waitcnt vmcnt(0)
v_cmp_ne_u32 vcc, 1, v12
s_add_u32 s21, s21, 1
s_cmp_ge_u32 s21, 0x40000
s_cbranch_scc1 L_pa_sequential_preLN__linear_attn_block__swiglu_ffn__prompt_kernel_ok
s_nop 1
s_cbranch_vccnz L_pa_sequential_preLN__linear_attn_block__swiglu_ffn__prompt_kernel_lp
L_pa_sequential_preLN__linear_attn_block__swiglu_ffn__prompt_kernel_ok:
s_nop 1
s_add_u32 s75, s70, 0
buffer_load_dwordx4 a[0:3], v4, s[8:11], s75 offen sc1
buffer_load_dwordx4 a[4:7], v5, s[8:11], s75 offen sc1
buffer_load_dwordx4 a[8:11], v6, s[8:11], s75 offen sc1
buffer_load_dwordx4 a[12:15], v7, s[8:11], s75 offen sc1
s_add_u32 s75, s70, 4096
buffer_load_dwordx4 a[16:19], v4, s[8:11], s75 offen sc1
buffer_load_dwordx4 a[20:23], v5, s[8:11], s75 offen sc1
buffer_load_dwordx4 a[24:27], v6, s[8:11], s75 offen sc1
buffer_load_dwordx4 a[28:31], v7, s[8:11], s75 offen sc1
s_add_u32 s75, s70, 16384
buffer_load_dwordx4 a[32:35], v4, s[8:11], s75 offen sc1
buffer_load_dwordx4 a[36:39], v5, s[8:11], s75 offen sc1
buffer_load_dwordx4 a[40:43], v6, s[8:11], s75 offen sc1
buffer_load_dwordx4 a[44:47], v7, s[8:11], s75 offen sc1
s_waitcnt vmcnt(12)
s_barrier
s_cmp_eq_u32 s16, 0
s_cselect_b32 s20, 19914752, s56
v_mov_b32 v10, s63
v_mov_b32 v11, 1
s_mov_b64 exec, 1
buffer_store_dword v11, v10, s[8:11], s20 offen sc1
s_mov_b64 exec, -1
v_add_u32 v13, s67, v2
v_add_u32 v14, 0x1e000, v13
v_bfe_u32 v10, v1, 4, 1
v_lshlrev_b32 v10, 9, v10
v_lshl_add_u32 v10, v9, 4, v10
v_lshrrev_b32 v12, 5, v1
v_lshl_add_u32 v10, v12, 3, v10
v_lshlrev_b32 v11, 2, v9
s_lshl_b32 s26, s17, 1
s_lshr_b32 s27, s16, 1
s_add_u32 s26, s26, s27
s_mul_i32 s26, s26, 40
s_mul_i32 s27, s18, 5
s_add_u32 s26, s26, s27
s_lshl_b32 s26, s26, 10
s_and_b32 s27, s16, 1
s_lshl_b32 s27, s27, 8
s_add_u32 s27, s27, s26
s_add_u32 s27, s27, 2621440
s_add_u32 s26, s27, 4096
s_lshl_b32 s28, s17, 2
s_add_u32 s28, s28, s16
s_lshl_b32 s28, s28, 6
s_add_u32 s28, s28, 21069824
s_add_u32 s20, s16, 1
s_and_b32 s20, s20, 3
s_mul_i32 s20, s20, 15360
s_add_u32 s20, s20, 40960
v_add_u32 v96, s20, v2
s_add_u32 s20, s16, 2
s_and_b32 s20, s20, 3
s_mul_i32 s20, s20, 15360
s_add_u32 s20, s20, 46080
v_add_u32 v97, s20, v2
s_add_u32 s20, s16, 3
s_and_b32 s20, s20, 3
s_mul_i32 s20, s20, 15360
s_add_u32 s20, s20, 51200
v_add_u32 v98, s20, v2
s_mul_i32 s20, s16, 15360
s_add_u32 s20, s20, 40960
v_add_u32 v99, s20, v2
s_waitcnt vmcnt(12)
v_mfma_f32_16x16x32_bf16 v[36:39], v[212:215], a[0:3], 0
s_waitcnt vmcnt(11)
v_mfma_f32_16x16x32_bf16 v[56:59], v[212:215], a[4:7], 0
s_add_u32 s75, s70, 20480
s_waitcnt vmcnt(10)
v_mfma_f32_16x16x32_bf16 v[76:79], v[212:215], a[8:11], 0
buffer_load_dwordx4 a[48:51], v4, s[8:11], s75 offen sc1
s_waitcnt vmcnt(10)
v_mfma_f32_16x16x32_bf16 v[16:19], v[212:215], a[12:15], 0
buffer_load_dwordx4 a[52:55], v5, s[8:11], s75 offen sc1
v_mfma_f32_16x16x32_bf16 v[40:43], v[216:219], a[0:3], 0
v_mfma_f32_16x16x32_bf16 v[60:63], v[216:219], a[4:7], 0
buffer_load_dwordx4 a[56:59], v6, s[8:11], s75 offen sc1
v_mfma_f32_16x16x32_bf16 v[80:83], v[216:219], a[8:11], 0
buffer_load_dwordx4 a[60:63], v7, s[8:11], s75 offen sc1
v_mfma_f32_16x16x32_bf16 v[20:23], v[216:219], a[12:15], 0
ds_read_b128 a[64:67], v14 offset:0
v_mfma_f32_16x16x32_bf16 v[44:47], v[220:223], a[0:3], 0
v_mfma_f32_16x16x32_bf16 v[64:67], v[220:223], a[4:7], 0
s_nop 0
v_mfma_f32_16x16x32_bf16 v[84:87], v[220:223], a[8:11], 0
ds_read_b128 a[68:71], v14 offset:1024
v_mfma_f32_16x16x32_bf16 v[24:27], v[220:223], a[12:15], 0
s_nop 0
v_mfma_f32_16x16x32_bf16 v[48:51], v[224:227], a[0:3], 0
v_mfma_f32_16x16x32_bf16 v[68:71], v[224:227], a[4:7], 0
ds_read_b128 a[72:75], v14 offset:2048
v_mfma_f32_16x16x32_bf16 v[88:91], v[224:227], a[8:11], 0
s_nop 0
v_mfma_f32_16x16x32_bf16 v[28:31], v[224:227], a[12:15], 0
ds_read_b128 a[76:79], v14 offset:3072
v_mfma_f32_16x16x32_bf16 v[52:55], v[228:231], a[0:3], 0
v_mfma_f32_16x16x32_bf16 v[72:75], v[228:231], a[4:7], 0
s_nop 0
v_mfma_f32_16x16x32_bf16 v[92:95], v[228:231], a[8:11], 0
ds_read_b128 a[80:83], v14 offset:4096
v_mfma_f32_16x16x32_bf16 v[32:35], v[228:231], a[12:15], 0
s_nop 0
s_waitcnt vmcnt(12)
v_mfma_f32_16x16x32_bf16 v[36:39], v[232:235], a[16:19], v[36:39]
s_waitcnt vmcnt(11)
v_mfma_f32_16x16x32_bf16 v[56:59], v[232:235], a[20:23], v[56:59]
s_add_u32 s75, s70, 28672
s_waitcnt vmcnt(10)
v_mfma_f32_16x16x32_bf16 v[76:79], v[232:235], a[24:27], v[76:79]
buffer_load_dwordx4 a[0:3], v4, s[8:11], s75 offen sc1
s_waitcnt vmcnt(10)
v_mfma_f32_16x16x32_bf16 v[16:19], v[232:235], a[28:31], v[16:19]
buffer_load_dwordx4 a[4:7], v5, s[8:11], s75 offen sc1
v_mfma_f32_16x16x32_bf16 v[40:43], v[236:239], a[16:19], v[40:43]
v_mfma_f32_16x16x32_bf16 v[60:63], v[236:239], a[20:23], v[60:63]
buffer_load_dwordx4 a[8:11], v6, s[8:11], s75 offen sc1
v_mfma_f32_16x16x32_bf16 v[80:83], v[236:239], a[24:27], v[80:83]
buffer_load_dwordx4 a[12:15], v7, s[8:11], s75 offen sc1
v_mfma_f32_16x16x32_bf16 v[20:23], v[236:239], a[28:31], v[20:23]
ds_read_b128 a[84:87], v14 offset:5120
v_mfma_f32_16x16x32_bf16 v[44:47], v[240:243], a[16:19], v[44:47]
v_mfma_f32_16x16x32_bf16 v[64:67], v[240:243], a[20:23], v[64:67]
s_nop 0
v_mfma_f32_16x16x32_bf16 v[84:87], v[240:243], a[24:27], v[84:87]
ds_read_b128 a[88:91], v14 offset:6144
v_mfma_f32_16x16x32_bf16 v[24:27], v[240:243], a[28:31], v[24:27]
s_nop 0
v_mfma_f32_16x16x32_bf16 v[48:51], v[244:247], a[16:19], v[48:51]
v_mfma_f32_16x16x32_bf16 v[68:71], v[244:247], a[20:23], v[68:71]
ds_read_b128 a[92:95], v14 offset:7168
v_mfma_f32_16x16x32_bf16 v[88:91], v[244:247], a[24:27], v[88:91]
s_nop 0
v_mfma_f32_16x16x32_bf16 v[28:31], v[244:247], a[28:31], v[28:31]
ds_read_b128 a[96:99], v14 offset:8192
v_mfma_f32_16x16x32_bf16 v[52:55], v[248:251], a[16:19], v[52:55]
v_mfma_f32_16x16x32_bf16 v[72:75], v[248:251], a[20:23], v[72:75]
s_nop 0
v_mfma_f32_16x16x32_bf16 v[92:95], v[248:251], a[24:27], v[92:95]
ds_read_b128 a[100:103], v14 offset:9216
v_mfma_f32_16x16x32_bf16 v[32:35], v[248:251], a[28:31], v[32:35]
s_nop 0
s_waitcnt vmcnt(12)
v_mfma_f32_16x16x32_bf16 v[36:39], v[252:255], a[32:35], v[36:39]
s_add_u32 s75, s70, 32768
s_waitcnt vmcnt(11)
v_mfma_f32_16x16x32_bf16 v[56:59], v[252:255], a[36:39], v[56:59]
buffer_load_dwordx4 a[16:19], v4, s[8:11], s75 offen sc1
s_waitcnt vmcnt(11)
v_mfma_f32_16x16x32_bf16 v[76:79], v[252:255], a[40:43], v[76:79]
buffer_load_dwordx4 a[20:23], v5, s[8:11], s75 offen sc1
s_waitcnt vmcnt(11)
v_mfma_f32_16x16x32_bf16 v[16:19], v[252:255], a[44:47], v[16:19]
buffer_load_dwordx4 a[24:27], v6, s[8:11], s75 offen sc1
v_mfma_f32_16x16x32_bf16 v[40:43], a[216:219], a[32:35], v[40:43]
buffer_load_dwordx4 a[28:31], v7, s[8:11], s75 offen sc1
v_mfma_f32_16x16x32_bf16 v[60:63], a[216:219], a[36:39], v[60:63]
buffer_load_dwordx2 v[100:101], v10, s[8:11], s27 offen offset:0 sc1
v_mfma_f32_16x16x32_bf16 v[80:83], a[216:219], a[40:43], v[80:83]
buffer_load_dwordx2 v[102:103], v10, s[8:11], s27 offen offset:1024 sc1
v_mfma_f32_16x16x32_bf16 v[20:23], a[216:219], a[44:47], v[20:23]
buffer_load_dwordx2 v[104:105], v10, s[8:11], s27 offen offset:2048 sc1
v_mfma_f32_16x16x32_bf16 v[44:47], a[220:223], a[32:35], v[44:47]
buffer_load_dwordx2 v[106:107], v10, s[8:11], s27 offen offset:3072 sc1
v_mfma_f32_16x16x32_bf16 v[64:67], a[220:223], a[36:39], v[64:67]
buffer_load_dwordx2 v[108:109], v10, s[8:11], s26 offen sc1
v_mfma_f32_16x16x32_bf16 v[84:87], a[220:223], a[40:43], v[84:87]
buffer_load_dword v110, v11, s[8:11], s28 offen sc1
v_mfma_f32_16x16x32_bf16 v[24:27], a[220:223], a[44:47], v[24:27]
ds_read_b128 a[104:107], v13 offset:0
v_mfma_f32_16x16x32_bf16 v[48:51], a[224:227], a[32:35], v[48:51]
s_nop 0
v_mfma_f32_16x16x32_bf16 v[68:71], a[224:227], a[36:39], v[68:71]
ds_read_b128 a[108:111], v13 offset:1024
v_mfma_f32_16x16x32_bf16 v[88:91], a[224:227], a[40:43], v[88:91]
s_nop 0
v_mfma_f32_16x16x32_bf16 v[28:31], a[224:227], a[44:47], v[28:31]
ds_read_b128 a[112:115], v13 offset:2048
v_mfma_f32_16x16x32_bf16 v[52:55], a[228:231], a[32:35], v[52:55]
s_nop 0
v_mfma_f32_16x16x32_bf16 v[72:75], a[228:231], a[36:39], v[72:75]
ds_read_b128 a[116:119], v13 offset:3072
v_mfma_f32_16x16x32_bf16 v[92:95], a[228:231], a[40:43], v[92:95]
s_nop 0
v_mfma_f32_16x16x32_bf16 v[32:35], a[228:231], a[44:47], v[32:35]
ds_read_b128 a[120:123], v13 offset:4096
s_nop 0
s_waitcnt vmcnt(17)
v_mfma_f32_16x16x32_bf16 v[36:39], a[232:235], a[48:51], v[36:39]
s_waitcnt vmcnt(16)
v_mfma_f32_16x16x32_bf16 v[56:59], a[232:235], a[52:55], v[56:59]
s_add_u32 s75, s70, 45056
s_waitcnt vmcnt(15)
v_mfma_f32_16x16x32_bf16 v[76:79], a[232:235], a[56:59], v[76:79]
buffer_load_dwordx4 a[32:35], v4, s[8:11], s75 offen sc1
s_waitcnt vmcnt(15)
v_mfma_f32_16x16x32_bf16 v[16:19], a[232:235], a[60:63], v[16:19]
buffer_load_dwordx4 a[36:39], v5, s[8:11], s75 offen sc1
v_mfma_f32_16x16x32_bf16 v[40:43], a[236:239], a[48:51], v[40:43]
buffer_load_dwordx4 a[40:43], v6, s[8:11], s75 offen sc1
v_mfma_f32_16x16x32_bf16 v[60:63], a[236:239], a[52:55], v[60:63]
v_mfma_f32_16x16x32_bf16 v[80:83], a[236:239], a[56:59], v[80:83]
buffer_load_dwordx4 a[44:47], v7, s[8:11], s75 offen sc1
v_mfma_f32_16x16x32_bf16 v[20:23], a[236:239], a[60:63], v[20:23]
s_waitcnt lgkmcnt(14)
ds_read_b128 a[124:127], v13 offset:5120
v_mfma_f32_16x16x32_bf16 v[44:47], a[240:243], a[48:51], v[44:47]
s_nop 0
v_mfma_f32_16x16x32_bf16 v[64:67], a[240:243], a[52:55], v[64:67]
s_waitcnt lgkmcnt(14)
ds_read_b128 a[128:131], v13 offset:6144
v_mfma_f32_16x16x32_bf16 v[84:87], a[240:243], a[56:59], v[84:87]
v_mfma_f32_16x16x32_bf16 v[24:27], a[240:243], a[60:63], v[24:27]
s_nop 0
v_mfma_f32_16x16x32_bf16 v[48:51], a[244:247], a[48:51], v[48:51]
s_waitcnt lgkmcnt(14)
ds_read_b128 a[132:135], v13 offset:7168
v_mfma_f32_16x16x32_bf16 v[68:71], a[244:247], a[52:55], v[68:71]
s_nop 0
v_mfma_f32_16x16x32_bf16 v[88:91], a[244:247], a[56:59], v[88:91]
s_waitcnt lgkmcnt(14)
ds_read_b128 a[136:139], v13 offset:8192
v_mfma_f32_16x16x32_bf16 v[28:31], a[244:247], a[60:63], v[28:31]
v_mfma_f32_16x16x32_bf16 v[52:55], a[248:251], a[48:51], v[52:55]
s_nop 0
v_mfma_f32_16x16x32_bf16 v[72:75], a[248:251], a[52:55], v[72:75]
s_waitcnt lgkmcnt(14)
ds_read_b128 a[140:143], v13 offset:9216
v_mfma_f32_16x16x32_bf16 v[92:95], a[248:251], a[56:59], v[92:95]
s_nop 0
v_mfma_f32_16x16x32_bf16 v[32:35], a[248:251], a[60:63], v[32:35]
v_and_b32 v15, 15, v1
v_lshlrev_b32 v15, 2, v15
v_add_u32 v15, s64, v15
s_mov_b32 s79, 19914752
buffer_load_dword v12, v15, s[8:11], s79 offen sc1
s_waitcnt vmcnt(18)
v_mfma_f32_16x16x32_bf16 v[36:39], a[252:255], a[0:3], v[36:39]
s_waitcnt vmcnt(17)
v_mfma_f32_16x16x32_bf16 v[56:59], a[252:255], a[4:7], v[56:59]
s_waitcnt vmcnt(16)
v_mfma_f32_16x16x32_bf16 v[76:79], a[252:255], a[8:11], v[76:79]
s_waitcnt vmcnt(15)
v_mfma_f32_16x16x32_bf16 v[16:19], a[252:255], a[12:15], v[16:19]
s_add_u32 s75, s74, 49152
v_mfma_f32_16x16x32_bf16 v[40:43], v[120:123], a[0:3], v[40:43]
v_mfma_f32_16x16x32_bf16 v[60:63], v[120:123], a[4:7], v[60:63]
v_mfma_f32_16x16x32_bf16 v[80:83], v[120:123], a[8:11], v[80:83]
v_mfma_f32_16x16x32_bf16 v[20:23], v[120:123], a[12:15], v[20:23]
buffer_load_dwordx4 a[48:51], v4, s[8:11], s75 offen sc1
v_mfma_f32_16x16x32_bf16 v[44:47], v[124:127], a[0:3], v[44:47]
v_mfma_f32_16x16x32_bf16 v[64:67], v[124:127], a[4:7], v[64:67]
v_mfma_f32_16x16x32_bf16 v[84:87], v[124:127], a[8:11], v[84:87]
v_mfma_f32_16x16x32_bf16 v[24:27], v[124:127], a[12:15], v[24:27]
buffer_load_dwordx4 a[52:55], v5, s[8:11], s75 offen sc1
v_mfma_f32_16x16x32_bf16 v[48:51], v[128:131], a[0:3], v[48:51]
v_mfma_f32_16x16x32_bf16 v[68:71], v[128:131], a[4:7], v[68:71]
v_mfma_f32_16x16x32_bf16 v[88:91], v[128:131], a[8:11], v[88:91]
v_mfma_f32_16x16x32_bf16 v[28:31], v[128:131], a[12:15], v[28:31]
buffer_load_dwordx4 a[56:59], v6, s[8:11], s75 offen sc1
v_mfma_f32_16x16x32_bf16 v[52:55], v[132:135], a[0:3], v[52:55]
v_mfma_f32_16x16x32_bf16 v[72:75], v[132:135], a[4:7], v[72:75]
v_mfma_f32_16x16x32_bf16 v[92:95], v[132:135], a[8:11], v[92:95]
v_mfma_f32_16x16x32_bf16 v[32:35], v[132:135], a[12:15], v[32:35]
buffer_load_dwordx4 a[60:63], v7, s[8:11], s75 offen sc1
s_waitcnt vmcnt(4)
v_cmp_ne_u32 vcc, 1, v12
s_nop 1
s_cbranch_vccz L_pb_sequential_preLN__linear_attn_block__swiglu_ffn__prompt_kernel_ok
s_mov_b32 s21, 0
L_pb_sequential_preLN__linear_attn_block__swiglu_ffn__prompt_kernel_lp:
s_sleep 2
buffer_load_dword v12, v15, s[8:11], s79 offen sc1
s_waitcnt vmcnt(0)
v_cmp_ne_u32 vcc, 1, v12
s_add_u32 s21, s21, 1
s_cmp_ge_u32 s21, 0x40000
s_cbranch_scc1 L_pb_sequential_preLN__linear_attn_block__swiglu_ffn__prompt_kernel_ok
s_nop 1
s_cbranch_vccnz L_pb_sequential_preLN__linear_attn_block__swiglu_ffn__prompt_kernel_lp
L_pb_sequential_preLN__linear_attn_block__swiglu_ffn__prompt_kernel_ok:
s_nop 1
v_mfma_f32_16x16x32_bf16 v[36:39], v[136:139], a[16:19], v[36:39]
v_mfma_f32_16x16x32_bf16 v[56:59], v[136:139], a[20:23], v[56:59]
v_mfma_f32_16x16x32_bf16 v[76:79], v[136:139], a[24:27], v[76:79]
v_mfma_f32_16x16x32_bf16 v[16:19], v[136:139], a[28:31], v[16:19]
s_add_u32 s75, s70, 8192
v_mfma_f32_16x16x32_bf16 v[40:43], v[140:143], a[16:19], v[40:43]
v_mfma_f32_16x16x32_bf16 v[60:63], v[140:143], a[20:23], v[60:63]
v_mfma_f32_16x16x32_bf16 v[80:83], v[140:143], a[24:27], v[80:83]
v_mfma_f32_16x16x32_bf16 v[20:23], v[140:143], a[28:31], v[20:23]
buffer_load_dwordx4 a[0:3], v4, s[8:11], s75 offen sc1
v_mfma_f32_16x16x32_bf16 v[44:47], v[144:147], a[16:19], v[44:47]
v_mfma_f32_16x16x32_bf16 v[64:67], v[144:147], a[20:23], v[64:67]
v_mfma_f32_16x16x32_bf16 v[84:87], v[144:147], a[24:27], v[84:87]
v_mfma_f32_16x16x32_bf16 v[24:27], v[144:147], a[28:31], v[24:27]
buffer_load_dwordx4 a[4:7], v5, s[8:11], s75 offen sc1
v_mfma_f32_16x16x32_bf16 v[48:51], v[148:151], a[16:19], v[48:51]
v_mfma_f32_16x16x32_bf16 v[68:71], v[148:151], a[20:23], v[68:71]
v_mfma_f32_16x16x32_bf16 v[88:91], v[148:151], a[24:27], v[88:91]
v_mfma_f32_16x16x32_bf16 v[28:31], v[148:151], a[28:31], v[28:31]
buffer_load_dwordx4 a[8:11], v6, s[8:11], s75 offen sc1
v_mfma_f32_16x16x32_bf16 v[52:55], v[152:155], a[16:19], v[52:55]
v_mfma_f32_16x16x32_bf16 v[72:75], v[152:155], a[20:23], v[72:75]
v_mfma_f32_16x16x32_bf16 v[92:95], v[152:155], a[24:27], v[92:95]
v_mfma_f32_16x16x32_bf16 v[32:35], v[152:155], a[28:31], v[32:35]
buffer_load_dwordx4 a[12:15], v7, s[8:11], s75 offen sc1
v_mfma_f32_16x16x32_bf16 v[36:39], v[156:159], a[32:35], v[36:39]
v_mfma_f32_16x16x32_bf16 v[56:59], v[156:159], a[36:39], v[56:59]
v_mfma_f32_16x16x32_bf16 v[76:79], v[156:159], a[40:43], v[76:79]
v_mfma_f32_16x16x32_bf16 v[16:19], v[156:159], a[44:47], v[16:19]
s_add_u32 s75, s70, 12288
v_mfma_f32_16x16x32_bf16 v[40:43], v[160:163], a[32:35], v[40:43]
v_mfma_f32_16x16x32_bf16 v[60:63], v[160:163], a[36:39], v[60:63]
v_mfma_f32_16x16x32_bf16 v[80:83], v[160:163], a[40:43], v[80:83]
v_mfma_f32_16x16x32_bf16 v[20:23], v[160:163], a[44:47], v[20:23]
buffer_load_dwordx4 a[16:19], v4, s[8:11], s75 offen sc1
v_mfma_f32_16x16x32_bf16 v[44:47], v[164:167], a[32:35], v[44:47]
v_mfma_f32_16x16x32_bf16 v[64:67], v[164:167], a[36:39], v[64:67]
v_mfma_f32_16x16x32_bf16 v[84:87], v[164:167], a[40:43], v[84:87]
v_mfma_f32_16x16x32_bf16 v[24:27], v[164:167], a[44:47], v[24:27]
buffer_load_dwordx4 a[20:23], v5, s[8:11], s75 offen sc1
v_mfma_f32_16x16x32_bf16 v[48:51], v[168:171], a[32:35], v[48:51]
v_mfma_f32_16x16x32_bf16 v[68:71], v[168:171], a[36:39], v[68:71]
v_mfma_f32_16x16x32_bf16 v[88:91], v[168:171], a[40:43], v[88:91]
v_mfma_f32_16x16x32_bf16 v[28:31], v[168:171], a[44:47], v[28:31]
buffer_load_dwordx4 a[24:27], v6, s[8:11], s75 offen sc1
v_mfma_f32_16x16x32_bf16 v[52:55], v[172:175], a[32:35], v[52:55]
v_mfma_f32_16x16x32_bf16 v[72:75], v[172:175], a[36:39], v[72:75]
v_mfma_f32_16x16x32_bf16 v[92:95], v[172:175], a[40:43], v[92:95]
v_mfma_f32_16x16x32_bf16 v[32:35], v[172:175], a[44:47], v[32:35]
buffer_load_dwordx4 a[28:31], v7, s[8:11], s75 offen sc1
s_waitcnt vmcnt(11)
v_mfma_f32_16x16x32_bf16 v[36:39], v[176:179], a[48:51], v[36:39]
s_waitcnt vmcnt(10)
v_mfma_f32_16x16x32_bf16 v[56:59], v[176:179], a[52:55], v[56:59]
s_waitcnt vmcnt(9)
v_mfma_f32_16x16x32_bf16 v[76:79], v[176:179], a[56:59], v[76:79]
s_waitcnt vmcnt(8)
v_mfma_f32_16x16x32_bf16 v[16:19], v[176:179], a[60:63], v[16:19]
s_add_u32 s75, s70, 24576
v_mfma_f32_16x16x32_bf16 v[40:43], v[180:183], a[48:51], v[40:43]
v_mfma_f32_16x16x32_bf16 v[60:63], v[180:183], a[52:55], v[60:63]
v_mfma_f32_16x16x32_bf16 v[80:83], v[180:183], a[56:59], v[80:83]
v_mfma_f32_16x16x32_bf16 v[20:23], v[180:183], a[60:63], v[20:23]
buffer_load_dwordx4 a[32:35], v4, s[8:11], s75 offen sc1
v_mfma_f32_16x16x32_bf16 v[44:47], v[184:187], a[48:51], v[44:47]
v_mfma_f32_16x16x32_bf16 v[64:67], v[184:187], a[52:55], v[64:67]
v_mfma_f32_16x16x32_bf16 v[84:87], v[184:187], a[56:59], v[84:87]
v_mfma_f32_16x16x32_bf16 v[24:27], v[184:187], a[60:63], v[24:27]
buffer_load_dwordx4 a[36:39], v5, s[8:11], s75 offen sc1
v_mfma_f32_16x16x32_bf16 v[48:51], v[188:191], a[48:51], v[48:51]
v_mfma_f32_16x16x32_bf16 v[68:71], v[188:191], a[52:55], v[68:71]
v_mfma_f32_16x16x32_bf16 v[88:91], v[188:191], a[56:59], v[88:91]
v_mfma_f32_16x16x32_bf16 v[28:31], v[188:191], a[60:63], v[28:31]
buffer_load_dwordx4 a[40:43], v6, s[8:11], s75 offen sc1
v_mfma_f32_16x16x32_bf16 v[52:55], v[192:195], a[48:51], v[52:55]
v_mfma_f32_16x16x32_bf16 v[72:75], v[192:195], a[52:55], v[72:75]
v_mfma_f32_16x16x32_bf16 v[92:95], v[192:195], a[56:59], v[92:95]
v_mfma_f32_16x16x32_bf16 v[32:35], v[192:195], a[60:63], v[32:35]
buffer_load_dwordx4 a[44:47], v7, s[8:11], s75 offen sc1
s_waitcnt vmcnt(11)
v_mfma_f32_16x16x32_bf16 v[36:39], v[196:199], a[0:3], v[36:39]
s_waitcnt vmcnt(10)
v_mfma_f32_16x16x32_bf16 v[56:59], v[196:199], a[4:7], v[56:59]
s_waitcnt vmcnt(9)
v_mfma_f32_16x16x32_bf16 v[76:79], v[196:199], a[8:11], v[76:79]
s_waitcnt vmcnt(8)
v_mfma_f32_16x16x32_bf16 v[16:19], v[196:199], a[12:15], v[16:19]
s_add_u32 s75, s70, 36864
v_mfma_f32_16x16x32_bf16 v[40:43], v[200:203], a[0:3], v[40:43]
v_mfma_f32_16x16x32_bf16 v[60:63], v[200:203], a[4:7], v[60:63]
v_mfma_f32_16x16x32_bf16 v[80:83], v[200:203], a[8:11], v[80:83]
v_mfma_f32_16x16x32_bf16 v[20:23], v[200:203], a[12:15], v[20:23]
buffer_load_dwordx4 a[48:51], v4, s[8:11], s75 offen sc1
v_mfma_f32_16x16x32_bf16 v[44:47], v[204:207], a[0:3], v[44:47]
v_mfma_f32_16x16x32_bf16 v[64:67], v[204:207], a[4:7], v[64:67]
v_mfma_f32_16x16x32_bf16 v[84:87], v[204:207], a[8:11], v[84:87]
v_mfma_f32_16x16x32_bf16 v[24:27], v[204:207], a[12:15], v[24:27]
buffer_load_dwordx4 a[52:55], v5, s[8:11], s75 offen sc1
v_mfma_f32_16x16x32_bf16 v[48:51], v[208:211], a[0:3], v[48:51]
v_mfma_f32_16x16x32_bf16 v[68:71], v[208:211], a[4:7], v[68:71]
v_mfma_f32_16x16x32_bf16 v[88:91], v[208:211], a[8:11], v[88:91]
v_mfma_f32_16x16x32_bf16 v[28:31], v[208:211], a[12:15], v[28:31]
buffer_load_dwordx4 a[56:59], v6, s[8:11], s75 offen sc1
v_mfma_f32_16x16x32_bf16 v[52:55], a[192:195], a[0:3], v[52:55]
v_mfma_f32_16x16x32_bf16 v[72:75], a[192:195], a[4:7], v[72:75]
v_mfma_f32_16x16x32_bf16 v[92:95], a[192:195], a[8:11], v[92:95]
v_mfma_f32_16x16x32_bf16 v[32:35], a[192:195], a[12:15], v[32:35]
buffer_load_dwordx4 a[60:63], v7, s[8:11], s75 offen sc1
s_waitcnt vmcnt(11)
v_mfma_f32_16x16x32_bf16 v[36:39], a[196:199], a[16:19], v[36:39]
s_waitcnt vmcnt(10)
v_mfma_f32_16x16x32_bf16 v[56:59], a[196:199], a[20:23], v[56:59]
s_waitcnt vmcnt(9)
v_mfma_f32_16x16x32_bf16 v[76:79], a[196:199], a[24:27], v[76:79]
s_waitcnt vmcnt(8)
v_mfma_f32_16x16x32_bf16 v[16:19], a[196:199], a[28:31], v[16:19]
s_add_u32 s75, s70, 40960
v_mfma_f32_16x16x32_bf16 v[40:43], a[200:203], a[16:19], v[40:43]
v_mfma_f32_16x16x32_bf16 v[60:63], a[200:203], a[20:23], v[60:63]
v_mfma_f32_16x16x32_bf16 v[80:83], a[200:203], a[24:27], v[80:83]
v_mfma_f32_16x16x32_bf16 v[20:23], a[200:203], a[28:31], v[20:23]
buffer_load_dwordx4 a[0:3], v4, s[8:11], s75 offen sc1
v_mfma_f32_16x16x32_bf16 v[44:47], a[204:207], a[16:19], v[44:47]
v_mfma_f32_16x16x32_bf16 v[64:67], a[204:207], a[20:23], v[64:67]
v_mfma_f32_16x16x32_bf16 v[84:87], a[204:207], a[24:27], v[84:87]
v_mfma_f32_16x16x32_bf16 v[24:27], a[204:207], a[28:31], v[24:27]
buffer_load_dwordx4 a[4:7], v5, s[8:11], s75 offen sc1
v_mfma_f32_16x16x32_bf16 v[48:51], a[208:211], a[16:19], v[48:51]
v_mfma_f32_16x16x32_bf16 v[68:71], a[208:211], a[20:23], v[68:71]
v_mfma_f32_16x16x32_bf16 v[88:91], a[208:211], a[24:27], v[88:91]
v_mfma_f32_16x16x32_bf16 v[28:31], a[208:211], a[28:31], v[28:31]
buffer_load_dwordx4 a[8:11], v6, s[8:11], s75 offen sc1
v_mfma_f32_16x16x32_bf16 v[52:55], a[212:215], a[16:19], v[52:55]
v_mfma_f32_16x16x32_bf16 v[72:75], a[212:215], a[20:23], v[72:75]
v_mfma_f32_16x16x32_bf16 v[92:95], a[212:215], a[24:27], v[92:95]
v_mfma_f32_16x16x32_bf16 v[32:35], a[212:215], a[28:31], v[32:35]
buffer_load_dwordx4 a[12:15], v7, s[8:11], s75 offen sc1
s_waitcnt vmcnt(11)
v_mfma_f32_16x16x32_bf16 v[36:39], a[64:67], a[32:35], v[36:39]
s_waitcnt vmcnt(10)
v_mfma_f32_16x16x32_bf16 v[56:59], a[64:67], a[36:39], v[56:59]
s_waitcnt vmcnt(9)
v_mfma_f32_16x16x32_bf16 v[76:79], a[64:67], a[40:43], v[76:79]
s_waitcnt vmcnt(8)
v_mfma_f32_16x16x32_bf16 v[16:19], a[64:67], a[44:47], v[16:19]
s_add_u32 s75, s74, 53248
v_mfma_f32_16x16x32_bf16 v[40:43], a[68:71], a[32:35], v[40:43]
v_mfma_f32_16x16x32_bf16 v[60:63], a[68:71], a[36:39], v[60:63]
v_mfma_f32_16x16x32_bf16 v[80:83], a[68:71], a[40:43], v[80:83]
v_mfma_f32_16x16x32_bf16 v[20:23], a[68:71], a[44:47], v[20:23]
buffer_load_dwordx4 a[16:19], v4, s[8:11], s75 offen sc1
v_mfma_f32_16x16x32_bf16 v[44:47], a[72:75], a[32:35], v[44:47]
v_mfma_f32_16x16x32_bf16 v[64:67], a[72:75], a[36:39], v[64:67]
v_mfma_f32_16x16x32_bf16 v[84:87], a[72:75], a[40:43], v[84:87]
v_mfma_f32_16x16x32_bf16 v[24:27], a[72:75], a[44:47], v[24:27]
buffer_load_dwordx4 a[20:23], v5, s[8:11], s75 offen sc1
v_mfma_f32_16x16x32_bf16 v[48:51], a[76:79], a[32:35], v[48:51]
v_mfma_f32_16x16x32_bf16 v[68:71], a[76:79], a[36:39], v[68:71]
v_mfma_f32_16x16x32_bf16 v[88:91], a[76:79], a[40:43], v[88:91]
v_mfma_f32_16x16x32_bf16 v[28:31], a[76:79], a[44:47], v[28:31]
buffer_load_dwordx4 a[24:27], v6, s[8:11], s75 offen sc1
v_mfma_f32_16x16x32_bf16 v[52:55], a[80:83], a[32:35], v[52:55]
v_mfma_f32_16x16x32_bf16 v[72:75], a[80:83], a[36:39], v[72:75]
v_mfma_f32_16x16x32_bf16 v[92:95], a[80:83], a[40:43], v[92:95]
v_mfma_f32_16x16x32_bf16 v[32:35], a[80:83], a[44:47], v[32:35]
buffer_load_dwordx4 a[28:31], v7, s[8:11], s75 offen sc1
s_waitcnt vmcnt(11) lgkmcnt(14)
v_mfma_f32_16x16x32_bf16 v[36:39], a[84:87], a[48:51], v[36:39]
s_waitcnt lgkmcnt(13)
v_mfma_f32_16x16x32_bf16 v[40:43], a[88:91], a[48:51], v[40:43]
s_waitcnt lgkmcnt(12)
v_mfma_f32_16x16x32_bf16 v[44:47], a[92:95], a[48:51], v[44:47]
s_waitcnt lgkmcnt(11)
v_mfma_f32_16x16x32_bf16 v[48:51], a[96:99], a[48:51], v[48:51]
s_waitcnt lgkmcnt(10)
v_mfma_f32_16x16x32_bf16 v[52:55], a[100:103], a[48:51], v[52:55]
s_waitcnt vmcnt(7) lgkmcnt(9)
v_mfma_f32_16x16x32_bf16 v[36:39], a[104:107], a[0:3], v[36:39]
s_waitcnt lgkmcnt(8)
v_mfma_f32_16x16x32_bf16 v[40:43], a[108:111], a[0:3], v[40:43]
s_waitcnt lgkmcnt(7)
v_mfma_f32_16x16x32_bf16 v[44:47], a[112:115], a[0:3], v[44:47]
s_waitcnt lgkmcnt(6)
v_mfma_f32_16x16x32_bf16 v[48:51], a[116:119], a[0:3], v[48:51]
s_waitcnt lgkmcnt(5)
v_mfma_f32_16x16x32_bf16 v[52:55], a[120:123], a[0:3], v[52:55]
s_waitcnt vmcnt(3) lgkmcnt(4)
v_mfma_f32_16x16x32_bf16 v[36:39], a[124:127], a[16:19], v[36:39]
s_waitcnt lgkmcnt(3)
v_mfma_f32_16x16x32_bf16 v[40:43], a[128:131], a[16:19], v[40:43]
s_waitcnt lgkmcnt(2)
v_mfma_f32_16x16x32_bf16 v[44:47], a[132:135], a[16:19], v[44:47]
s_waitcnt lgkmcnt(1)
v_mfma_f32_16x16x32_bf16 v[48:51], a[136:139], a[16:19], v[48:51]
s_waitcnt lgkmcnt(0)
v_mfma_f32_16x16x32_bf16 v[52:55], a[140:143], a[16:19], v[52:55]
v_mfma_f32_16x16x32_bf16 v[56:59], a[84:87], a[52:55], v[56:59]
v_mfma_f32_16x16x32_bf16 v[60:63], a[88:91], a[52:55], v[60:63]
v_mfma_f32_16x16x32_bf16 v[64:67], a[92:95], a[52:55], v[64:67]
v_mfma_f32_16x16x32_bf16 v[68:71], a[96:99], a[52:55], v[68:71]
v_mfma_f32_16x16x32_bf16 v[72:75], a[100:103], a[52:55], v[72:75]
v_mfma_f32_16x16x32_bf16 v[56:59], a[104:107], a[4:7], v[56:59]
v_mfma_f32_16x16x32_bf16 v[60:63], a[108:111], a[4:7], v[60:63]
ds_write_b128 v96, v[36:39] offset:0
v_mfma_f32_16x16x32_bf16 v[64:67], a[112:115], a[4:7], v[64:67]
v_mfma_f32_16x16x32_bf16 v[68:71], a[116:119], a[4:7], v[68:71]
ds_write_b128 v96, v[40:43] offset:1024
v_mfma_f32_16x16x32_bf16 v[72:75], a[120:123], a[4:7], v[72:75]
s_waitcnt vmcnt(2)
v_mfma_f32_16x16x32_bf16 v[56:59], a[124:127], a[20:23], v[56:59]
ds_write_b128 v96, v[44:47] offset:2048
v_mfma_f32_16x16x32_bf16 v[60:63], a[128:131], a[20:23], v[60:63]
v_mfma_f32_16x16x32_bf16 v[64:67], a[132:135], a[20:23], v[64:67]
ds_write_b128 v96, v[48:51] offset:3072
v_mfma_f32_16x16x32_bf16 v[68:71], a[136:139], a[20:23], v[68:71]
v_mfma_f32_16x16x32_bf16 v[72:75], a[140:143], a[20:23], v[72:75]
ds_write_b128 v96, v[52:55] offset:4096
v_mfma_f32_16x16x32_bf16 v[76:79], a[84:87], a[56:59], v[76:79]
v_mfma_f32_16x16x32_bf16 v[80:83], a[88:91], a[56:59], v[80:83]
v_mfma_f32_16x16x32_bf16 v[84:87], a[92:95], a[56:59], v[84:87]
v_mfma_f32_16x16x32_bf16 v[88:91], a[96:99], a[56:59], v[88:91]
v_mfma_f32_16x16x32_bf16 v[92:95], a[100:103], a[56:59], v[92:95]
v_mfma_f32_16x16x32_bf16 v[76:79], a[104:107], a[8:11], v[76:79]
v_mfma_f32_16x16x32_bf16 v[80:83], a[108:111], a[8:11], v[80:83]
ds_write_b128 v97, v[56:59] offset:0
v_mfma_f32_16x16x32_bf16 v[84:87], a[112:115], a[8:11], v[84:87]
v_mfma_f32_16x16x32_bf16 v[88:91], a[116:119], a[8:11], v[88:91]
ds_write_b128 v97, v[60:63] offset:1024
v_mfma_f32_16x16x32_bf16 v[92:95], a[120:123], a[8:11], v[92:95]
s_waitcnt vmcnt(1)
v_mfma_f32_16x16x32_bf16 v[76:79], a[124:127], a[24:27], v[76:79]
ds_write_b128 v97, v[64:67] offset:2048
v_mfma_f32_16x16x32_bf16 v[80:83], a[128:131], a[24:27], v[80:83]
v_mfma_f32_16x16x32_bf16 v[84:87], a[132:135], a[24:27], v[84:87]
ds_write_b128 v97, v[68:71] offset:3072
v_mfma_f32_16x16x32_bf16 v[88:91], a[136:139], a[24:27], v[88:91]
v_mfma_f32_16x16x32_bf16 v[92:95], a[140:143], a[24:27], v[92:95]
ds_write_b128 v97, v[72:75] offset:4096
v_mfma_f32_16x16x32_bf16 v[16:19], a[84:87], a[60:63], v[16:19]
v_mfma_f32_16x16x32_bf16 v[20:23], a[88:91], a[60:63], v[20:23]
v_mfma_f32_16x16x32_bf16 v[24:27], a[92:95], a[60:63], v[24:27]
v_mfma_f32_16x16x32_bf16 v[28:31], a[96:99], a[60:63], v[28:31]
ds_write_b128 v98, v[76:79] offset:0
ds_write_b128 v98, v[80:83] offset:1024
ds_write_b128 v98, v[84:87] offset:2048
ds_write_b128 v98, v[88:91] offset:3072
v_mfma_f32_16x16x32_bf16 v[32:35], a[100:103], a[60:63], v[32:35]
ds_write_b128 v98, v[92:95] offset:4096
v_lshrrev_b32 v3, 4, v1
s_movk_i32 s20, 1280
v_mul_lo_u32 v2, v9, s20
v_and_b32 v4, 1, v3
v_mfma_f32_16x16x32_bf16 v[16:19], a[104:107], a[12:15], v[16:19]
v_lshlrev_b32 v4, 5, v4
v_lshrrev_b32 v5, 1, v3
v_lshlrev_b32 v5, 4, v5
v_add3_u32 v4, v4, v5, v2
v_lshl_add_u32 v5, v3, 3, v2
v_mfma_f32_16x16x32_bf16 v[20:23], a[108:111], a[12:15], v[20:23]
s_lshl_b32 s20, s17, 2
s_add_u32 s20, s20, s16
s_mul_i32 s20, s20, 20480
s_mul_i32 s21, s18, 160
s_add_u32 s20, s20, s21
v_mfma_f32_16x16x32_bf16 v[24:27], a[112:115], a[12:15], v[24:27]
v_lshlrev_b32 v180, 16, v100
v_and_b32 v181, 0xffff0000, v100
v_lshlrev_b32 v182, 16, v101
v_and_b32 v183, 0xffff0000, v101
v_lshlrev_b32 v184, 16, v102
v_mfma_f32_16x16x32_bf16 v[28:31], a[116:119], a[12:15], v[28:31]
v_and_b32 v185, 0xffff0000, v102
v_lshlrev_b32 v186, 16, v103
v_and_b32 v187, 0xffff0000, v103
v_lshlrev_b32 v188, 16, v104
v_and_b32 v189, 0xffff0000, v104
v_mfma_f32_16x16x32_bf16 v[32:35], a[120:123], a[12:15], v[32:35]
v_lshlrev_b32 v190, 16, v105
v_and_b32 v191, 0xffff0000, v105
v_lshlrev_b32 v192, 16, v106
v_and_b32 v193, 0xffff0000, v106
v_lshlrev_b32 v194, 16, v107
s_waitcnt vmcnt(0)
v_mfma_f32_16x16x32_bf16 v[16:19], a[124:127], a[28:31], v[16:19]
v_and_b32 v195, 0xffff0000, v107
v_lshlrev_b32 v196, 16, v108
v_and_b32 v197, 0xffff0000, v108
v_lshlrev_b32 v198, 16, v109
v_and_b32 v199, 0xffff0000, v109
v_mfma_f32_16x16x32_bf16 v[20:23], a[128:131], a[28:31], v[20:23]
v_add_f32 v180, v180, v110
v_add_f32 v181, v181, v110
v_add_f32 v182, v182, v110
v_add_f32 v183, v183, v110
v_add_f32 v184, v184, v110
v_mfma_f32_16x16x32_bf16 v[24:27], a[132:135], a[28:31], v[24:27]
v_add_f32 v185, v185, v110
v_add_f32 v186, v186, v110
v_add_f32 v187, v187, v110
v_add_f32 v188, v188, v110
v_add_f32 v189, v189, v110
v_mfma_f32_16x16x32_bf16 v[28:31], a[136:139], a[28:31], v[28:31]
v_add_f32 v190, v190, v110
v_add_f32 v191, v191, v110
v_add_f32 v192, v192, v110
v_add_f32 v193, v193, v110
v_add_f32 v194, v194, v110
v_mfma_f32_16x16x32_bf16 v[32:35], a[140:143], a[28:31], v[32:35]
v_add_f32 v195, v195, v110
v_add_f32 v196, v196, v110
v_add_f32 v197, v197, v110
v_add_f32 v198, v198, v110
v_add_f32 v199, v199, v110
s_waitcnt lgkmcnt(0)
s_barrier
ds_read_b128 v[120:123], v99 offset:0
ds_read_b128 v[124:127], v99 offset:5120
ds_read_b128 v[128:131], v99 offset:10240
ds_read_b128 v[132:135], v99 offset:1024
ds_read_b128 v[136:139], v99 offset:6144
ds_read_b128 v[140:143], v99 offset:11264
ds_read_b128 v[144:147], v99 offset:2048
ds_read_b128 v[148:151], v99 offset:7168
ds_read_b128 v[152:155], v99 offset:12288
ds_read_b128 v[156:159], v99 offset:3072
ds_read_b128 v[160:163], v99 offset:8192
ds_read_b128 v[164:167], v99 offset:13312
ds_read_b128 v[168:171], v99 offset:4096
ds_read_b128 v[172:175], v99 offset:9216
ds_read_b128 v[176:179], v99 offset:14336
v_add_f32 v16, v16, v180
v_add_f32 v17, v17, v181
v_add_f32 v18, v18, v182
v_add_f32 v19, v19, v183
v_add_f32 v20, v20, v184
v_add_f32 v21, v21, v185
v_add_f32 v22, v22, v186
v_add_f32 v23, v23, v187
v_add_f32 v24, v24, v188
v_add_f32 v25, v25, v189
v_add_f32 v26, v26, v190
v_add_f32 v27, v27, v191
v_add_f32 v28, v28, v192
v_add_f32 v29, v29, v193
v_add_f32 v30, v30, v194
v_add_f32 v31, v31, v195
v_add_f32 v32, v32, v196
v_add_f32 v33, v33, v197
v_add_f32 v34, v34, v198
v_add_f32 v35, v35, v199
s_waitcnt lgkmcnt(13)
v_add_f32 v120, v120, v124
s_waitcnt lgkmcnt(12)
v_add_f32 v16, v16, v128
v_add_f32 v121, v121, v125
v_add_f32 v17, v17, v129
v_add_f32 v122, v122, v126
v_add_f32 v18, v18, v130
v_add_f32 v123, v123, v127
v_add_f32 v19, v19, v131
v_add_f32 v16, v16, v120
v_add_f32 v17, v17, v121
v_add_f32 v18, v18, v122
v_add_f32 v19, v19, v123
v_cvt_pk_bf16_f32 v112, v16, v17
v_cvt_pk_bf16_f32 v113, v18, v19
s_waitcnt lgkmcnt(10)
v_add_f32 v132, v132, v136
s_waitcnt lgkmcnt(9)
v_add_f32 v20, v20, v140
v_add_f32 v133, v133, v137
v_add_f32 v21, v21, v141
v_add_f32 v134, v134, v138
v_add_f32 v22, v22, v142
v_add_f32 v135, v135, v139
v_add_f32 v23, v23, v143
v_add_f32 v20, v20, v132
v_add_f32 v21, v21, v133
v_add_f32 v22, v22, v134
v_add_f32 v23, v23, v135
v_cvt_pk_bf16_f32 v114, v20, v21
v_cvt_pk_bf16_f32 v115, v22, v23
s_nop 0
v_permlane16_swap_b32 v112, v114
v_permlane16_swap_b32 v113, v115
buffer_store_dwordx4 v[112:115], v4, s[96:99], s20 offen offset:0
s_waitcnt lgkmcnt(7)
v_add_f32 v144, v144, v148
s_waitcnt lgkmcnt(6)
v_add_f32 v24, v24, v152
v_add_f32 v145, v145, v149
v_add_f32 v25, v25, v153
v_add_f32 v146, v146, v150
v_add_f32 v26, v26, v154
v_add_f32 v147, v147, v151
v_add_f32 v27, v27, v155
v_add_f32 v24, v24, v144
v_add_f32 v25, v25, v145
v_add_f32 v26, v26, v146
v_add_f32 v27, v27, v147
v_cvt_pk_bf16_f32 v116, v24, v25
v_cvt_pk_bf16_f32 v117, v26, v27
s_waitcnt lgkmcnt(4)
v_add_f32 v156, v156, v160
s_waitcnt lgkmcnt(3)
v_add_f32 v28, v28, v164
v_add_f32 v157, v157, v161
v_add_f32 v29, v29, v165
v_add_f32 v158, v158, v162
v_add_f32 v30, v30, v166
v_add_f32 v159, v159, v163
v_add_f32 v31, v31, v167
v_add_f32 v28, v28, v156
v_add_f32 v29, v29, v157
v_add_f32 v30, v30, v158
v_add_f32 v31, v31, v159
v_cvt_pk_bf16_f32 v118, v28, v29
v_cvt_pk_bf16_f32 v119, v30, v31
s_nop 0
v_permlane16_swap_b32 v116, v118
v_permlane16_swap_b32 v117, v119
buffer_store_dwordx4 v[116:119], v4, s[96:99], s20 offen offset:64
s_waitcnt lgkmcnt(1)
v_add_f32 v168, v168, v172
s_waitcnt lgkmcnt(0)
v_add_f32 v32, v32, v176
v_add_f32 v169, v169, v173
v_add_f32 v33, v33, v177
v_add_f32 v170, v170, v174
v_add_f32 v34, v34, v178
v_add_f32 v171, v171, v175
v_add_f32 v35, v35, v179
v_add_f32 v32, v32, v168
v_add_f32 v33, v33, v169
v_add_f32 v34, v34, v170
v_add_f32 v35, v35, v171
v_cvt_pk_bf16_f32 v112, v32, v33
v_cvt_pk_bf16_f32 v113, v34, v35
buffer_store_dwordx2 v[112:113], v5, s[96:99], s20 offen offset:128
L_end_sequential_preLN__linear_attn_block__swiglu_ffn__prompt_kernel:
s_endpgm

.section .rodata,"a"
.p2align 6
.amdhsa_kernel sequential_preLN__linear_attn_block__swiglu_ffn__prompt_kernel
  .amdhsa_next_free_vgpr 512
  .amdhsa_next_free_sgpr 102
  .amdhsa_accum_offset 256
  .amdhsa_group_segment_fixed_size 0
  .amdhsa_kernarg_size 80
  .amdhsa_user_sgpr_count 2
  .amdhsa_user_sgpr_kernarg_segment_ptr 1
  .amdhsa_system_sgpr_workgroup_id_x 1
  .amdhsa_float_denorm_mode_32 3
.end_amdhsa_kernel
```
